```python
import torch

def _softmax(x, axis=-1):
    return torch.softmax(x, dim=axis)
def _gelu(x):
    return torch.nn.functional.gelu(x, approximate="tanh")
def _silu(x):
    return torch.nn.functional.silu(x)
def _sigmoid(x):
    return torch.sigmoid(x)
def _layernorm(x, axis=-1, eps=1e-5):
    m = x.mean(dim=axis, keepdim=True)
    v = x.var(dim=axis, keepdim=True, unbiased=False)
    return (x - m) / torch.sqrt(v + eps)
def _scatter_add(tgt, idx, src, axis=0):
    return tgt.clone().index_add_(axis, idx, src)
def _segment_sum(src, seg, n):
    out = torch.zeros((n,) + src.shape[1:], dtype=src.dtype)
    return out.index_add_(0, seg, src)
def _pad(x, pw):
    flat = tuple(v for pair in reversed(pw) for v in pair)
    return torch.nn.functional.pad(x, flat)

kernel_name = 'concat_heads__mha_block_cached__mha_block_cached__near_ridge'

def setup_inputs():

    _w = (lambda a: (lambda t: t.to(torch.bfloat16) if t.is_floating_point() else t)(torch.as_tensor(a)))
    def _A_setup():
        B, Sq, D = 8, 144, 512
        H, Sk, Dh = 32, 1024, 128
        return {
            "x": _w((lambda *s: torch.randn(*s, dtype=torch.bfloat16) * 0.8)(B, Sq, D)),
            "k_cache": _w((lambda *s: torch.randn(*s, dtype=torch.bfloat16) * 0.8)(B, H, Sk, Dh)),
            "v_cache": _w((lambda *s: torch.randn(*s, dtype=torch.bfloat16) * 0.05)(B, H, Sk, Dh)),
            "wq": _w((lambda *s: torch.randn(*s, dtype=torch.bfloat16) * 0.8)(D, H * Dh) * (D ** -0.5)),
            "wo": _w((lambda *s: torch.randn(*s, dtype=torch.bfloat16) * 0.05)(H * Dh, D) * ((H * Dh) ** -0.5)),
        }
    _A_in = _A_setup()

    def _B_setup():
        B, Sq, D = 8, 144, 512
        H, Sk, Dh = 32, 1024, 128
        return {
            "x": _w((lambda *s: torch.randn(*s, dtype=torch.bfloat16) * 0.8)(B, Sq, D)),
            "k_cache": _w((lambda *s: torch.randn(*s, dtype=torch.bfloat16) * 0.8)(B, H, Sk, Dh)),
            "v_cache": _w((lambda *s: torch.randn(*s, dtype=torch.bfloat16) * 0.05)(B, H, Sk, Dh)),
            "wq": _w((lambda *s: torch.randn(*s, dtype=torch.bfloat16) * 0.8)(D, H * Dh) * (D ** -0.5)),
            "wo": _w((lambda *s: torch.randn(*s, dtype=torch.bfloat16) * 0.05)(H * Dh, D) * ((H * Dh) ** -0.5)),
        }
    _B_in = _B_setup()

    return {
        "A_x": _A_in["x"],
        "A_k_cache": _A_in["k_cache"],
        "A_v_cache": _A_in["v_cache"],
        "A_wq": _A_in["wq"],
        "A_wo": _A_in["wo"],
        "B_x": _B_in["x"],
        "B_k_cache": _B_in["k_cache"],
        "B_v_cache": _B_in["v_cache"],
        "B_wq": _B_in["wq"],
        "B_wo": _B_in["wo"],
    }

def reference(A_x, A_k_cache, A_v_cache, A_wq, A_wo, B_x, B_k_cache, B_v_cache, B_wq, B_wo):
    def _A_ref(x, k_cache, v_cache, wq, wo):
        B, Sq, D = x.shape
        H, Dh = 32, 128
        q = (lambda x, *d: x.permute(*d))((x @ wq).reshape(B, Sq, H, Dh), 0, 2, 1, 3)
        scores = torch.einsum("bhqd,bhkd->bhqk", q, k_cache) * (Dh ** -0.5)
        p = _softmax(scores, axis=-1)
        o = torch.einsum("bhqk,bhkd->bhqd", p, v_cache)
        return (lambda x, *d: x.permute(*d))(o, 0, 2, 1, 3).reshape(B, Sq, H * Dh) @ wo

    def _B_ref(x, k_cache, v_cache, wq, wo):
        B, Sq, D = x.shape
        H, Dh = 32, 128
        q = (lambda x, *d: x.permute(*d))((x @ wq).reshape(B, Sq, H, Dh), 0, 2, 1, 3)
        scores = torch.einsum("bhqd,bhkd->bhqk", q, k_cache) * (Dh ** -0.5)
        p = _softmax(scores, axis=-1)
        o = torch.einsum("bhqk,bhkd->bhqd", p, v_cache)
        return (lambda x, *d: x.permute(*d))(o, 0, 2, 1, 3).reshape(B, Sq, H * Dh) @ wo

    a = _A_ref(A_x, A_k_cache, A_v_cache, A_wq, A_wo)
    b = _B_ref(B_x, B_k_cache, B_v_cache, B_wq, B_wo)
    return torch.concatenate([a, b], axis=-1)
```

```asm
; @launch kernel=mha_attn_kernel grid=(256,1,1) block=(512,1,1) lds=150528
; @launch kernel=mha_oproj_kernel grid=(256,1,1) block=(512,1,1) lds=163840
.amdgcn_target "amdgcn-amd-amdhsa--gfx950"
.text
.globl mha_attn_kernel
.p2align 8
.type mha_attn_kernel,@function
mha_attn_kernel:
  s_cmp_ge_u32 s2, 256
  s_cbranch_scc1 K1_EXIT
  s_load_dwordx8 s[76:83], s[0:1], 0
  s_load_dwordx8 s[84:91], s[0:1], 40
  s_load_dwordx2 s[56:57], s[0:1], 96
  v_and_b32 v244, 63, v0
  v_lshrrev_b32 v1, 6, v0
  v_lshlrev_b32 v242, 4, v244
  v_readfirstlane_b32 s3, v1
  s_and_b32 s33, s2, 7
  s_lshl_b32 s33, s33, 2
  s_bfe_u32 s60, s2, 0x20003
  s_add_u32 s33, s33, s60
  s_lshr_b32 s32, s2, 5
  s_lshl_b32 s60, s3, 2
  s_lshr_b32 s35, 0x75375300, s60
  s_and_b32 s35, s35, 15
  s_lshr_b32 s36, 0x43276501, s60
  s_and_b32 s36, s36, 15
  s_lshr_b32 s34, 0xE2, s3
  s_and_b32 s34, s34, 1
  s_mov_b32 s64, 0x41000000
  s_mov_b32 s65, 0x3e0293ee
  s_mov_b32 s24, 0
  s_mov_b32 s26, 0
  s_mov_b32 s73, 0
  s_mov_b32 s27, 0
  s_mov_b32 s28, 0
  s_mov_b32 s29, 0
  s_mov_b32 s31, 0
  s_lshl_b32 s60, s32, 5
  s_add_u32 s60, s60, s33
  s_lshl_b32 s60, s60, 18
  s_mul_i32 s61, s32, 147456
  s_lshl_b32 s62, s33, 8
  s_waitcnt lgkmcnt(0)
  s_add_u32 s40, s78, s60
  s_addc_u32 s41, s79, 0
  s_add_u32 s44, s80, s60
  s_addc_u32 s45, s81, 0
  s_add_u32 s42, s86, s60
  s_addc_u32 s43, s87, 0
  s_add_u32 s46, s88, s60
  s_addc_u32 s47, s89, 0
  s_add_u32 s48, s76, s61
  s_addc_u32 s49, s77, 0
  s_add_u32 s50, s84, s61
  s_addc_u32 s51, s85, 0
  s_add_u32 s52, s82, s62
  s_addc_u32 s53, s83, 0
  s_add_u32 s54, s90, s62
  s_addc_u32 s55, s91, 0
  s_mov_b32 s4, s40
  s_mov_b32 s5, s41
  s_mov_b32 s8, s44
  s_mov_b32 s9, s45
  s_mov_b32 s6, 262144
  s_mov_b32 s7, 0x20000
  s_mov_b32 s10, 262144
  s_mov_b32 s11, 0x20000
  s_mov_b32 s14, 147456
  s_mov_b32 s15, 0x20000
  s_mov_b32 s18, 4194304
  s_mov_b32 s19, 0x20000
  s_mov_b32 s22, 9437184
  s_mov_b32 s23, 0x20000
  s_lshr_b32 s60, s2, 3
  s_lshl_b32 s60, s60, 3
  s_add_u32 s60, s60, s3
  s_cmp_lt_u32 s60, 64
  s_cbranch_scc0 L1
  s_mov_b32 s12, s82
  s_mov_b32 s13, s83
  s_mov_b32 s14, 4194304
  s_lshl_b32 s60, s60, 16
  s_and_b32 s61, s2, 7
  s_lshl_b32 s61, s61, 10
  s_add_u32 s60, s60, s61
  v_lshrrev_b32 v253, 3, v244
  v_and_b32 v254, 7, v244
  v_lshlrev_b32 v254, 7, v254
  v_lshl_add_u32 v253, v253, 13, v254
  buffer_load_dword v255, v253, s[12:15], s60 offen
  s_branch L2
L1:
  s_mov_b32 s12, s76
  s_mov_b32 s13, s77
  s_mov_b32 s14, 1179648
  s_sub_u32 s60, s60, 64
  s_lshl_b32 s60, s60, 13
  v_lshlrev_b32 v253, 7, v244
  buffer_load_dword v255, v253, s[12:15], s60 offen
L2:
  s_mov_b32 s14, 147456
  v_and_b32 v1, 15, v244
  v_lshrrev_b32 v2, 4, v244
  v_and_b32 v3, 7, v1
  v_lshlrev_b32 v3, 1, v3
  s_lshl_b32 s60, s34, 13
  v_lshlrev_b32 v4, 8, v1
  v_add_u32 v4, s60, v4
  v_add_u32 v5, 0, v2
  v_xor_b32 v5, v5, v3
  v_lshl_add_u32 v224, v5, 4, v4
  v_add_u32 v5, 4, v2
  v_xor_b32 v5, v5, v3
  v_lshl_add_u32 v225, v5, 4, v4
  v_add_u32 v5, 8, v2
  v_xor_b32 v5, v5, v3
  v_lshl_add_u32 v226, v5, 4, v4
  v_add_u32 v5, 12, v2
  v_xor_b32 v5, v5, v3
  v_lshl_add_u32 v227, v5, 4, v4
  v_lshrrev_b32 v1, 2, v244
  v_and_b32 v3, 7, v1
  v_lshlrev_b32 v3, 1, v3
  v_bfe_u32 v5, v244, 1, 1
  v_xor_b32 v5, v5, v3
  v_lshlrev_b32 v5, 4, v5
  v_and_b32 v6, 1, v244
  v_lshl_add_u32 v5, v6, 3, v5
  v_lshl_add_u32 v5, v1, 8, v5
  s_add_u32 s60, s60, 16384
  v_add_u32 v5, s60, v5
  v_xor_b32 v228, 0, v5
  v_xor_b32 v229, 32, v5
  v_xor_b32 v230, 64, v5
  v_xor_b32 v231, 96, v5
  v_xor_b32 v232, 128, v5
  v_xor_b32 v233, 160, v5
  v_xor_b32 v234, 192, v5
  v_xor_b32 v235, 224, v5
  v_bfe_u32 v1, v244, 2, 2
  v_lshl_add_u32 v3, v2, 3, v1
  v_lshlrev_b32 v3, 8, v3
  s_and_b32 s60, s3, 3
  s_lshl_b32 s60, s60, 2
  v_and_b32 v5, 3, v244
  v_add_u32 v5, s60, v5
  v_lshlrev_b32 v1, 2, v1
  v_xor_b32 v5, v5, v1
  v_lshl_add_u32 v3, v5, 4, v3
  v_add_u32 v243, 98304, v3
  v_mov_b32 v236, 0x3f803f80
  v_mov_b32 v237, 0x3f803f80
  v_mov_b32 v238, 0x3f803f80
  v_mov_b32 v239, 0x3f803f80
  s_and_b32 s39, s3, 1
  s_lshr_b32 s60, s3, 2
  s_lshl_b32 s60, s60, 1
  s_add_u32 s39, s39, s60
  s_cmp_lt_u32 s3, 2
  s_cbranch_scc1 K1_A
  s_cmp_lt_u32 s3, 4
  s_cbranch_scc1 K1_J1
  s_cmp_lt_u32 s3, 6
  s_cbranch_scc1 K1_J2
  s_branch K1_D
K1_J1:
  s_branch K1_B
K1_J2:
  s_branch K1_C
K1_A:
  v_lshrrev_b32 v245, 4, v244
  v_and_b32 v246, 15, v244
  v_lshrrev_b32 v247, 2, v244
  v_sub_u32 v248, 0, v245
  v_xor_b32 v248, v248, v244
  v_and_b32 v248, 3, v248
  v_lshlrev_b32 v248, 4, v248
  v_lshl_add_u32 v240, v247, 10, v248
  v_lshlrev_b32 v247, 2, v245
  v_xor_b32 v248, v246, v247
  v_lshlrev_b32 v248, 4, v248
  v_lshl_add_u32 v241, v245, 13, v248
  s_mov_b32 s60, s39
  s_lshl_b32 s66, s60, 14
  s_lshl_b32 s67, s60, 10
  s_lshl_b32 s70, s60, 16
  s_lshl_b32 s71, s60, 11
  s_lshl_b32 s61, s60, 4
  s_mov_b64 s[68:69], 0xffff
  s_lshl_b64 s[68:69], s[68:69], s61
UNIT_A:
  s_mul_i32 s60, s24, 9437184
  s_add_u32 s20, s56, s60
  s_addc_u32 s21, s57, 0
  s_mov_b32 s58, s24
  s_and_b32 s60, s26, s24
  s_cmp_lg_u32 s60, 0
  s_cbranch_scc1 INIT_A
QP_A:
  s_cmp_eq_u32 s58, 0
  s_cselect_b32 s12, s48, s50
  s_cselect_b32 s13, s49, s51
  s_cselect_b32 s16, s52, s54
  s_cselect_b32 s17, s53, s55
  v_mov_b32 v0, 0
  v_mov_b32 v1, 0
  v_mov_b32 v2, 0
  v_mov_b32 v3, 0
  v_mov_b32 v4, 0
  v_mov_b32 v5, 0
  v_mov_b32 v6, 0
  v_mov_b32 v7, 0
  v_mov_b32 v8, 0
  v_mov_b32 v9, 0
  v_mov_b32 v10, 0
  v_mov_b32 v11, 0
  v_mov_b32 v12, 0
  v_mov_b32 v13, 0
  v_mov_b32 v14, 0
  v_mov_b32 v15, 0
  v_mov_b32 v16, 0
  v_mov_b32 v17, 0
  v_mov_b32 v18, 0
  v_mov_b32 v19, 0
  v_mov_b32 v20, 0
  v_mov_b32 v21, 0
  v_mov_b32 v22, 0
  v_mov_b32 v23, 0
  v_mov_b32 v24, 0
  v_mov_b32 v25, 0
  v_mov_b32 v26, 0
  v_mov_b32 v27, 0
  v_mov_b32 v28, 0
  v_mov_b32 v29, 0
  v_mov_b32 v30, 0
  v_mov_b32 v31, 0
  v_mov_b32 v32, 0
  v_mov_b32 v33, 0
  v_mov_b32 v34, 0
  v_mov_b32 v35, 0
  v_mov_b32 v36, 0
  v_mov_b32 v37, 0
  v_mov_b32 v38, 0
  v_mov_b32 v39, 0
  v_and_b32 v245, 15, v244
  v_lshrrev_b32 v246, 2, v245
  v_sub_u32 v246, 0, v246
  v_lshrrev_b32 v247, 4, v244
  v_xor_b32 v246, v246, v247
  v_and_b32 v246, 3, v246
  v_lshlrev_b32 v246, 4, v246
  v_lshl_add_u32 v245, v245, 6, v246
  v_add_u32 v245, 98304, v245
  s_add_u32 s37, s73, 0
  s_and_b32 s37, s37, 15
  s_lshl_b32 s38, s37, 18
  s_lshl_b32 s37, s37, 6
  s_add_u32 m0, s67, 98304
  s_add_u32 s60, s66, s37
  buffer_load_dwordx4 v240, s[12:15], s60 offen lds
  s_add_u32 m0, s67, 102400
  s_add_u32 s60, s60, 65536
  buffer_load_dwordx4 v240, s[12:15], s60 offen lds
  s_mov_b32 m0, 106496
  s_add_u32 s60, s37, 131072
  s_mov_b64 exec, s[68:69]
  buffer_load_dwordx4 v240, s[12:15], s60 offen lds
  s_mov_b64 exec, -1
  s_add_u32 s37, s73, 1
  s_and_b32 s37, s37, 15
  s_lshl_b32 s38, s37, 18
  s_lshl_b32 s37, s37, 6
  s_add_u32 m0, s67, 115712
  s_add_u32 s60, s66, s37
  buffer_load_dwordx4 v240, s[12:15], s60 offen lds
  s_add_u32 m0, s67, 119808
  s_add_u32 s60, s60, 65536
  buffer_load_dwordx4 v240, s[12:15], s60 offen lds
  s_mov_b32 m0, 123904
  s_add_u32 s60, s37, 131072
  s_mov_b64 exec, s[68:69]
  buffer_load_dwordx4 v240, s[12:15], s60 offen lds
  s_mov_b64 exec, -1
  s_add_u32 s37, s73, 2
  s_and_b32 s37, s37, 15
  s_lshl_b32 s38, s37, 18
  s_lshl_b32 s37, s37, 6
  s_add_u32 m0, s67, 133120
  s_add_u32 s60, s66, s37
  buffer_load_dwordx4 v240, s[12:15], s60 offen lds
  s_add_u32 m0, s67, 137216
  s_add_u32 s60, s60, 65536
  buffer_load_dwordx4 v240, s[12:15], s60 offen lds
  s_mov_b32 m0, 141312
  s_add_u32 s60, s37, 131072
  s_mov_b64 exec, s[68:69]
  buffer_load_dwordx4 v240, s[12:15], s60 offen lds
  s_mov_b64 exec, -1
  s_waitcnt vmcnt(6)
  s_barrier
  ds_read_b64_tr_b16 v[40:41], v243 offset:9216
  ds_read_b64_tr_b16 v[42:43], v243 offset:10240
  ds_read_b64_tr_b16 v[44:45], v243 offset:9224
  ds_read_b64_tr_b16 v[46:47], v243 offset:10248
  ds_read_b128 v[56:59], v245 offset:0
  ds_read_b128 v[60:63], v245 offset:1024
  ds_read_b128 v[64:67], v245 offset:2048
  ds_read_b128 v[68:71], v245 offset:3072
  ds_read_b128 v[72:75], v245 offset:4096
  s_waitcnt vmcnt(3)
  s_waitcnt lgkmcnt(0)
  s_barrier
  ds_read_b64_tr_b16 v[48:49], v243 offset:26624
  ds_read_b64_tr_b16 v[50:51], v243 offset:27648
  ds_read_b64_tr_b16 v[52:53], v243 offset:26632
  ds_read_b64_tr_b16 v[54:55], v243 offset:27656
  ds_read_b128 v[76:79], v245 offset:17408
  ds_read_b128 v[80:83], v245 offset:18432
  ds_read_b128 v[84:87], v245 offset:19456
  ds_read_b128 v[88:91], v245 offset:20480
  ds_read_b128 v[92:95], v245 offset:21504
  v_mfma_f32_16x16x32_bf16 v[0:3], v[40:43], v[56:59], v[0:3]
  v_mfma_f32_16x16x32_bf16 v[20:23], v[44:47], v[56:59], v[20:23]
  s_add_u32 s37, s73, 3
  s_and_b32 s37, s37, 15
  s_lshl_b32 s38, s37, 18
  s_lshl_b32 s37, s37, 6
  s_add_u32 m0, s67, 98304
  s_add_u32 s60, s66, s37
  buffer_load_dwordx4 v240, s[12:15], s60 offen lds
  v_mfma_f32_16x16x32_bf16 v[4:7], v[40:43], v[60:63], v[4:7]
  v_mfma_f32_16x16x32_bf16 v[24:27], v[44:47], v[60:63], v[24:27]
  s_add_u32 m0, s67, 102400
  s_add_u32 s60, s60, 65536
  buffer_load_dwordx4 v240, s[12:15], s60 offen lds
  v_mfma_f32_16x16x32_bf16 v[8:11], v[40:43], v[64:67], v[8:11]
  v_mfma_f32_16x16x32_bf16 v[28:31], v[44:47], v[64:67], v[28:31]
  s_mov_b32 m0, 106496
  s_add_u32 s60, s37, 131072
  s_mov_b64 exec, s[68:69]
  buffer_load_dwordx4 v240, s[12:15], s60 offen lds
  s_mov_b64 exec, -1
  v_mfma_f32_16x16x32_bf16 v[12:15], v[40:43], v[68:71], v[12:15]
  v_mfma_f32_16x16x32_bf16 v[32:35], v[44:47], v[68:71], v[32:35]
  v_mfma_f32_16x16x32_bf16 v[16:19], v[40:43], v[72:75], v[16:19]
  v_mfma_f32_16x16x32_bf16 v[36:39], v[44:47], v[72:75], v[36:39]
  s_waitcnt vmcnt(3)
  s_waitcnt lgkmcnt(0)
  s_barrier
  ds_read_b64_tr_b16 v[40:41], v243 offset:44032
  ds_read_b64_tr_b16 v[42:43], v243 offset:45056
  ds_read_b64_tr_b16 v[44:45], v243 offset:44040
  ds_read_b64_tr_b16 v[46:47], v243 offset:45064
  ds_read_b128 v[56:59], v245 offset:34816
  ds_read_b128 v[60:63], v245 offset:35840
  ds_read_b128 v[64:67], v245 offset:36864
  ds_read_b128 v[68:71], v245 offset:37888
  ds_read_b128 v[72:75], v245 offset:38912
  v_mfma_f32_16x16x32_bf16 v[0:3], v[48:51], v[76:79], v[0:3]
  v_mfma_f32_16x16x32_bf16 v[20:23], v[52:55], v[76:79], v[20:23]
  s_add_u32 s37, s73, 4
  s_and_b32 s37, s37, 15
  s_lshl_b32 s38, s37, 18
  s_lshl_b32 s37, s37, 6
  s_add_u32 m0, s67, 115712
  s_add_u32 s60, s66, s37
  buffer_load_dwordx4 v240, s[12:15], s60 offen lds
  v_mfma_f32_16x16x32_bf16 v[4:7], v[48:51], v[80:83], v[4:7]
  v_mfma_f32_16x16x32_bf16 v[24:27], v[52:55], v[80:83], v[24:27]
  s_add_u32 m0, s67, 119808
  s_add_u32 s60, s60, 65536
  buffer_load_dwordx4 v240, s[12:15], s60 offen lds
  v_mfma_f32_16x16x32_bf16 v[8:11], v[48:51], v[84:87], v[8:11]
  v_mfma_f32_16x16x32_bf16 v[28:31], v[52:55], v[84:87], v[28:31]
  s_mov_b32 m0, 123904
  s_add_u32 s60, s37, 131072
  s_mov_b64 exec, s[68:69]
  buffer_load_dwordx4 v240, s[12:15], s60 offen lds
  s_mov_b64 exec, -1
  v_mfma_f32_16x16x32_bf16 v[12:15], v[48:51], v[88:91], v[12:15]
  v_mfma_f32_16x16x32_bf16 v[32:35], v[52:55], v[88:91], v[32:35]
  v_mfma_f32_16x16x32_bf16 v[16:19], v[48:51], v[92:95], v[16:19]
  v_mfma_f32_16x16x32_bf16 v[36:39], v[52:55], v[92:95], v[36:39]
  s_waitcnt vmcnt(3)
  s_waitcnt lgkmcnt(0)
  s_barrier
  ds_read_b64_tr_b16 v[48:49], v243 offset:9216
  ds_read_b64_tr_b16 v[50:51], v243 offset:10240
  ds_read_b64_tr_b16 v[52:53], v243 offset:9224
  ds_read_b64_tr_b16 v[54:55], v243 offset:10248
  ds_read_b128 v[76:79], v245 offset:0
  ds_read_b128 v[80:83], v245 offset:1024
  ds_read_b128 v[84:87], v245 offset:2048
  ds_read_b128 v[88:91], v245 offset:3072
  ds_read_b128 v[92:95], v245 offset:4096
  v_mfma_f32_16x16x32_bf16 v[0:3], v[40:43], v[56:59], v[0:3]
  v_mfma_f32_16x16x32_bf16 v[20:23], v[44:47], v[56:59], v[20:23]
  s_add_u32 s37, s73, 5
  s_and_b32 s37, s37, 15
  s_lshl_b32 s38, s37, 18
  s_lshl_b32 s37, s37, 6
  s_add_u32 m0, s67, 133120
  s_add_u32 s60, s66, s37
  buffer_load_dwordx4 v240, s[12:15], s60 offen lds
  v_mfma_f32_16x16x32_bf16 v[4:7], v[40:43], v[60:63], v[4:7]
  v_mfma_f32_16x16x32_bf16 v[24:27], v[44:47], v[60:63], v[24:27]
  s_add_u32 m0, s67, 137216
  s_add_u32 s60, s60, 65536
  buffer_load_dwordx4 v240, s[12:15], s60 offen lds
  v_mfma_f32_16x16x32_bf16 v[8:11], v[40:43], v[64:67], v[8:11]
  v_mfma_f32_16x16x32_bf16 v[28:31], v[44:47], v[64:67], v[28:31]
  s_mov_b32 m0, 141312
  s_add_u32 s60, s37, 131072
  s_mov_b64 exec, s[68:69]
  buffer_load_dwordx4 v240, s[12:15], s60 offen lds
  s_mov_b64 exec, -1
  v_mfma_f32_16x16x32_bf16 v[12:15], v[40:43], v[68:71], v[12:15]
  v_mfma_f32_16x16x32_bf16 v[32:35], v[44:47], v[68:71], v[32:35]
  v_mfma_f32_16x16x32_bf16 v[16:19], v[40:43], v[72:75], v[16:19]
  v_mfma_f32_16x16x32_bf16 v[36:39], v[44:47], v[72:75], v[36:39]
  s_waitcnt vmcnt(3)
  s_waitcnt lgkmcnt(0)
  s_barrier
  ds_read_b64_tr_b16 v[40:41], v243 offset:26624
  ds_read_b64_tr_b16 v[42:43], v243 offset:27648
  ds_read_b64_tr_b16 v[44:45], v243 offset:26632
  ds_read_b64_tr_b16 v[46:47], v243 offset:27656
  ds_read_b128 v[56:59], v245 offset:17408
  ds_read_b128 v[60:63], v245 offset:18432
  ds_read_b128 v[64:67], v245 offset:19456
  ds_read_b128 v[68:71], v245 offset:20480
  ds_read_b128 v[72:75], v245 offset:21504
  v_mfma_f32_16x16x32_bf16 v[0:3], v[48:51], v[76:79], v[0:3]
  v_mfma_f32_16x16x32_bf16 v[20:23], v[52:55], v[76:79], v[20:23]
  s_add_u32 s37, s73, 6
  s_and_b32 s37, s37, 15
  s_lshl_b32 s38, s37, 18
  s_lshl_b32 s37, s37, 6
  s_add_u32 m0, s67, 98304
  s_add_u32 s60, s66, s37
  buffer_load_dwordx4 v240, s[12:15], s60 offen lds
  v_mfma_f32_16x16x32_bf16 v[4:7], v[48:51], v[80:83], v[4:7]
  v_mfma_f32_16x16x32_bf16 v[24:27], v[52:55], v[80:83], v[24:27]
  s_add_u32 m0, s67, 102400
  s_add_u32 s60, s60, 65536
  buffer_load_dwordx4 v240, s[12:15], s60 offen lds
  v_mfma_f32_16x16x32_bf16 v[8:11], v[48:51], v[84:87], v[8:11]
  v_mfma_f32_16x16x32_bf16 v[28:31], v[52:55], v[84:87], v[28:31]
  s_mov_b32 m0, 106496
  s_add_u32 s60, s37, 131072
  s_mov_b64 exec, s[68:69]
  buffer_load_dwordx4 v240, s[12:15], s60 offen lds
  s_mov_b64 exec, -1
  v_mfma_f32_16x16x32_bf16 v[12:15], v[48:51], v[88:91], v[12:15]
  v_mfma_f32_16x16x32_bf16 v[32:35], v[52:55], v[88:91], v[32:35]
  v_mfma_f32_16x16x32_bf16 v[16:19], v[48:51], v[92:95], v[16:19]
  v_mfma_f32_16x16x32_bf16 v[36:39], v[52:55], v[92:95], v[36:39]
  s_waitcnt vmcnt(3)
  s_waitcnt lgkmcnt(0)
  s_barrier
  ds_read_b64_tr_b16 v[48:49], v243 offset:44032
  ds_read_b64_tr_b16 v[50:51], v243 offset:45056
  ds_read_b64_tr_b16 v[52:53], v243 offset:44040
  ds_read_b64_tr_b16 v[54:55], v243 offset:45064
  ds_read_b128 v[76:79], v245 offset:34816
  ds_read_b128 v[80:83], v245 offset:35840
  ds_read_b128 v[84:87], v245 offset:36864
  ds_read_b128 v[88:91], v245 offset:37888
  ds_read_b128 v[92:95], v245 offset:38912
  v_mfma_f32_16x16x32_bf16 v[0:3], v[40:43], v[56:59], v[0:3]
  v_mfma_f32_16x16x32_bf16 v[20:23], v[44:47], v[56:59], v[20:23]
  s_add_u32 s37, s73, 7
  s_and_b32 s37, s37, 15
  s_lshl_b32 s38, s37, 18
  s_lshl_b32 s37, s37, 6
  s_add_u32 m0, s67, 115712
  s_add_u32 s60, s66, s37
  buffer_load_dwordx4 v240, s[12:15], s60 offen lds
  v_mfma_f32_16x16x32_bf16 v[4:7], v[40:43], v[60:63], v[4:7]
  v_mfma_f32_16x16x32_bf16 v[24:27], v[44:47], v[60:63], v[24:27]
  s_add_u32 m0, s67, 119808
  s_add_u32 s60, s60, 65536
  buffer_load_dwordx4 v240, s[12:15], s60 offen lds
  v_mfma_f32_16x16x32_bf16 v[8:11], v[40:43], v[64:67], v[8:11]
  v_mfma_f32_16x16x32_bf16 v[28:31], v[44:47], v[64:67], v[28:31]
  s_mov_b32 m0, 123904
  s_add_u32 s60, s37, 131072
  s_mov_b64 exec, s[68:69]
  buffer_load_dwordx4 v240, s[12:15], s60 offen lds
  s_mov_b64 exec, -1
  v_mfma_f32_16x16x32_bf16 v[12:15], v[40:43], v[68:71], v[12:15]
  v_mfma_f32_16x16x32_bf16 v[32:35], v[44:47], v[68:71], v[32:35]
  v_mfma_f32_16x16x32_bf16 v[16:19], v[40:43], v[72:75], v[16:19]
  v_mfma_f32_16x16x32_bf16 v[36:39], v[44:47], v[72:75], v[36:39]
  s_waitcnt vmcnt(3)
  s_waitcnt lgkmcnt(0)
  s_barrier
  ds_read_b64_tr_b16 v[40:41], v243 offset:9216
  ds_read_b64_tr_b16 v[42:43], v243 offset:10240
  ds_read_b64_tr_b16 v[44:45], v243 offset:9224
  ds_read_b64_tr_b16 v[46:47], v243 offset:10248
  ds_read_b128 v[56:59], v245 offset:0
  ds_read_b128 v[60:63], v245 offset:1024
  ds_read_b128 v[64:67], v245 offset:2048
  ds_read_b128 v[68:71], v245 offset:3072
  ds_read_b128 v[72:75], v245 offset:4096
  v_mfma_f32_16x16x32_bf16 v[0:3], v[48:51], v[76:79], v[0:3]
  v_mfma_f32_16x16x32_bf16 v[20:23], v[52:55], v[76:79], v[20:23]
  s_add_u32 s37, s73, 8
  s_and_b32 s37, s37, 15
  s_lshl_b32 s38, s37, 18
  s_lshl_b32 s37, s37, 6
  s_add_u32 m0, s67, 133120
  s_add_u32 s60, s66, s37
  buffer_load_dwordx4 v240, s[12:15], s60 offen lds
  v_mfma_f32_16x16x32_bf16 v[4:7], v[48:51], v[80:83], v[4:7]
  v_mfma_f32_16x16x32_bf16 v[24:27], v[52:55], v[80:83], v[24:27]
  s_add_u32 m0, s67, 137216
  s_add_u32 s60, s60, 65536
  buffer_load_dwordx4 v240, s[12:15], s60 offen lds
  v_mfma_f32_16x16x32_bf16 v[8:11], v[48:51], v[84:87], v[8:11]
  v_mfma_f32_16x16x32_bf16 v[28:31], v[52:55], v[84:87], v[28:31]
  s_mov_b32 m0, 141312
  s_add_u32 s60, s37, 131072
  s_mov_b64 exec, s[68:69]
  buffer_load_dwordx4 v240, s[12:15], s60 offen lds
  s_mov_b64 exec, -1
  v_mfma_f32_16x16x32_bf16 v[12:15], v[48:51], v[88:91], v[12:15]
  v_mfma_f32_16x16x32_bf16 v[32:35], v[52:55], v[88:91], v[32:35]
  v_mfma_f32_16x16x32_bf16 v[16:19], v[48:51], v[92:95], v[16:19]
  v_mfma_f32_16x16x32_bf16 v[36:39], v[52:55], v[92:95], v[36:39]
  s_waitcnt vmcnt(3)
  s_waitcnt lgkmcnt(0)
  s_barrier
  ds_read_b64_tr_b16 v[48:49], v243 offset:26624
  ds_read_b64_tr_b16 v[50:51], v243 offset:27648
  ds_read_b64_tr_b16 v[52:53], v243 offset:26632
  ds_read_b64_tr_b16 v[54:55], v243 offset:27656
  ds_read_b128 v[76:79], v245 offset:17408
  ds_read_b128 v[80:83], v245 offset:18432
  ds_read_b128 v[84:87], v245 offset:19456
  ds_read_b128 v[88:91], v245 offset:20480
  ds_read_b128 v[92:95], v245 offset:21504
  v_mfma_f32_16x16x32_bf16 v[0:3], v[40:43], v[56:59], v[0:3]
  v_mfma_f32_16x16x32_bf16 v[20:23], v[44:47], v[56:59], v[20:23]
  s_add_u32 s37, s73, 9
  s_and_b32 s37, s37, 15
  s_lshl_b32 s38, s37, 18
  s_lshl_b32 s37, s37, 6
  s_add_u32 m0, s67, 98304
  s_add_u32 s60, s66, s37
  buffer_load_dwordx4 v240, s[12:15], s60 offen lds
  v_mfma_f32_16x16x32_bf16 v[4:7], v[40:43], v[60:63], v[4:7]
  v_mfma_f32_16x16x32_bf16 v[24:27], v[44:47], v[60:63], v[24:27]
  s_add_u32 m0, s67, 102400
  s_add_u32 s60, s60, 65536
  buffer_load_dwordx4 v240, s[12:15], s60 offen lds
  v_mfma_f32_16x16x32_bf16 v[8:11], v[40:43], v[64:67], v[8:11]
  v_mfma_f32_16x16x32_bf16 v[28:31], v[44:47], v[64:67], v[28:31]
  s_mov_b32 m0, 106496
  s_add_u32 s60, s37, 131072
  s_mov_b64 exec, s[68:69]
  buffer_load_dwordx4 v240, s[12:15], s60 offen lds
  s_mov_b64 exec, -1
  v_mfma_f32_16x16x32_bf16 v[12:15], v[40:43], v[68:71], v[12:15]
  v_mfma_f32_16x16x32_bf16 v[32:35], v[44:47], v[68:71], v[32:35]
  v_mfma_f32_16x16x32_bf16 v[16:19], v[40:43], v[72:75], v[16:19]
  v_mfma_f32_16x16x32_bf16 v[36:39], v[44:47], v[72:75], v[36:39]
  s_waitcnt vmcnt(3)
  s_waitcnt lgkmcnt(0)
  s_barrier
  ds_read_b64_tr_b16 v[40:41], v243 offset:44032
  ds_read_b64_tr_b16 v[42:43], v243 offset:45056
  ds_read_b64_tr_b16 v[44:45], v243 offset:44040
  ds_read_b64_tr_b16 v[46:47], v243 offset:45064
  ds_read_b128 v[56:59], v245 offset:34816
  ds_read_b128 v[60:63], v245 offset:35840
  ds_read_b128 v[64:67], v245 offset:36864
  ds_read_b128 v[68:71], v245 offset:37888
  ds_read_b128 v[72:75], v245 offset:38912
  v_mfma_f32_16x16x32_bf16 v[0:3], v[48:51], v[76:79], v[0:3]
  v_mfma_f32_16x16x32_bf16 v[20:23], v[52:55], v[76:79], v[20:23]
  s_add_u32 s37, s73, 10
  s_and_b32 s37, s37, 15
  s_lshl_b32 s38, s37, 18
  s_lshl_b32 s37, s37, 6
  s_add_u32 m0, s67, 115712
  s_add_u32 s60, s66, s37
  buffer_load_dwordx4 v240, s[12:15], s60 offen lds
  v_mfma_f32_16x16x32_bf16 v[4:7], v[48:51], v[80:83], v[4:7]
  v_mfma_f32_16x16x32_bf16 v[24:27], v[52:55], v[80:83], v[24:27]
  s_add_u32 m0, s67, 119808
  s_add_u32 s60, s60, 65536
  buffer_load_dwordx4 v240, s[12:15], s60 offen lds
  v_mfma_f32_16x16x32_bf16 v[8:11], v[48:51], v[84:87], v[8:11]
  v_mfma_f32_16x16x32_bf16 v[28:31], v[52:55], v[84:87], v[28:31]
  s_mov_b32 m0, 123904
  s_add_u32 s60, s37, 131072
  s_mov_b64 exec, s[68:69]
  buffer_load_dwordx4 v240, s[12:15], s60 offen lds
  s_mov_b64 exec, -1
  v_mfma_f32_16x16x32_bf16 v[12:15], v[48:51], v[88:91], v[12:15]
  v_mfma_f32_16x16x32_bf16 v[32:35], v[52:55], v[88:91], v[32:35]
  v_mfma_f32_16x16x32_bf16 v[16:19], v[48:51], v[92:95], v[16:19]
  v_mfma_f32_16x16x32_bf16 v[36:39], v[52:55], v[92:95], v[36:39]
  s_waitcnt vmcnt(3)
  s_waitcnt lgkmcnt(0)
  s_barrier
  ds_read_b64_tr_b16 v[48:49], v243 offset:9216
  ds_read_b64_tr_b16 v[50:51], v243 offset:10240
  ds_read_b64_tr_b16 v[52:53], v243 offset:9224
  ds_read_b64_tr_b16 v[54:55], v243 offset:10248
  ds_read_b128 v[76:79], v245 offset:0
  ds_read_b128 v[80:83], v245 offset:1024
  ds_read_b128 v[84:87], v245 offset:2048
  ds_read_b128 v[88:91], v245 offset:3072
  ds_read_b128 v[92:95], v245 offset:4096
  v_mfma_f32_16x16x32_bf16 v[0:3], v[40:43], v[56:59], v[0:3]
  v_mfma_f32_16x16x32_bf16 v[20:23], v[44:47], v[56:59], v[20:23]
  s_add_u32 s37, s73, 11
  s_and_b32 s37, s37, 15
  s_lshl_b32 s38, s37, 18
  s_lshl_b32 s37, s37, 6
  s_add_u32 m0, s67, 133120
  s_add_u32 s60, s66, s37
  buffer_load_dwordx4 v240, s[12:15], s60 offen lds
  v_mfma_f32_16x16x32_bf16 v[4:7], v[40:43], v[60:63], v[4:7]
  v_mfma_f32_16x16x32_bf16 v[24:27], v[44:47], v[60:63], v[24:27]
  s_add_u32 m0, s67, 137216
  s_add_u32 s60, s60, 65536
  buffer_load_dwordx4 v240, s[12:15], s60 offen lds
  v_mfma_f32_16x16x32_bf16 v[8:11], v[40:43], v[64:67], v[8:11]
  v_mfma_f32_16x16x32_bf16 v[28:31], v[44:47], v[64:67], v[28:31]
  s_mov_b32 m0, 141312
  s_add_u32 s60, s37, 131072
  s_mov_b64 exec, s[68:69]
  buffer_load_dwordx4 v240, s[12:15], s60 offen lds
  s_mov_b64 exec, -1
  v_mfma_f32_16x16x32_bf16 v[12:15], v[40:43], v[68:71], v[12:15]
  v_mfma_f32_16x16x32_bf16 v[32:35], v[44:47], v[68:71], v[32:35]
  v_mfma_f32_16x16x32_bf16 v[16:19], v[40:43], v[72:75], v[16:19]
  v_mfma_f32_16x16x32_bf16 v[36:39], v[44:47], v[72:75], v[36:39]
  s_waitcnt vmcnt(3)
  s_waitcnt lgkmcnt(0)
  s_barrier
  ds_read_b64_tr_b16 v[40:41], v243 offset:26624
  ds_read_b64_tr_b16 v[42:43], v243 offset:27648
  ds_read_b64_tr_b16 v[44:45], v243 offset:26632
  ds_read_b64_tr_b16 v[46:47], v243 offset:27656
  ds_read_b128 v[56:59], v245 offset:17408
  ds_read_b128 v[60:63], v245 offset:18432
  ds_read_b128 v[64:67], v245 offset:19456
  ds_read_b128 v[68:71], v245 offset:20480
  ds_read_b128 v[72:75], v245 offset:21504
  v_mfma_f32_16x16x32_bf16 v[0:3], v[48:51], v[76:79], v[0:3]
  v_mfma_f32_16x16x32_bf16 v[20:23], v[52:55], v[76:79], v[20:23]
  s_add_u32 s37, s73, 12
  s_and_b32 s37, s37, 15
  s_lshl_b32 s38, s37, 18
  s_lshl_b32 s37, s37, 6
  s_add_u32 m0, s67, 98304
  s_add_u32 s60, s66, s37
  buffer_load_dwordx4 v240, s[12:15], s60 offen lds
  v_mfma_f32_16x16x32_bf16 v[4:7], v[48:51], v[80:83], v[4:7]
  v_mfma_f32_16x16x32_bf16 v[24:27], v[52:55], v[80:83], v[24:27]
  s_add_u32 m0, s67, 102400
  s_add_u32 s60, s60, 65536
  buffer_load_dwordx4 v240, s[12:15], s60 offen lds
  v_mfma_f32_16x16x32_bf16 v[8:11], v[48:51], v[84:87], v[8:11]
  v_mfma_f32_16x16x32_bf16 v[28:31], v[52:55], v[84:87], v[28:31]
  s_mov_b32 m0, 106496
  s_add_u32 s60, s37, 131072
  s_mov_b64 exec, s[68:69]
  buffer_load_dwordx4 v240, s[12:15], s60 offen lds
  s_mov_b64 exec, -1
  v_mfma_f32_16x16x32_bf16 v[12:15], v[48:51], v[88:91], v[12:15]
  v_mfma_f32_16x16x32_bf16 v[32:35], v[52:55], v[88:91], v[32:35]
  v_mfma_f32_16x16x32_bf16 v[16:19], v[48:51], v[92:95], v[16:19]
  v_mfma_f32_16x16x32_bf16 v[36:39], v[52:55], v[92:95], v[36:39]
  s_waitcnt vmcnt(3)
  s_waitcnt lgkmcnt(0)
  s_barrier
  ds_read_b64_tr_b16 v[48:49], v243 offset:44032
  ds_read_b64_tr_b16 v[50:51], v243 offset:45056
  ds_read_b64_tr_b16 v[52:53], v243 offset:44040
  ds_read_b64_tr_b16 v[54:55], v243 offset:45064
  ds_read_b128 v[76:79], v245 offset:34816
  ds_read_b128 v[80:83], v245 offset:35840
  ds_read_b128 v[84:87], v245 offset:36864
  ds_read_b128 v[88:91], v245 offset:37888
  ds_read_b128 v[92:95], v245 offset:38912
  v_mfma_f32_16x16x32_bf16 v[0:3], v[40:43], v[56:59], v[0:3]
  v_mfma_f32_16x16x32_bf16 v[20:23], v[44:47], v[56:59], v[20:23]
  s_add_u32 s37, s73, 13
  s_and_b32 s37, s37, 15
  s_lshl_b32 s38, s37, 18
  s_lshl_b32 s37, s37, 6
  s_add_u32 m0, s67, 115712
  s_add_u32 s60, s66, s37
  buffer_load_dwordx4 v240, s[12:15], s60 offen lds
  v_mfma_f32_16x16x32_bf16 v[4:7], v[40:43], v[60:63], v[4:7]
  v_mfma_f32_16x16x32_bf16 v[24:27], v[44:47], v[60:63], v[24:27]
  s_add_u32 m0, s67, 119808
  s_add_u32 s60, s60, 65536
  buffer_load_dwordx4 v240, s[12:15], s60 offen lds
  v_mfma_f32_16x16x32_bf16 v[8:11], v[40:43], v[64:67], v[8:11]
  v_mfma_f32_16x16x32_bf16 v[28:31], v[44:47], v[64:67], v[28:31]
  s_mov_b32 m0, 123904
  s_add_u32 s60, s37, 131072
  s_mov_b64 exec, s[68:69]
  buffer_load_dwordx4 v240, s[12:15], s60 offen lds
  s_mov_b64 exec, -1
  v_mfma_f32_16x16x32_bf16 v[12:15], v[40:43], v[68:71], v[12:15]
  v_mfma_f32_16x16x32_bf16 v[32:35], v[44:47], v[68:71], v[32:35]
  v_mfma_f32_16x16x32_bf16 v[16:19], v[40:43], v[72:75], v[16:19]
  v_mfma_f32_16x16x32_bf16 v[36:39], v[44:47], v[72:75], v[36:39]
  s_waitcnt vmcnt(3)
  s_waitcnt lgkmcnt(0)
  s_barrier
  ds_read_b64_tr_b16 v[40:41], v243 offset:9216
  ds_read_b64_tr_b16 v[42:43], v243 offset:10240
  ds_read_b64_tr_b16 v[44:45], v243 offset:9224
  ds_read_b64_tr_b16 v[46:47], v243 offset:10248
  ds_read_b128 v[56:59], v245 offset:0
  ds_read_b128 v[60:63], v245 offset:1024
  ds_read_b128 v[64:67], v245 offset:2048
  ds_read_b128 v[68:71], v245 offset:3072
  ds_read_b128 v[72:75], v245 offset:4096
  v_mfma_f32_16x16x32_bf16 v[0:3], v[48:51], v[76:79], v[0:3]
  v_mfma_f32_16x16x32_bf16 v[20:23], v[52:55], v[76:79], v[20:23]
  s_add_u32 s37, s73, 14
  s_and_b32 s37, s37, 15
  s_lshl_b32 s38, s37, 18
  s_lshl_b32 s37, s37, 6
  s_add_u32 m0, s67, 133120
  s_add_u32 s60, s66, s37
  buffer_load_dwordx4 v240, s[12:15], s60 offen lds
  v_mfma_f32_16x16x32_bf16 v[4:7], v[48:51], v[80:83], v[4:7]
  v_mfma_f32_16x16x32_bf16 v[24:27], v[52:55], v[80:83], v[24:27]
  s_add_u32 m0, s67, 137216
  s_add_u32 s60, s60, 65536
  buffer_load_dwordx4 v240, s[12:15], s60 offen lds
  v_mfma_f32_16x16x32_bf16 v[8:11], v[48:51], v[84:87], v[8:11]
  v_mfma_f32_16x16x32_bf16 v[28:31], v[52:55], v[84:87], v[28:31]
  s_mov_b32 m0, 141312
  s_add_u32 s60, s37, 131072
  s_mov_b64 exec, s[68:69]
  buffer_load_dwordx4 v240, s[12:15], s60 offen lds
  s_mov_b64 exec, -1
  v_mfma_f32_16x16x32_bf16 v[12:15], v[48:51], v[88:91], v[12:15]
  v_mfma_f32_16x16x32_bf16 v[32:35], v[52:55], v[88:91], v[32:35]
  v_mfma_f32_16x16x32_bf16 v[16:19], v[48:51], v[92:95], v[16:19]
  v_mfma_f32_16x16x32_bf16 v[36:39], v[52:55], v[92:95], v[36:39]
  s_waitcnt vmcnt(3)
  s_waitcnt lgkmcnt(0)
  s_barrier
  ds_read_b64_tr_b16 v[48:49], v243 offset:26624
  ds_read_b64_tr_b16 v[50:51], v243 offset:27648
  ds_read_b64_tr_b16 v[52:53], v243 offset:26632
  ds_read_b64_tr_b16 v[54:55], v243 offset:27656
  ds_read_b128 v[76:79], v245 offset:17408
  ds_read_b128 v[80:83], v245 offset:18432
  ds_read_b128 v[84:87], v245 offset:19456
  ds_read_b128 v[88:91], v245 offset:20480
  ds_read_b128 v[92:95], v245 offset:21504
  v_mfma_f32_16x16x32_bf16 v[0:3], v[40:43], v[56:59], v[0:3]
  v_mfma_f32_16x16x32_bf16 v[20:23], v[44:47], v[56:59], v[20:23]
  s_add_u32 s37, s73, 15
  s_and_b32 s37, s37, 15
  s_lshl_b32 s38, s37, 18
  s_lshl_b32 s37, s37, 6
  s_add_u32 m0, s67, 98304
  s_add_u32 s60, s66, s37
  buffer_load_dwordx4 v240, s[12:15], s60 offen lds
  v_mfma_f32_16x16x32_bf16 v[4:7], v[40:43], v[60:63], v[4:7]
  v_mfma_f32_16x16x32_bf16 v[24:27], v[44:47], v[60:63], v[24:27]
  s_add_u32 m0, s67, 102400
  s_add_u32 s60, s60, 65536
  buffer_load_dwordx4 v240, s[12:15], s60 offen lds
  v_mfma_f32_16x16x32_bf16 v[8:11], v[40:43], v[64:67], v[8:11]
  v_mfma_f32_16x16x32_bf16 v[28:31], v[44:47], v[64:67], v[28:31]
  s_mov_b32 m0, 106496
  s_add_u32 s60, s37, 131072
  s_mov_b64 exec, s[68:69]
  buffer_load_dwordx4 v240, s[12:15], s60 offen lds
  s_mov_b64 exec, -1
  v_mfma_f32_16x16x32_bf16 v[12:15], v[40:43], v[68:71], v[12:15]
  v_mfma_f32_16x16x32_bf16 v[32:35], v[44:47], v[68:71], v[32:35]
  v_mfma_f32_16x16x32_bf16 v[16:19], v[40:43], v[72:75], v[16:19]
  v_mfma_f32_16x16x32_bf16 v[36:39], v[44:47], v[72:75], v[36:39]
  s_waitcnt vmcnt(3)
  s_waitcnt lgkmcnt(0)
  s_barrier
  ds_read_b64_tr_b16 v[40:41], v243 offset:44032
  ds_read_b64_tr_b16 v[42:43], v243 offset:45056
  ds_read_b64_tr_b16 v[44:45], v243 offset:44040
  ds_read_b64_tr_b16 v[46:47], v243 offset:45064
  ds_read_b128 v[56:59], v245 offset:34816
  ds_read_b128 v[60:63], v245 offset:35840
  ds_read_b128 v[64:67], v245 offset:36864
  ds_read_b128 v[68:71], v245 offset:37888
  ds_read_b128 v[72:75], v245 offset:38912
  v_mfma_f32_16x16x32_bf16 v[0:3], v[48:51], v[76:79], v[0:3]
  v_mfma_f32_16x16x32_bf16 v[20:23], v[52:55], v[76:79], v[20:23]
  v_mfma_f32_16x16x32_bf16 v[4:7], v[48:51], v[80:83], v[4:7]
  v_mfma_f32_16x16x32_bf16 v[24:27], v[52:55], v[80:83], v[24:27]
  v_mfma_f32_16x16x32_bf16 v[8:11], v[48:51], v[84:87], v[8:11]
  v_mfma_f32_16x16x32_bf16 v[28:31], v[52:55], v[84:87], v[28:31]
  v_mfma_f32_16x16x32_bf16 v[12:15], v[48:51], v[88:91], v[12:15]
  v_mfma_f32_16x16x32_bf16 v[32:35], v[52:55], v[88:91], v[32:35]
  v_mfma_f32_16x16x32_bf16 v[16:19], v[48:51], v[92:95], v[16:19]
  v_mfma_f32_16x16x32_bf16 v[36:39], v[52:55], v[92:95], v[36:39]
  s_waitcnt vmcnt(0)
  s_waitcnt lgkmcnt(0)
  s_barrier
  ds_read_b64_tr_b16 v[48:49], v243 offset:9216
  ds_read_b64_tr_b16 v[50:51], v243 offset:10240
  ds_read_b64_tr_b16 v[52:53], v243 offset:9224
  ds_read_b64_tr_b16 v[54:55], v243 offset:10248
  ds_read_b128 v[76:79], v245 offset:0
  ds_read_b128 v[80:83], v245 offset:1024
  ds_read_b128 v[84:87], v245 offset:2048
  ds_read_b128 v[88:91], v245 offset:3072
  ds_read_b128 v[92:95], v245 offset:4096
  v_mfma_f32_16x16x32_bf16 v[0:3], v[40:43], v[56:59], v[0:3]
  v_mfma_f32_16x16x32_bf16 v[20:23], v[44:47], v[56:59], v[20:23]
  v_mfma_f32_16x16x32_bf16 v[4:7], v[40:43], v[60:63], v[4:7]
  v_mfma_f32_16x16x32_bf16 v[24:27], v[44:47], v[60:63], v[24:27]
  v_mfma_f32_16x16x32_bf16 v[8:11], v[40:43], v[64:67], v[8:11]
  v_mfma_f32_16x16x32_bf16 v[28:31], v[44:47], v[64:67], v[28:31]
  v_mfma_f32_16x16x32_bf16 v[12:15], v[40:43], v[68:71], v[12:15]
  v_mfma_f32_16x16x32_bf16 v[32:35], v[44:47], v[68:71], v[32:35]
  v_mfma_f32_16x16x32_bf16 v[16:19], v[40:43], v[72:75], v[16:19]
  v_mfma_f32_16x16x32_bf16 v[36:39], v[44:47], v[72:75], v[36:39]
  s_waitcnt lgkmcnt(0)
  v_mfma_f32_16x16x32_bf16 v[0:3], v[48:51], v[76:79], v[0:3]
  v_mfma_f32_16x16x32_bf16 v[20:23], v[52:55], v[76:79], v[20:23]
  v_mfma_f32_16x16x32_bf16 v[4:7], v[48:51], v[80:83], v[4:7]
  v_mfma_f32_16x16x32_bf16 v[24:27], v[52:55], v[80:83], v[24:27]
  v_mfma_f32_16x16x32_bf16 v[8:11], v[48:51], v[84:87], v[8:11]
  v_mfma_f32_16x16x32_bf16 v[28:31], v[52:55], v[84:87], v[28:31]
  v_mfma_f32_16x16x32_bf16 v[12:15], v[48:51], v[88:91], v[12:15]
  v_mfma_f32_16x16x32_bf16 v[32:35], v[52:55], v[88:91], v[32:35]
  v_mfma_f32_16x16x32_bf16 v[16:19], v[48:51], v[92:95], v[16:19]
  v_mfma_f32_16x16x32_bf16 v[36:39], v[52:55], v[92:95], v[36:39]
  s_barrier
  s_and_b32 s60, s3, 3
  s_lshl_b32 s60, s60, 10
  s_add_u32 s60, s60, 98304
  v_add_u32 v245, s60, v242
  v_mul_f32 v0, s65, v0
  v_mul_f32 v1, s65, v1
  v_mul_f32 v2, s65, v2
  v_mul_f32 v3, s65, v3
  v_mul_f32 v20, s65, v20
  v_mul_f32 v21, s65, v21
  v_mul_f32 v22, s65, v22
  v_mul_f32 v23, s65, v23
  v_cvt_pk_bf16_f32 v40, v0, v1
  v_cvt_pk_bf16_f32 v41, v2, v3
  v_cvt_pk_bf16_f32 v42, v20, v21
  v_cvt_pk_bf16_f32 v43, v22, v23
  ds_write_b128 v245, v[40:43] offset:0
  v_mul_f32 v4, s65, v4
  v_mul_f32 v5, s65, v5
  v_mul_f32 v6, s65, v6
  v_mul_f32 v7, s65, v7
  v_mul_f32 v24, s65, v24
  v_mul_f32 v25, s65, v25
  v_mul_f32 v26, s65, v26
  v_mul_f32 v27, s65, v27
  v_cvt_pk_bf16_f32 v44, v4, v5
  v_cvt_pk_bf16_f32 v45, v6, v7
  v_cvt_pk_bf16_f32 v46, v24, v25
  v_cvt_pk_bf16_f32 v47, v26, v27
  ds_write_b128 v245, v[44:47] offset:4096
  v_mul_f32 v8, s65, v8
  v_mul_f32 v9, s65, v9
  v_mul_f32 v10, s65, v10
  v_mul_f32 v11, s65, v11
  v_mul_f32 v28, s65, v28
  v_mul_f32 v29, s65, v29
  v_mul_f32 v30, s65, v30
  v_mul_f32 v31, s65, v31
  v_cvt_pk_bf16_f32 v48, v8, v9
  v_cvt_pk_bf16_f32 v49, v10, v11
  v_cvt_pk_bf16_f32 v50, v28, v29
  v_cvt_pk_bf16_f32 v51, v30, v31
  ds_write_b128 v245, v[48:51] offset:8192
  v_mul_f32 v12, s65, v12
  v_mul_f32 v13, s65, v13
  v_mul_f32 v14, s65, v14
  v_mul_f32 v15, s65, v15
  v_mul_f32 v32, s65, v32
  v_mul_f32 v33, s65, v33
  v_mul_f32 v34, s65, v34
  v_mul_f32 v35, s65, v35
  v_cvt_pk_bf16_f32 v52, v12, v13
  v_cvt_pk_bf16_f32 v53, v14, v15
  v_cvt_pk_bf16_f32 v54, v32, v33
  v_cvt_pk_bf16_f32 v55, v34, v35
  ds_write_b128 v245, v[52:55] offset:12288
  v_mul_f32 v16, s65, v16
  v_mul_f32 v17, s65, v17
  v_mul_f32 v18, s65, v18
  v_mul_f32 v19, s65, v19
  v_mul_f32 v36, s65, v36
  v_mul_f32 v37, s65, v37
  v_mul_f32 v38, s65, v38
  v_mul_f32 v39, s65, v39
  v_cvt_pk_bf16_f32 v56, v16, v17
  v_cvt_pk_bf16_f32 v57, v18, v19
  v_cvt_pk_bf16_f32 v58, v36, v37
  v_cvt_pk_bf16_f32 v59, v38, v39
  ds_write_b128 v245, v[56:59] offset:16384
  s_waitcnt lgkmcnt(0)
  s_barrier
  s_cmp_lg_u32 s58, s24
  s_cbranch_scc1 INIT_A
  s_lshl_b32 s60, s35, 12
  s_add_u32 s60, s60, 98304
  v_add_u32 v245, s60, v242
  ds_read_b128 v[108:111], v245 offset:0
  ds_read_b128 v[112:115], v245 offset:1024
  ds_read_b128 v[116:119], v245 offset:2048
  ds_read_b128 v[120:123], v245 offset:3072
  ds_read_b128 v[124:127], v245 offset:4096
  ds_read_b128 v[128:131], v245 offset:5120
  ds_read_b128 v[132:135], v245 offset:6144
  ds_read_b128 v[136:139], v245 offset:7168
  ds_read_b128 v[140:143], v245 offset:8192
  ds_read_b128 v[144:147], v245 offset:9216
  ds_read_b128 v[148:151], v245 offset:10240
  ds_read_b128 v[152:155], v245 offset:11264
  s_cmp_eq_u32 s26, 0
  s_cbranch_scc1 INIT_A
  s_waitcnt lgkmcnt(0)
  s_barrier
  s_mov_b32 s58, 1
  s_branch QP_A
INIT_A:
  v_mov_b32 v0, 0
  v_mov_b32 v1, 0
  v_mov_b32 v2, 0
  v_mov_b32 v3, 0
  v_mov_b32 v4, 0
  v_mov_b32 v5, 0
  v_mov_b32 v6, 0
  v_mov_b32 v7, 0
  v_mov_b32 v8, 0
  v_mov_b32 v9, 0
  v_mov_b32 v10, 0
  v_mov_b32 v11, 0
  v_mov_b32 v12, 0
  v_mov_b32 v13, 0
  v_mov_b32 v14, 0
  v_mov_b32 v15, 0
  v_mov_b32 v16, 0
  v_mov_b32 v17, 0
  v_mov_b32 v18, 0
  v_mov_b32 v19, 0
  v_mov_b32 v20, 0
  v_mov_b32 v21, 0
  v_mov_b32 v22, 0
  v_mov_b32 v23, 0
  v_mov_b32 v24, 0
  v_mov_b32 v25, 0
  v_mov_b32 v26, 0
  v_mov_b32 v27, 0
  v_mov_b32 v28, 0
  v_mov_b32 v29, 0
  v_mov_b32 v30, 0
  v_mov_b32 v31, 0
  v_mov_b32 v32, 0
  v_mov_b32 v33, 0
  v_mov_b32 v34, 0
  v_mov_b32 v35, 0
  v_mov_b32 v36, 0
  v_mov_b32 v37, 0
  v_mov_b32 v38, 0
  v_mov_b32 v39, 0
  v_mov_b32 v40, 0
  v_mov_b32 v41, 0
  v_mov_b32 v42, 0
  v_mov_b32 v43, 0
  v_mov_b32 v44, 0
  v_mov_b32 v45, 0
  v_mov_b32 v46, 0
  v_mov_b32 v47, 0
  v_mov_b32 v48, 0
  v_mov_b32 v49, 0
  v_mov_b32 v50, 0
  v_mov_b32 v51, 0
  v_mov_b32 v52, 0
  v_mov_b32 v53, 0
  v_mov_b32 v54, 0
  v_mov_b32 v55, 0
  v_mov_b32 v56, 0
  v_mov_b32 v57, 0
  v_mov_b32 v58, 0
  v_mov_b32 v59, 0
  v_mov_b32 v60, 0
  v_mov_b32 v61, 0
  v_mov_b32 v62, 0
  v_mov_b32 v63, 0
  v_mov_b32 v64, 0
  v_mov_b32 v65, 0
  v_mov_b32 v66, 0
  v_mov_b32 v67, 0
  v_mov_b32 v68, 0
  v_mov_b32 v69, 0
  v_mov_b32 v70, 0
  v_mov_b32 v71, 0
  v_mov_b32 v72, 0
  v_mov_b32 v73, 0
  v_mov_b32 v74, 0
  v_mov_b32 v75, 0
  v_mov_b32 v76, 0
  v_mov_b32 v77, 0
  v_mov_b32 v78, 0
  v_mov_b32 v79, 0
  v_mov_b32 v80, 0
  v_mov_b32 v81, 0
  v_mov_b32 v82, 0
  v_mov_b32 v83, 0
  v_mov_b32 v84, 0
  v_mov_b32 v85, 0
  v_mov_b32 v86, 0
  v_mov_b32 v87, 0
  v_mov_b32 v88, 0
  v_mov_b32 v89, 0
  v_mov_b32 v90, 0
  v_mov_b32 v91, 0
  v_mov_b32 v92, 0
  v_mov_b32 v93, 0
  v_mov_b32 v94, 0
  v_mov_b32 v95, 0
  v_mov_b32 v96, 0
  v_mov_b32 v180, 0
  v_mov_b32 v97, 0
  v_mov_b32 v181, 0
  v_mov_b32 v98, 0
  v_mov_b32 v182, 0
  v_mov_b32 v99, 0
  v_mov_b32 v183, 0
  v_mov_b32 v100, 0
  v_mov_b32 v184, 0
  v_mov_b32 v101, 0
  v_mov_b32 v185, 0
  v_mov_b32 v102, 0
  v_mov_b32 v186, 0
  v_mov_b32 v103, 0
  v_mov_b32 v187, 0
  v_mov_b32 v104, 0
  v_mov_b32 v188, 0
  v_mov_b32 v105, 0
  v_mov_b32 v189, 0
  v_mov_b32 v106, 0
  v_mov_b32 v190, 0
  v_mov_b32 v107, 0
  v_mov_b32 v191, 0
  s_waitcnt lgkmcnt(0)
  s_barrier
  ds_read_b128 v[192:195], v224 offset:0
  ds_read_b128 v[196:199], v225 offset:0
  ds_read_b128 v[200:203], v226 offset:0
  ds_read_b128 v[204:207], v227 offset:0
  ds_read_b128 v[208:211], v224 offset:4096
  ds_read_b128 v[212:215], v225 offset:4096
  ds_read_b128 v[216:219], v226 offset:4096
  ds_read_b128 v[220:223], v227 offset:4096
  s_waitcnt lgkmcnt(7)
  v_mfma_f32_16x16x32_bf16 v[156:159], v[192:195], v[108:111], v[180:183]
  v_mfma_f32_16x16x32_bf16 v[164:167], v[192:195], v[124:127], v[184:187]
  v_mfma_f32_16x16x32_bf16 v[172:175], v[192:195], v[140:143], v[188:191]
  s_waitcnt lgkmcnt(6)
  v_mfma_f32_16x16x32_bf16 v[156:159], v[196:199], v[112:115], v[156:159]
  v_mfma_f32_16x16x32_bf16 v[164:167], v[196:199], v[128:131], v[164:167]
  v_mfma_f32_16x16x32_bf16 v[172:175], v[196:199], v[144:147], v[172:175]
  ds_read_b64_tr_b16 v[192:193], v228 offset:0
  ds_read_b64_tr_b16 v[194:195], v228 offset:4096
  s_waitcnt lgkmcnt(7)
  v_mfma_f32_16x16x32_bf16 v[156:159], v[200:203], v[116:119], v[156:159]
  v_mfma_f32_16x16x32_bf16 v[164:167], v[200:203], v[132:135], v[164:167]
  v_mfma_f32_16x16x32_bf16 v[172:175], v[200:203], v[148:151], v[172:175]
  ds_read_b64_tr_b16 v[196:197], v229 offset:0
  ds_read_b64_tr_b16 v[198:199], v229 offset:4096
  s_waitcnt lgkmcnt(8)
  v_mfma_f32_16x16x32_bf16 v[156:159], v[204:207], v[120:123], v[156:159]
  v_mfma_f32_16x16x32_bf16 v[164:167], v[204:207], v[136:139], v[164:167]
  v_mfma_f32_16x16x32_bf16 v[172:175], v[204:207], v[152:155], v[172:175]
  ds_read_b64_tr_b16 v[200:201], v230 offset:0
  ds_read_b64_tr_b16 v[202:203], v230 offset:4096
  s_waitcnt lgkmcnt(9)
  v_mfma_f32_16x16x32_bf16 v[160:163], v[208:211], v[108:111], v[180:183]
  v_mfma_f32_16x16x32_bf16 v[168:171], v[208:211], v[124:127], v[184:187]
  v_mfma_f32_16x16x32_bf16 v[176:179], v[208:211], v[140:143], v[188:191]
  ds_read_b64_tr_b16 v[204:205], v231 offset:0
  ds_read_b64_tr_b16 v[206:207], v231 offset:4096
  s_waitcnt lgkmcnt(10)
  v_mfma_f32_16x16x32_bf16 v[160:163], v[212:215], v[112:115], v[160:163]
  v_mfma_f32_16x16x32_bf16 v[168:171], v[212:215], v[128:131], v[168:171]
  v_mfma_f32_16x16x32_bf16 v[176:179], v[212:215], v[144:147], v[176:179]
  ds_read_b64_tr_b16 v[208:209], v232 offset:0
  ds_read_b64_tr_b16 v[210:211], v232 offset:4096
  s_waitcnt lgkmcnt(11)
  v_mfma_f32_16x16x32_bf16 v[160:163], v[216:219], v[116:119], v[160:163]
  v_mfma_f32_16x16x32_bf16 v[168:171], v[216:219], v[132:135], v[168:171]
  v_mfma_f32_16x16x32_bf16 v[176:179], v[216:219], v[148:151], v[176:179]
  ds_read_b64_tr_b16 v[212:213], v233 offset:0
  ds_read_b64_tr_b16 v[214:215], v233 offset:4096
  s_waitcnt lgkmcnt(12)
  v_mfma_f32_16x16x32_bf16 v[160:163], v[220:223], v[120:123], v[160:163]
  v_mfma_f32_16x16x32_bf16 v[168:171], v[220:223], v[136:139], v[168:171]
  v_mfma_f32_16x16x32_bf16 v[176:179], v[220:223], v[152:155], v[176:179]
  ds_read_b64_tr_b16 v[216:217], v234 offset:0
  ds_read_b64_tr_b16 v[218:219], v234 offset:4096
  s_add_u32 s31, s31, 1
  s_cmp_eq_u32 s31, 4
  s_cselect_b32 s31, 0, s31
  s_mov_b32 s30, 32768
  s_cselect_b32 s30, 0xfffe8000, s30
  v_add_u32 v224, s30, v224
  v_add_u32 v225, s30, v225
  v_add_u32 v226, s30, v226
  v_add_u32 v227, s30, v227
  ds_read_b64_tr_b16 v[220:221], v235 offset:0
  ds_read_b64_tr_b16 v[222:223], v235 offset:4096
  v_xor_b32 v245, 16, v244
  v_lshlrev_b32 v245, 2, v245
  v_xor_b32 v246, 32, v244
  v_lshlrev_b32 v246, 2, v246
  v_max3_f32 v247, v156, v157, v158
  v_max3_f32 v247, v247, v159, v160
  v_max3_f32 v247, v247, v161, v162
  v_max_f32 v247, v247, v163
  ds_bpermute_b32 v252, v245, v247
  s_waitcnt lgkmcnt(0)
  v_max_f32 v247, v247, v252
  ds_bpermute_b32 v252, v246, v247
  s_waitcnt lgkmcnt(0)
  v_max_f32 v247, v247, v252
  v_sub_f32 v156, v156, v247
  v_sub_f32 v157, v157, v247
  v_sub_f32 v158, v158, v247
  v_sub_f32 v159, v159, v247
  v_sub_f32 v160, v160, v247
  v_sub_f32 v161, v161, v247
  v_sub_f32 v162, v162, v247
  v_sub_f32 v163, v163, v247
  v_sub_f32 v180, v180, v247
  v_sub_f32 v181, v181, v247
  v_sub_f32 v182, v182, v247
  v_sub_f32 v183, v183, v247
  v_max3_f32 v248, v164, v165, v166
  v_max3_f32 v248, v248, v167, v168
  v_max3_f32 v248, v248, v169, v170
  v_max_f32 v248, v248, v171
  ds_bpermute_b32 v252, v245, v248
  s_waitcnt lgkmcnt(0)
  v_max_f32 v248, v248, v252
  ds_bpermute_b32 v252, v246, v248
  s_waitcnt lgkmcnt(0)
  v_max_f32 v248, v248, v252
  v_sub_f32 v164, v164, v248
  v_sub_f32 v165, v165, v248
  v_sub_f32 v166, v166, v248
  v_sub_f32 v167, v167, v248
  v_sub_f32 v168, v168, v248
  v_sub_f32 v169, v169, v248
  v_sub_f32 v170, v170, v248
  v_sub_f32 v171, v171, v248
  v_sub_f32 v184, v184, v248
  v_sub_f32 v185, v185, v248
  v_sub_f32 v186, v186, v248
  v_sub_f32 v187, v187, v248
  v_max3_f32 v249, v172, v173, v174
  v_max3_f32 v249, v249, v175, v176
  v_max3_f32 v249, v249, v177, v178
  v_max_f32 v249, v249, v179
  ds_bpermute_b32 v252, v245, v249
  s_waitcnt lgkmcnt(0)
  v_max_f32 v249, v249, v252
  ds_bpermute_b32 v252, v246, v249
  s_waitcnt lgkmcnt(0)
  v_max_f32 v249, v249, v252
  v_sub_f32 v172, v172, v249
  v_sub_f32 v173, v173, v249
  v_sub_f32 v174, v174, v249
  v_sub_f32 v175, v175, v249
  v_sub_f32 v176, v176, v249
  v_sub_f32 v177, v177, v249
  v_sub_f32 v178, v178, v249
  v_sub_f32 v179, v179, v249
  v_sub_f32 v188, v188, v249
  v_sub_f32 v189, v189, v249
  v_sub_f32 v190, v190, v249
  v_sub_f32 v191, v191, v249
  v_exp_f32 v156, v156
  v_exp_f32 v157, v157
  v_exp_f32 v158, v158
  v_exp_f32 v159, v159
  v_exp_f32 v160, v160
  v_exp_f32 v161, v161
  v_exp_f32 v162, v162
  v_exp_f32 v163, v163
  v_cvt_pk_bf16_f32 v156, v156, v157
  v_cvt_pk_bf16_f32 v157, v158, v159
  v_cvt_pk_bf16_f32 v158, v160, v161
  v_cvt_pk_bf16_f32 v159, v162, v163
  v_exp_f32 v164, v164
  v_exp_f32 v165, v165
  v_exp_f32 v166, v166
  v_exp_f32 v167, v167
  v_exp_f32 v168, v168
  v_exp_f32 v169, v169
  v_exp_f32 v170, v170
  v_exp_f32 v171, v171
  v_cvt_pk_bf16_f32 v164, v164, v165
  v_cvt_pk_bf16_f32 v165, v166, v167
  v_cvt_pk_bf16_f32 v166, v168, v169
  v_cvt_pk_bf16_f32 v167, v170, v171
  v_exp_f32 v172, v172
  v_exp_f32 v173, v173
  v_exp_f32 v174, v174
  v_exp_f32 v175, v175
  v_exp_f32 v176, v176
  v_exp_f32 v177, v177
  v_exp_f32 v178, v178
  v_exp_f32 v179, v179
  v_cvt_pk_bf16_f32 v172, v172, v173
  v_cvt_pk_bf16_f32 v173, v174, v175
  v_cvt_pk_bf16_f32 v174, v176, v177
  v_cvt_pk_bf16_f32 v175, v178, v179
  s_waitcnt lgkmcnt(14)
  v_mfma_f32_16x16x32_bf16 v[0:3], v[192:195], v[156:159], v[0:3]
  v_mfma_f32_16x16x32_bf16 v[4:7], v[192:195], v[164:167], v[4:7]
  v_mfma_f32_16x16x32_bf16 v[8:11], v[192:195], v[172:175], v[8:11]
  v_mfma_f32_16x16x32_bf16 v[96:99], v[236:239], v[156:159], v[96:99]
  v_mfma_f32_16x16x32_bf16 v[100:103], v[236:239], v[164:167], v[100:103]
  v_mfma_f32_16x16x32_bf16 v[104:107], v[236:239], v[172:175], v[104:107]
  s_waitcnt lgkmcnt(12)
  v_mfma_f32_16x16x32_bf16 v[12:15], v[196:199], v[156:159], v[12:15]
  v_mfma_f32_16x16x32_bf16 v[16:19], v[196:199], v[164:167], v[16:19]
  v_mfma_f32_16x16x32_bf16 v[20:23], v[196:199], v[172:175], v[20:23]
  s_waitcnt lgkmcnt(10)
  v_mfma_f32_16x16x32_bf16 v[24:27], v[200:203], v[156:159], v[24:27]
  v_mfma_f32_16x16x32_bf16 v[28:31], v[200:203], v[164:167], v[28:31]
  v_mfma_f32_16x16x32_bf16 v[32:35], v[200:203], v[172:175], v[32:35]
  s_waitcnt lgkmcnt(8)
  v_mfma_f32_16x16x32_bf16 v[36:39], v[204:207], v[156:159], v[36:39]
  v_mfma_f32_16x16x32_bf16 v[40:43], v[204:207], v[164:167], v[40:43]
  v_mfma_f32_16x16x32_bf16 v[44:47], v[204:207], v[172:175], v[44:47]
  s_waitcnt lgkmcnt(6)
  v_mfma_f32_16x16x32_bf16 v[48:51], v[208:211], v[156:159], v[48:51]
  v_mfma_f32_16x16x32_bf16 v[52:55], v[208:211], v[164:167], v[52:55]
  v_mfma_f32_16x16x32_bf16 v[56:59], v[208:211], v[172:175], v[56:59]
  s_waitcnt lgkmcnt(4)
  v_mfma_f32_16x16x32_bf16 v[60:63], v[212:215], v[156:159], v[60:63]
  v_mfma_f32_16x16x32_bf16 v[64:67], v[212:215], v[164:167], v[64:67]
  v_mfma_f32_16x16x32_bf16 v[68:71], v[212:215], v[172:175], v[68:71]
  s_waitcnt lgkmcnt(2)
  v_mfma_f32_16x16x32_bf16 v[72:75], v[216:219], v[156:159], v[72:75]
  v_mfma_f32_16x16x32_bf16 v[76:79], v[216:219], v[164:167], v[76:79]
  v_mfma_f32_16x16x32_bf16 v[80:83], v[216:219], v[172:175], v[80:83]
  s_waitcnt lgkmcnt(0)
  v_mfma_f32_16x16x32_bf16 v[84:87], v[220:223], v[156:159], v[84:87]
  v_mfma_f32_16x16x32_bf16 v[88:91], v[220:223], v[164:167], v[88:91]
  v_mfma_f32_16x16x32_bf16 v[92:95], v[220:223], v[172:175], v[92:95]
  v_add_u32 v228, s30, v228
  v_add_u32 v229, s30, v229
  v_add_u32 v230, s30, v230
  v_add_u32 v231, s30, v231
  v_add_u32 v232, s30, v232
  v_add_u32 v233, s30, v233
  v_add_u32 v234, s30, v234
  v_add_u32 v235, s30, v235
  s_mov_b32 s25, 1
LOOP_A:
  s_waitcnt lgkmcnt(0)
  s_barrier
  ds_read_b128 v[192:195], v224 offset:0
  ds_read_b128 v[196:199], v225 offset:0
  ds_read_b128 v[200:203], v226 offset:0
  ds_read_b128 v[204:207], v227 offset:0
  ds_read_b128 v[208:211], v224 offset:4096
  ds_read_b128 v[212:215], v225 offset:4096
  ds_read_b128 v[216:219], v226 offset:4096
  ds_read_b128 v[220:223], v227 offset:4096
  s_waitcnt lgkmcnt(7)
  v_mfma_f32_16x16x32_bf16 v[156:159], v[192:195], v[108:111], v[180:183]
  v_mfma_f32_16x16x32_bf16 v[164:167], v[192:195], v[124:127], v[184:187]
  v_mfma_f32_16x16x32_bf16 v[172:175], v[192:195], v[140:143], v[188:191]
  s_waitcnt lgkmcnt(6)
  v_mfma_f32_16x16x32_bf16 v[156:159], v[196:199], v[112:115], v[156:159]
  v_mfma_f32_16x16x32_bf16 v[164:167], v[196:199], v[128:131], v[164:167]
  v_mfma_f32_16x16x32_bf16 v[172:175], v[196:199], v[144:147], v[172:175]
  ds_read_b64_tr_b16 v[192:193], v228 offset:0
  ds_read_b64_tr_b16 v[194:195], v228 offset:4096
  s_waitcnt lgkmcnt(7)
  v_mfma_f32_16x16x32_bf16 v[156:159], v[200:203], v[116:119], v[156:159]
  v_mfma_f32_16x16x32_bf16 v[164:167], v[200:203], v[132:135], v[164:167]
  v_mfma_f32_16x16x32_bf16 v[172:175], v[200:203], v[148:151], v[172:175]
  ds_read_b64_tr_b16 v[196:197], v229 offset:0
  ds_read_b64_tr_b16 v[198:199], v229 offset:4096
  s_waitcnt lgkmcnt(8)
  v_mfma_f32_16x16x32_bf16 v[156:159], v[204:207], v[120:123], v[156:159]
  v_mfma_f32_16x16x32_bf16 v[164:167], v[204:207], v[136:139], v[164:167]
  v_mfma_f32_16x16x32_bf16 v[172:175], v[204:207], v[152:155], v[172:175]
  ds_read_b64_tr_b16 v[200:201], v230 offset:0
  ds_read_b64_tr_b16 v[202:203], v230 offset:4096
  s_waitcnt lgkmcnt(9)
  v_mfma_f32_16x16x32_bf16 v[160:163], v[208:211], v[108:111], v[180:183]
  v_mfma_f32_16x16x32_bf16 v[168:171], v[208:211], v[124:127], v[184:187]
  v_mfma_f32_16x16x32_bf16 v[176:179], v[208:211], v[140:143], v[188:191]
  ds_read_b64_tr_b16 v[204:205], v231 offset:0
  ds_read_b64_tr_b16 v[206:207], v231 offset:4096
  s_waitcnt lgkmcnt(10)
  v_mfma_f32_16x16x32_bf16 v[160:163], v[212:215], v[112:115], v[160:163]
  v_mfma_f32_16x16x32_bf16 v[168:171], v[212:215], v[128:131], v[168:171]
  v_mfma_f32_16x16x32_bf16 v[176:179], v[212:215], v[144:147], v[176:179]
  ds_read_b64_tr_b16 v[208:209], v232 offset:0
  ds_read_b64_tr_b16 v[210:211], v232 offset:4096
  s_waitcnt lgkmcnt(11)
  v_mfma_f32_16x16x32_bf16 v[160:163], v[216:219], v[116:119], v[160:163]
  v_mfma_f32_16x16x32_bf16 v[168:171], v[216:219], v[132:135], v[168:171]
  v_mfma_f32_16x16x32_bf16 v[176:179], v[216:219], v[148:151], v[176:179]
  ds_read_b64_tr_b16 v[212:213], v233 offset:0
  ds_read_b64_tr_b16 v[214:215], v233 offset:4096
  s_waitcnt lgkmcnt(12)
  v_mfma_f32_16x16x32_bf16 v[160:163], v[220:223], v[120:123], v[160:163]
  v_mfma_f32_16x16x32_bf16 v[168:171], v[220:223], v[136:139], v[168:171]
  v_mfma_f32_16x16x32_bf16 v[176:179], v[220:223], v[152:155], v[176:179]
  ds_read_b64_tr_b16 v[216:217], v234 offset:0
  ds_read_b64_tr_b16 v[218:219], v234 offset:4096
  s_add_u32 s31, s31, 1
  s_cmp_eq_u32 s31, 4
  s_cselect_b32 s31, 0, s31
  s_mov_b32 s30, 32768
  s_cselect_b32 s30, 0xfffe8000, s30
  v_add_u32 v224, s30, v224
  v_add_u32 v225, s30, v225
  v_add_u32 v226, s30, v226
  v_add_u32 v227, s30, v227
  v_max3_f32 v252, v156, v157, v158
  v_max3_f32 v252, v252, v159, v164
  v_max3_f32 v252, v252, v165, v166
  v_max3_f32 v252, v252, v167, v172
  v_max3_f32 v252, v252, v173, v174
  v_max3_f32 v252, v252, v175, v160
  v_max3_f32 v252, v252, v161, v162
  v_max3_f32 v252, v252, v163, v168
  v_max3_f32 v252, v252, v169, v170
  v_max3_f32 v252, v252, v171, v176
  v_max3_f32 v252, v252, v177, v178
  v_max_f32 v252, v252, v179
  v_cmp_lt_f32 vcc, s64, v252
  ds_read_b64_tr_b16 v[220:221], v235 offset:0
  ds_read_b64_tr_b16 v[222:223], v235 offset:4096
  s_nop 2
  s_cbranch_vccnz SLOW_A
BACK_A:
  v_exp_f32 v156, v156
  v_exp_f32 v157, v157
  v_exp_f32 v158, v158
  v_exp_f32 v159, v159
  v_exp_f32 v160, v160
  v_exp_f32 v161, v161
  v_exp_f32 v162, v162
  v_exp_f32 v163, v163
  v_cvt_pk_bf16_f32 v156, v156, v157
  v_cvt_pk_bf16_f32 v157, v158, v159
  v_cvt_pk_bf16_f32 v158, v160, v161
  v_cvt_pk_bf16_f32 v159, v162, v163
  v_exp_f32 v164, v164
  v_exp_f32 v165, v165
  v_exp_f32 v166, v166
  v_exp_f32 v167, v167
  v_exp_f32 v168, v168
  v_exp_f32 v169, v169
  v_exp_f32 v170, v170
  v_exp_f32 v171, v171
  v_cvt_pk_bf16_f32 v164, v164, v165
  v_cvt_pk_bf16_f32 v165, v166, v167
  v_cvt_pk_bf16_f32 v166, v168, v169
  v_cvt_pk_bf16_f32 v167, v170, v171
  v_exp_f32 v172, v172
  v_exp_f32 v173, v173
  v_exp_f32 v174, v174
  v_exp_f32 v175, v175
  v_exp_f32 v176, v176
  v_exp_f32 v177, v177
  v_exp_f32 v178, v178
  v_exp_f32 v179, v179
  v_cvt_pk_bf16_f32 v172, v172, v173
  v_cvt_pk_bf16_f32 v173, v174, v175
  v_cvt_pk_bf16_f32 v174, v176, v177
  v_cvt_pk_bf16_f32 v175, v178, v179
  s_waitcnt lgkmcnt(14)
  v_mfma_f32_16x16x32_bf16 v[0:3], v[192:195], v[156:159], v[0:3]
  v_mfma_f32_16x16x32_bf16 v[4:7], v[192:195], v[164:167], v[4:7]
  v_mfma_f32_16x16x32_bf16 v[8:11], v[192:195], v[172:175], v[8:11]
  v_mfma_f32_16x16x32_bf16 v[96:99], v[236:239], v[156:159], v[96:99]
  v_mfma_f32_16x16x32_bf16 v[100:103], v[236:239], v[164:167], v[100:103]
  v_mfma_f32_16x16x32_bf16 v[104:107], v[236:239], v[172:175], v[104:107]
  s_waitcnt lgkmcnt(12)
  v_mfma_f32_16x16x32_bf16 v[12:15], v[196:199], v[156:159], v[12:15]
  v_mfma_f32_16x16x32_bf16 v[16:19], v[196:199], v[164:167], v[16:19]
  v_mfma_f32_16x16x32_bf16 v[20:23], v[196:199], v[172:175], v[20:23]
  s_waitcnt lgkmcnt(10)
  v_mfma_f32_16x16x32_bf16 v[24:27], v[200:203], v[156:159], v[24:27]
  v_mfma_f32_16x16x32_bf16 v[28:31], v[200:203], v[164:167], v[28:31]
  v_mfma_f32_16x16x32_bf16 v[32:35], v[200:203], v[172:175], v[32:35]
  s_waitcnt lgkmcnt(8)
  v_mfma_f32_16x16x32_bf16 v[36:39], v[204:207], v[156:159], v[36:39]
  v_mfma_f32_16x16x32_bf16 v[40:43], v[204:207], v[164:167], v[40:43]
  v_mfma_f32_16x16x32_bf16 v[44:47], v[204:207], v[172:175], v[44:47]
  s_waitcnt lgkmcnt(6)
  v_mfma_f32_16x16x32_bf16 v[48:51], v[208:211], v[156:159], v[48:51]
  v_mfma_f32_16x16x32_bf16 v[52:55], v[208:211], v[164:167], v[52:55]
  v_mfma_f32_16x16x32_bf16 v[56:59], v[208:211], v[172:175], v[56:59]
  s_waitcnt lgkmcnt(4)
  v_mfma_f32_16x16x32_bf16 v[60:63], v[212:215], v[156:159], v[60:63]
  v_mfma_f32_16x16x32_bf16 v[64:67], v[212:215], v[164:167], v[64:67]
  v_mfma_f32_16x16x32_bf16 v[68:71], v[212:215], v[172:175], v[68:71]
  s_waitcnt lgkmcnt(2)
  v_mfma_f32_16x16x32_bf16 v[72:75], v[216:219], v[156:159], v[72:75]
  v_mfma_f32_16x16x32_bf16 v[76:79], v[216:219], v[164:167], v[76:79]
  v_mfma_f32_16x16x32_bf16 v[80:83], v[216:219], v[172:175], v[80:83]
  s_waitcnt lgkmcnt(0)
  v_mfma_f32_16x16x32_bf16 v[84:87], v[220:223], v[156:159], v[84:87]
  v_mfma_f32_16x16x32_bf16 v[88:91], v[220:223], v[164:167], v[88:91]
  v_mfma_f32_16x16x32_bf16 v[92:95], v[220:223], v[172:175], v[92:95]
  v_add_u32 v228, s30, v228
  v_add_u32 v229, s30, v229
  v_add_u32 v230, s30, v230
  v_add_u32 v231, s30, v231
  v_add_u32 v232, s30, v232
  v_add_u32 v233, s30, v233
  v_add_u32 v234, s30, v234
  v_add_u32 v235, s30, v235
  s_add_u32 s25, s25, 1
  s_cmp_lt_u32 s25, 16
  s_cbranch_scc1 LOOP_A
  s_cmp_gt_u32 s26, s24
  s_cbranch_scc0 L3
  s_lshl_b32 s60, s35, 12
  s_add_u32 s60, s60, 98304
  v_add_u32 v245, s60, v242
  ds_read_b128 v[108:111], v245 offset:0
  ds_read_b128 v[112:115], v245 offset:1024
  ds_read_b128 v[116:119], v245 offset:2048
  ds_read_b128 v[120:123], v245 offset:3072
  ds_read_b128 v[124:127], v245 offset:4096
  ds_read_b128 v[128:131], v245 offset:5120
  ds_read_b128 v[132:135], v245 offset:6144
  ds_read_b128 v[136:139], v245 offset:7168
  ds_read_b128 v[140:143], v245 offset:8192
  ds_read_b128 v[144:147], v245 offset:9216
  ds_read_b128 v[148:151], v245 offset:10240
  ds_read_b128 v[152:155], v245 offset:11264
  s_waitcnt lgkmcnt(0)
L3:
  s_barrier
  s_cmp_lg_u32 s24, 0
  s_cbranch_scc1 L4
  s_lshr_b32 s60, s2, 3
  s_lshl_b32 s60, s60, 3
  s_add_u32 s60, s60, s3
  s_cmp_lt_u32 s60, 64
  s_cbranch_scc0 L5
  s_mov_b32 s12, s90
  s_mov_b32 s13, s91
  s_mov_b32 s14, 4194304
  s_lshl_b32 s60, s60, 16
  s_and_b32 s61, s2, 7
  s_lshl_b32 s61, s61, 10
  s_add_u32 s60, s60, s61
  v_lshrrev_b32 v253, 3, v244
  v_and_b32 v254, 7, v244
  v_lshlrev_b32 v254, 7, v254
  v_lshl_add_u32 v253, v253, 13, v254
  buffer_load_dword v255, v253, s[12:15], s60 offen
  s_branch L6
L5:
  s_mov_b32 s12, s84
  s_mov_b32 s13, s85
  s_mov_b32 s14, 1179648
  s_sub_u32 s60, s60, 64
  s_lshl_b32 s60, s60, 13
  v_lshlrev_b32 v253, 7, v244
  buffer_load_dword v255, v253, s[12:15], s60 offen
L6:
  s_mov_b32 s14, 147456
L4:
  s_cmp_eq_u32 s24, 0
  s_cbranch_scc1 L7
  s_and_b32 s60, s2, 1
  s_mul_i32 s60, s60, 40
  s_add_u32 s62, s0, s60
  s_addc_u32 s63, s1, 0
  s_load_dwordx2 s[12:13], s[62:63], 32
  s_lshr_b32 s60, s2, 3
  s_lshl_b32 s60, s60, 3
  s_add_u32 s60, s60, s3
  s_lshl_b32 s60, s60, 14
  s_bfe_u32 s61, s2, 0x10001
  s_lshl_b32 s61, s61, 9
  s_add_u32 s60, s60, s61
  v_lshrrev_b32 v253, 2, v244
  v_and_b32 v254, 3, v244
  v_lshlrev_b32 v254, 7, v254
  v_lshl_add_u32 v253, v253, 10, v254
  s_mov_b32 s14, 4194304
  s_waitcnt lgkmcnt(0)
  buffer_load_dword v255, v253, s[12:15], s60 offen
L7:
  v_and_b32 v247, 15, v244
  v_lshlrev_b32 v247, 2, v247
  s_mul_i32 s60, s3, 384
  s_add_u32 s60, s60, 147456
  v_add_u32 v245, s60, v247
  s_mul_i32 s60, s36, 384
  s_add_u32 s60, s60, 147456
  v_add_u32 v246, s60, v247
  s_nop 7
  ds_write_b32 v245, v180 offset:0
  ds_write_b32 v245, v96 offset:64
  ds_write_b32 v245, v184 offset:128
  ds_write_b32 v245, v100 offset:192
  ds_write_b32 v245, v188 offset:256
  ds_write_b32 v245, v104 offset:320
  s_waitcnt lgkmcnt(0)
  s_barrier
  ds_read_b32 v156, v246 offset:0
  ds_read_b32 v157, v246 offset:64
  ds_read_b32 v164, v246 offset:128
  ds_read_b32 v165, v246 offset:192
  ds_read_b32 v172, v246 offset:256
  ds_read_b32 v173, v246 offset:320
  s_waitcnt lgkmcnt(0)
  v_min_f32 v158, v156, v180
  v_sub_f32 v159, v158, v180
  v_sub_f32 v160, v158, v156
  v_exp_f32 v159, v159
  v_exp_f32 v160, v160
  v_mul_f32 v161, v159, v96
  v_fma_f32 v161, v160, v157, v161
  v_rcp_f32 v161, v161
  s_nop 0
  v_mul_f32 v162, v159, v161
  v_mul_f32 v0, v162, v0
  v_mul_f32 v1, v162, v1
  v_mul_f32 v2, v162, v2
  v_mul_f32 v3, v162, v3
  v_mul_f32 v12, v162, v12
  v_mul_f32 v13, v162, v13
  v_mul_f32 v14, v162, v14
  v_mul_f32 v15, v162, v15
  v_mul_f32 v24, v162, v24
  v_mul_f32 v25, v162, v25
  v_mul_f32 v26, v162, v26
  v_mul_f32 v27, v162, v27
  v_mul_f32 v36, v162, v36
  v_mul_f32 v37, v162, v37
  v_mul_f32 v38, v162, v38
  v_mul_f32 v39, v162, v39
  v_mul_f32 v48, v162, v48
  v_mul_f32 v49, v162, v49
  v_mul_f32 v50, v162, v50
  v_mul_f32 v51, v162, v51
  v_mul_f32 v60, v162, v60
  v_mul_f32 v61, v162, v61
  v_mul_f32 v62, v162, v62
  v_mul_f32 v63, v162, v63
  v_mul_f32 v72, v162, v72
  v_mul_f32 v73, v162, v73
  v_mul_f32 v74, v162, v74
  v_mul_f32 v75, v162, v75
  v_mul_f32 v84, v162, v84
  v_mul_f32 v85, v162, v85
  v_mul_f32 v86, v162, v86
  v_mul_f32 v87, v162, v87
  v_min_f32 v166, v164, v184
  v_sub_f32 v167, v166, v184
  v_sub_f32 v168, v166, v164
  v_exp_f32 v167, v167
  v_exp_f32 v168, v168
  v_mul_f32 v169, v167, v100
  v_fma_f32 v169, v168, v165, v169
  v_rcp_f32 v169, v169
  s_nop 0
  v_mul_f32 v170, v167, v169
  v_mul_f32 v4, v170, v4
  v_mul_f32 v5, v170, v5
  v_mul_f32 v6, v170, v6
  v_mul_f32 v7, v170, v7
  v_mul_f32 v16, v170, v16
  v_mul_f32 v17, v170, v17
  v_mul_f32 v18, v170, v18
  v_mul_f32 v19, v170, v19
  v_mul_f32 v28, v170, v28
  v_mul_f32 v29, v170, v29
  v_mul_f32 v30, v170, v30
  v_mul_f32 v31, v170, v31
  v_mul_f32 v40, v170, v40
  v_mul_f32 v41, v170, v41
  v_mul_f32 v42, v170, v42
  v_mul_f32 v43, v170, v43
  v_mul_f32 v52, v170, v52
  v_mul_f32 v53, v170, v53
  v_mul_f32 v54, v170, v54
  v_mul_f32 v55, v170, v55
  v_mul_f32 v64, v170, v64
  v_mul_f32 v65, v170, v65
  v_mul_f32 v66, v170, v66
  v_mul_f32 v67, v170, v67
  v_mul_f32 v76, v170, v76
  v_mul_f32 v77, v170, v77
  v_mul_f32 v78, v170, v78
  v_mul_f32 v79, v170, v79
  v_mul_f32 v88, v170, v88
  v_mul_f32 v89, v170, v89
  v_mul_f32 v90, v170, v90
  v_mul_f32 v91, v170, v91
  v_min_f32 v174, v172, v188
  v_sub_f32 v175, v174, v188
  v_sub_f32 v176, v174, v172
  v_exp_f32 v175, v175
  v_exp_f32 v176, v176
  v_mul_f32 v177, v175, v104
  v_fma_f32 v177, v176, v173, v177
  v_rcp_f32 v177, v177
  s_nop 0
  v_mul_f32 v178, v175, v177
  v_mul_f32 v8, v178, v8
  v_mul_f32 v9, v178, v9
  v_mul_f32 v10, v178, v10
  v_mul_f32 v11, v178, v11
  v_mul_f32 v20, v178, v20
  v_mul_f32 v21, v178, v21
  v_mul_f32 v22, v178, v22
  v_mul_f32 v23, v178, v23
  v_mul_f32 v32, v178, v32
  v_mul_f32 v33, v178, v33
  v_mul_f32 v34, v178, v34
  v_mul_f32 v35, v178, v35
  v_mul_f32 v44, v178, v44
  v_mul_f32 v45, v178, v45
  v_mul_f32 v46, v178, v46
  v_mul_f32 v47, v178, v47
  v_mul_f32 v56, v178, v56
  v_mul_f32 v57, v178, v57
  v_mul_f32 v58, v178, v58
  v_mul_f32 v59, v178, v59
  v_mul_f32 v68, v178, v68
  v_mul_f32 v69, v178, v69
  v_mul_f32 v70, v178, v70
  v_mul_f32 v71, v178, v71
  v_mul_f32 v80, v178, v80
  v_mul_f32 v81, v178, v81
  v_mul_f32 v82, v178, v82
  v_mul_f32 v83, v178, v83
  v_mul_f32 v92, v178, v92
  v_mul_f32 v93, v178, v93
  v_mul_f32 v94, v178, v94
  v_mul_f32 v95, v178, v95
  s_mul_i32 s60, s3, 6144
  s_add_u32 s60, s60, 98304
  v_add_u32 v245, s60, v242
  s_mul_i32 s60, s36, 6144
  s_add_u32 s60, s60, 98304
  v_add_u32 v246, s60, v242
  s_cmp_lg_u32 s34, 0
  s_cbranch_scc1 L8
  ds_write_b128 v245, v[48:51] offset:0
  ds_write_b128 v245, v[60:63] offset:1024
  ds_write_b128 v245, v[52:55] offset:2048
  ds_write_b128 v245, v[64:67] offset:3072
  ds_write_b128 v245, v[56:59] offset:4096
  ds_write_b128 v245, v[68:71] offset:5120
  s_waitcnt lgkmcnt(0)
  s_barrier
  ds_read_b128 v[192:195], v246 offset:0
  ds_read_b128 v[196:199], v246 offset:1024
  ds_read_b128 v[200:203], v246 offset:2048
  ds_read_b128 v[204:207], v246 offset:3072
  ds_read_b128 v[208:211], v246 offset:4096
  ds_read_b128 v[212:215], v246 offset:5120
  s_waitcnt lgkmcnt(0)
  s_barrier
  v_add_f32 v0, v0, v192
  v_add_f32 v1, v1, v193
  v_add_f32 v2, v2, v194
  v_add_f32 v3, v3, v195
  v_add_f32 v12, v12, v196
  v_add_f32 v13, v13, v197
  v_add_f32 v14, v14, v198
  v_add_f32 v15, v15, v199
  v_add_f32 v4, v4, v200
  v_add_f32 v5, v5, v201
  v_add_f32 v6, v6, v202
  v_add_f32 v7, v7, v203
  v_add_f32 v16, v16, v204
  v_add_f32 v17, v17, v205
  v_add_f32 v18, v18, v206
  v_add_f32 v19, v19, v207
  v_add_f32 v8, v8, v208
  v_add_f32 v9, v9, v209
  v_add_f32 v10, v10, v210
  v_add_f32 v11, v11, v211
  v_add_f32 v20, v20, v212
  v_add_f32 v21, v21, v213
  v_add_f32 v22, v22, v214
  v_add_f32 v23, v23, v215
  ds_write_b128 v245, v[72:75] offset:0
  ds_write_b128 v245, v[84:87] offset:1024
  ds_write_b128 v245, v[76:79] offset:2048
  ds_write_b128 v245, v[88:91] offset:3072
  ds_write_b128 v245, v[80:83] offset:4096
  ds_write_b128 v245, v[92:95] offset:5120
  s_waitcnt lgkmcnt(0)
  s_barrier
  ds_read_b128 v[192:195], v246 offset:0
  ds_read_b128 v[196:199], v246 offset:1024
  ds_read_b128 v[200:203], v246 offset:2048
  ds_read_b128 v[204:207], v246 offset:3072
  ds_read_b128 v[208:211], v246 offset:4096
  ds_read_b128 v[212:215], v246 offset:5120
  s_waitcnt lgkmcnt(0)
  s_barrier
  v_add_f32 v24, v24, v192
  v_add_f32 v25, v25, v193
  v_add_f32 v26, v26, v194
  v_add_f32 v27, v27, v195
  v_add_f32 v36, v36, v196
  v_add_f32 v37, v37, v197
  v_add_f32 v38, v38, v198
  v_add_f32 v39, v39, v199
  v_add_f32 v28, v28, v200
  v_add_f32 v29, v29, v201
  v_add_f32 v30, v30, v202
  v_add_f32 v31, v31, v203
  v_add_f32 v40, v40, v204
  v_add_f32 v41, v41, v205
  v_add_f32 v42, v42, v206
  v_add_f32 v43, v43, v207
  v_add_f32 v32, v32, v208
  v_add_f32 v33, v33, v209
  v_add_f32 v34, v34, v210
  v_add_f32 v35, v35, v211
  v_add_f32 v44, v44, v212
  v_add_f32 v45, v45, v213
  v_add_f32 v46, v46, v214
  v_add_f32 v47, v47, v215
  s_mul_i32 s60, s32, 9
  s_add_u32 s60, s60, s35
  s_lshl_b32 s60, s60, 7
  s_lshl_b32 s61, s33, 2
  s_add_u32 s60, s60, s61
  s_add_u32 s60, s60, 0
  s_lshl_b32 s60, s60, 10
  v_cvt_pk_bf16_f32 v192, v0, v1
  v_cvt_pk_bf16_f32 v193, v2, v3
  v_cvt_pk_bf16_f32 v194, v12, v13
  v_cvt_pk_bf16_f32 v195, v14, v15
  s_add_u32 s61, s60, 0
  buffer_store_dwordx4 v[192:195], v242, s[20:23], s61 offen
  v_cvt_pk_bf16_f32 v196, v24, v25
  v_cvt_pk_bf16_f32 v197, v26, v27
  v_cvt_pk_bf16_f32 v198, v36, v37
  v_cvt_pk_bf16_f32 v199, v38, v39
  s_add_u32 s61, s60, 1024
  buffer_store_dwordx4 v[196:199], v242, s[20:23], s61 offen
  v_cvt_pk_bf16_f32 v200, v4, v5
  v_cvt_pk_bf16_f32 v201, v6, v7
  v_cvt_pk_bf16_f32 v202, v16, v17
  v_cvt_pk_bf16_f32 v203, v18, v19
  s_add_u32 s61, s60, 131072
  buffer_store_dwordx4 v[200:203], v242, s[20:23], s61 offen
  v_cvt_pk_bf16_f32 v204, v28, v29
  v_cvt_pk_bf16_f32 v205, v30, v31
  v_cvt_pk_bf16_f32 v206, v40, v41
  v_cvt_pk_bf16_f32 v207, v42, v43
  s_add_u32 s61, s60, 132096
  buffer_store_dwordx4 v[204:207], v242, s[20:23], s61 offen
  v_cvt_pk_bf16_f32 v208, v8, v9
  v_cvt_pk_bf16_f32 v209, v10, v11
  v_cvt_pk_bf16_f32 v210, v20, v21
  v_cvt_pk_bf16_f32 v211, v22, v23
  s_add_u32 s61, s60, 262144
  buffer_store_dwordx4 v[208:211], v242, s[20:23], s61 offen
  v_cvt_pk_bf16_f32 v212, v32, v33
  v_cvt_pk_bf16_f32 v213, v34, v35
  v_cvt_pk_bf16_f32 v214, v44, v45
  v_cvt_pk_bf16_f32 v215, v46, v47
  s_add_u32 s61, s60, 263168
  buffer_store_dwordx4 v[212:215], v242, s[20:23], s61 offen
  s_branch L9
L8:
  ds_write_b128 v245, v[0:3] offset:0
  ds_write_b128 v245, v[12:15] offset:1024
  ds_write_b128 v245, v[4:7] offset:2048
  ds_write_b128 v245, v[16:19] offset:3072
  ds_write_b128 v245, v[8:11] offset:4096
  ds_write_b128 v245, v[20:23] offset:5120
  s_waitcnt lgkmcnt(0)
  s_barrier
  ds_read_b128 v[192:195], v246 offset:0
  ds_read_b128 v[196:199], v246 offset:1024
  ds_read_b128 v[200:203], v246 offset:2048
  ds_read_b128 v[204:207], v246 offset:3072
  ds_read_b128 v[208:211], v246 offset:4096
  ds_read_b128 v[212:215], v246 offset:5120
  s_waitcnt lgkmcnt(0)
  s_barrier
  v_add_f32 v48, v48, v192
  v_add_f32 v49, v49, v193
  v_add_f32 v50, v50, v194
  v_add_f32 v51, v51, v195
  v_add_f32 v60, v60, v196
  v_add_f32 v61, v61, v197
  v_add_f32 v62, v62, v198
  v_add_f32 v63, v63, v199
  v_add_f32 v52, v52, v200
  v_add_f32 v53, v53, v201
  v_add_f32 v54, v54, v202
  v_add_f32 v55, v55, v203
  v_add_f32 v64, v64, v204
  v_add_f32 v65, v65, v205
  v_add_f32 v66, v66, v206
  v_add_f32 v67, v67, v207
  v_add_f32 v56, v56, v208
  v_add_f32 v57, v57, v209
  v_add_f32 v58, v58, v210
  v_add_f32 v59, v59, v211
  v_add_f32 v68, v68, v212
  v_add_f32 v69, v69, v213
  v_add_f32 v70, v70, v214
  v_add_f32 v71, v71, v215
  ds_write_b128 v245, v[24:27] offset:0
  ds_write_b128 v245, v[36:39] offset:1024
  ds_write_b128 v245, v[28:31] offset:2048
  ds_write_b128 v245, v[40:43] offset:3072
  ds_write_b128 v245, v[32:35] offset:4096
  ds_write_b128 v245, v[44:47] offset:5120
  s_waitcnt lgkmcnt(0)
  s_barrier
  ds_read_b128 v[192:195], v246 offset:0
  ds_read_b128 v[196:199], v246 offset:1024
  ds_read_b128 v[200:203], v246 offset:2048
  ds_read_b128 v[204:207], v246 offset:3072
  ds_read_b128 v[208:211], v246 offset:4096
  ds_read_b128 v[212:215], v246 offset:5120
  s_waitcnt lgkmcnt(0)
  s_barrier
  v_add_f32 v72, v72, v192
  v_add_f32 v73, v73, v193
  v_add_f32 v74, v74, v194
  v_add_f32 v75, v75, v195
  v_add_f32 v84, v84, v196
  v_add_f32 v85, v85, v197
  v_add_f32 v86, v86, v198
  v_add_f32 v87, v87, v199
  v_add_f32 v76, v76, v200
  v_add_f32 v77, v77, v201
  v_add_f32 v78, v78, v202
  v_add_f32 v79, v79, v203
  v_add_f32 v88, v88, v204
  v_add_f32 v89, v89, v205
  v_add_f32 v90, v90, v206
  v_add_f32 v91, v91, v207
  v_add_f32 v80, v80, v208
  v_add_f32 v81, v81, v209
  v_add_f32 v82, v82, v210
  v_add_f32 v83, v83, v211
  v_add_f32 v92, v92, v212
  v_add_f32 v93, v93, v213
  v_add_f32 v94, v94, v214
  v_add_f32 v95, v95, v215
  s_mul_i32 s60, s32, 9
  s_add_u32 s60, s60, s35
  s_lshl_b32 s60, s60, 7
  s_lshl_b32 s61, s33, 2
  s_add_u32 s60, s60, s61
  s_add_u32 s60, s60, 2
  s_lshl_b32 s60, s60, 10
  v_cvt_pk_bf16_f32 v192, v48, v49
  v_cvt_pk_bf16_f32 v193, v50, v51
  v_cvt_pk_bf16_f32 v194, v60, v61
  v_cvt_pk_bf16_f32 v195, v62, v63
  s_add_u32 s61, s60, 0
  buffer_store_dwordx4 v[192:195], v242, s[20:23], s61 offen
  v_cvt_pk_bf16_f32 v196, v72, v73
  v_cvt_pk_bf16_f32 v197, v74, v75
  v_cvt_pk_bf16_f32 v198, v84, v85
  v_cvt_pk_bf16_f32 v199, v86, v87
  s_add_u32 s61, s60, 1024
  buffer_store_dwordx4 v[196:199], v242, s[20:23], s61 offen
  v_cvt_pk_bf16_f32 v200, v52, v53
  v_cvt_pk_bf16_f32 v201, v54, v55
  v_cvt_pk_bf16_f32 v202, v64, v65
  v_cvt_pk_bf16_f32 v203, v66, v67
  s_add_u32 s61, s60, 131072
  buffer_store_dwordx4 v[200:203], v242, s[20:23], s61 offen
  v_cvt_pk_bf16_f32 v204, v76, v77
  v_cvt_pk_bf16_f32 v205, v78, v79
  v_cvt_pk_bf16_f32 v206, v88, v89
  v_cvt_pk_bf16_f32 v207, v90, v91
  s_add_u32 s61, s60, 132096
  buffer_store_dwordx4 v[204:207], v242, s[20:23], s61 offen
  v_cvt_pk_bf16_f32 v208, v56, v57
  v_cvt_pk_bf16_f32 v209, v58, v59
  v_cvt_pk_bf16_f32 v210, v68, v69
  v_cvt_pk_bf16_f32 v211, v70, v71
  s_add_u32 s61, s60, 262144
  buffer_store_dwordx4 v[208:211], v242, s[20:23], s61 offen
  v_cvt_pk_bf16_f32 v212, v80, v81
  v_cvt_pk_bf16_f32 v213, v82, v83
  v_cvt_pk_bf16_f32 v214, v92, v93
  v_cvt_pk_bf16_f32 v215, v94, v95
  s_add_u32 s61, s60, 263168
  buffer_store_dwordx4 v[212:215], v242, s[20:23], s61 offen
L9:
  s_add_u32 s24, s24, 1
  s_cmp_lt_u32 s24, 2
  s_cbranch_scc1 UNIT_A
  s_waitcnt vmcnt(0)
  s_waitcnt vmcnt(0)
  s_endpgm
SLOW_A:
  v_xor_b32 v245, 16, v244
  v_lshlrev_b32 v245, 2, v245
  v_xor_b32 v246, 32, v244
  v_lshlrev_b32 v246, 2, v246
  v_max3_f32 v247, v156, v157, v158
  v_max3_f32 v247, v247, v159, v160
  v_max3_f32 v247, v247, v161, v162
  v_max_f32 v247, v247, v163
  ds_bpermute_b32 v252, v245, v247
  s_waitcnt lgkmcnt(0)
  v_max_f32 v247, v247, v252
  ds_bpermute_b32 v252, v246, v247
  s_waitcnt lgkmcnt(0)
  v_max_f32 v247, v247, v252
  v_max_f32 v247, 0, v247
  v_sub_f32 v156, v156, v247
  v_sub_f32 v157, v157, v247
  v_sub_f32 v158, v158, v247
  v_sub_f32 v159, v159, v247
  v_sub_f32 v160, v160, v247
  v_sub_f32 v161, v161, v247
  v_sub_f32 v162, v162, v247
  v_sub_f32 v163, v163, v247
  v_sub_f32 v180, v180, v247
  v_sub_f32 v181, v181, v247
  v_sub_f32 v182, v182, v247
  v_sub_f32 v183, v183, v247
  v_max3_f32 v248, v164, v165, v166
  v_max3_f32 v248, v248, v167, v168
  v_max3_f32 v248, v248, v169, v170
  v_max_f32 v248, v248, v171
  ds_bpermute_b32 v252, v245, v248
  s_waitcnt lgkmcnt(0)
  v_max_f32 v248, v248, v252
  ds_bpermute_b32 v252, v246, v248
  s_waitcnt lgkmcnt(0)
  v_max_f32 v248, v248, v252
  v_max_f32 v248, 0, v248
  v_sub_f32 v164, v164, v248
  v_sub_f32 v165, v165, v248
  v_sub_f32 v166, v166, v248
  v_sub_f32 v167, v167, v248
  v_sub_f32 v168, v168, v248
  v_sub_f32 v169, v169, v248
  v_sub_f32 v170, v170, v248
  v_sub_f32 v171, v171, v248
  v_sub_f32 v184, v184, v248
  v_sub_f32 v185, v185, v248
  v_sub_f32 v186, v186, v248
  v_sub_f32 v187, v187, v248
  v_max3_f32 v249, v172, v173, v174
  v_max3_f32 v249, v249, v175, v176
  v_max3_f32 v249, v249, v177, v178
  v_max_f32 v249, v249, v179
  ds_bpermute_b32 v252, v245, v249
  s_waitcnt lgkmcnt(0)
  v_max_f32 v249, v249, v252
  ds_bpermute_b32 v252, v246, v249
  s_waitcnt lgkmcnt(0)
  v_max_f32 v249, v249, v252
  v_max_f32 v249, 0, v249
  v_sub_f32 v172, v172, v249
  v_sub_f32 v173, v173, v249
  v_sub_f32 v174, v174, v249
  v_sub_f32 v175, v175, v249
  v_sub_f32 v176, v176, v249
  v_sub_f32 v177, v177, v249
  v_sub_f32 v178, v178, v249
  v_sub_f32 v179, v179, v249
  v_sub_f32 v188, v188, v249
  v_sub_f32 v189, v189, v249
  v_sub_f32 v190, v190, v249
  v_sub_f32 v191, v191, v249
  v_sub_f32 v247, 0, v247
  v_exp_f32 v247, v247
  s_nop 0
  v_mul_f32 v0, v247, v0
  v_mul_f32 v1, v247, v1
  v_mul_f32 v2, v247, v2
  v_mul_f32 v3, v247, v3
  v_mul_f32 v12, v247, v12
  v_mul_f32 v13, v247, v13
  v_mul_f32 v14, v247, v14
  v_mul_f32 v15, v247, v15
  v_mul_f32 v24, v247, v24
  v_mul_f32 v25, v247, v25
  v_mul_f32 v26, v247, v26
  v_mul_f32 v27, v247, v27
  v_mul_f32 v36, v247, v36
  v_mul_f32 v37, v247, v37
  v_mul_f32 v38, v247, v38
  v_mul_f32 v39, v247, v39
  v_mul_f32 v48, v247, v48
  v_mul_f32 v49, v247, v49
  v_mul_f32 v50, v247, v50
  v_mul_f32 v51, v247, v51
  v_mul_f32 v60, v247, v60
  v_mul_f32 v61, v247, v61
  v_mul_f32 v62, v247, v62
  v_mul_f32 v63, v247, v63
  v_mul_f32 v72, v247, v72
  v_mul_f32 v73, v247, v73
  v_mul_f32 v74, v247, v74
  v_mul_f32 v75, v247, v75
  v_mul_f32 v84, v247, v84
  v_mul_f32 v85, v247, v85
  v_mul_f32 v86, v247, v86
  v_mul_f32 v87, v247, v87
  v_mul_f32 v96, v247, v96
  v_mul_f32 v97, v247, v97
  v_mul_f32 v98, v247, v98
  v_mul_f32 v99, v247, v99
  v_sub_f32 v248, 0, v248
  v_exp_f32 v248, v248
  s_nop 0
  v_mul_f32 v4, v248, v4
  v_mul_f32 v5, v248, v5
  v_mul_f32 v6, v248, v6
  v_mul_f32 v7, v248, v7
  v_mul_f32 v16, v248, v16
  v_mul_f32 v17, v248, v17
  v_mul_f32 v18, v248, v18
  v_mul_f32 v19, v248, v19
  v_mul_f32 v28, v248, v28
  v_mul_f32 v29, v248, v29
  v_mul_f32 v30, v248, v30
  v_mul_f32 v31, v248, v31
  v_mul_f32 v40, v248, v40
  v_mul_f32 v41, v248, v41
  v_mul_f32 v42, v248, v42
  v_mul_f32 v43, v248, v43
  v_mul_f32 v52, v248, v52
  v_mul_f32 v53, v248, v53
  v_mul_f32 v54, v248, v54
  v_mul_f32 v55, v248, v55
  v_mul_f32 v64, v248, v64
  v_mul_f32 v65, v248, v65
  v_mul_f32 v66, v248, v66
  v_mul_f32 v67, v248, v67
  v_mul_f32 v76, v248, v76
  v_mul_f32 v77, v248, v77
  v_mul_f32 v78, v248, v78
  v_mul_f32 v79, v248, v79
  v_mul_f32 v88, v248, v88
  v_mul_f32 v89, v248, v89
  v_mul_f32 v90, v248, v90
  v_mul_f32 v91, v248, v91
  v_mul_f32 v100, v248, v100
  v_mul_f32 v101, v248, v101
  v_mul_f32 v102, v248, v102
  v_mul_f32 v103, v248, v103
  v_sub_f32 v249, 0, v249
  v_exp_f32 v249, v249
  s_nop 0
  v_mul_f32 v8, v249, v8
  v_mul_f32 v9, v249, v9
  v_mul_f32 v10, v249, v10
  v_mul_f32 v11, v249, v11
  v_mul_f32 v20, v249, v20
  v_mul_f32 v21, v249, v21
  v_mul_f32 v22, v249, v22
  v_mul_f32 v23, v249, v23
  v_mul_f32 v32, v249, v32
  v_mul_f32 v33, v249, v33
  v_mul_f32 v34, v249, v34
  v_mul_f32 v35, v249, v35
  v_mul_f32 v44, v249, v44
  v_mul_f32 v45, v249, v45
  v_mul_f32 v46, v249, v46
  v_mul_f32 v47, v249, v47
  v_mul_f32 v56, v249, v56
  v_mul_f32 v57, v249, v57
  v_mul_f32 v58, v249, v58
  v_mul_f32 v59, v249, v59
  v_mul_f32 v68, v249, v68
  v_mul_f32 v69, v249, v69
  v_mul_f32 v70, v249, v70
  v_mul_f32 v71, v249, v71
  v_mul_f32 v80, v249, v80
  v_mul_f32 v81, v249, v81
  v_mul_f32 v82, v249, v82
  v_mul_f32 v83, v249, v83
  v_mul_f32 v92, v249, v92
  v_mul_f32 v93, v249, v93
  v_mul_f32 v94, v249, v94
  v_mul_f32 v95, v249, v95
  v_mul_f32 v104, v249, v104
  v_mul_f32 v105, v249, v105
  v_mul_f32 v106, v249, v106
  v_mul_f32 v107, v249, v107
  s_nop 1
  s_branch BACK_A
K1_B:
  v_lshrrev_b32 v245, 4, v244
  v_and_b32 v246, 15, v244
  v_lshlrev_b32 v247, 1, v245
  v_xor_b32 v248, v246, v247
  v_lshlrev_b32 v248, 4, v248
  v_lshl_add_u32 v240, v245, 8, v248
  v_xor_b32 v241, 128, v240
UNIT_B:
  s_mul_i32 s60, s24, 9437184
  s_add_u32 s20, s56, s60
  s_addc_u32 s21, s57, 0
  s_mov_b32 s58, s24
  s_and_b32 s60, s26, s24
  s_cmp_lg_u32 s60, 0
  s_cbranch_scc1 INIT_B
QP_B:
  s_cmp_eq_u32 s58, 0
  s_cselect_b32 s12, s48, s50
  s_cselect_b32 s13, s49, s51
  s_cselect_b32 s16, s52, s54
  s_cselect_b32 s17, s53, s55
  v_mov_b32 v0, 0
  v_mov_b32 v1, 0
  v_mov_b32 v2, 0
  v_mov_b32 v3, 0
  v_mov_b32 v4, 0
  v_mov_b32 v5, 0
  v_mov_b32 v6, 0
  v_mov_b32 v7, 0
  v_mov_b32 v8, 0
  v_mov_b32 v9, 0
  v_mov_b32 v10, 0
  v_mov_b32 v11, 0
  v_mov_b32 v12, 0
  v_mov_b32 v13, 0
  v_mov_b32 v14, 0
  v_mov_b32 v15, 0
  v_mov_b32 v16, 0
  v_mov_b32 v17, 0
  v_mov_b32 v18, 0
  v_mov_b32 v19, 0
  v_mov_b32 v20, 0
  v_mov_b32 v21, 0
  v_mov_b32 v22, 0
  v_mov_b32 v23, 0
  v_mov_b32 v24, 0
  v_mov_b32 v25, 0
  v_mov_b32 v26, 0
  v_mov_b32 v27, 0
  v_mov_b32 v28, 0
  v_mov_b32 v29, 0
  v_mov_b32 v30, 0
  v_mov_b32 v31, 0
  v_mov_b32 v32, 0
  v_mov_b32 v33, 0
  v_mov_b32 v34, 0
  v_mov_b32 v35, 0
  v_mov_b32 v36, 0
  v_mov_b32 v37, 0
  v_mov_b32 v38, 0
  v_mov_b32 v39, 0
  v_and_b32 v245, 15, v244
  v_lshrrev_b32 v246, 2, v245
  v_sub_u32 v246, 0, v246
  v_lshrrev_b32 v247, 4, v244
  v_xor_b32 v246, v246, v247
  v_and_b32 v246, 3, v246
  v_lshlrev_b32 v246, 4, v246
  v_lshl_add_u32 v245, v245, 6, v246
  v_add_u32 v245, 98304, v245
  v_lshrrev_b32 v101, 4, v244
  v_and_b32 v102, 15, v244
  v_lshlrev_b32 v103, 2, v101
  v_xor_b32 v103, v102, v103
  v_lshlrev_b32 v103, 4, v103
  v_lshl_add_u32 v100, v101, 13, v103
  s_lshl_b32 s70, s39, 16
  s_lshl_b32 s71, s39, 11
  s_add_u32 s37, s73, 0
  s_and_b32 s37, s37, 15
  s_lshl_b32 s38, s37, 18
  s_lshl_b32 s37, s37, 6
  s_add_u32 m0, s71, 107520
  s_add_u32 s60, s70, s38
  buffer_load_dwordx4 v100, s[16:19], s60 offen lds
  s_add_u32 m0, s71, 108544
  s_add_u32 s60, s60, 32768
  buffer_load_dwordx4 v100, s[16:19], s60 offen lds
  s_add_u32 s37, s73, 1
  s_and_b32 s37, s37, 15
  s_lshl_b32 s38, s37, 18
  s_lshl_b32 s37, s37, 6
  s_add_u32 m0, s71, 124928
  s_add_u32 s60, s70, s38
  buffer_load_dwordx4 v100, s[16:19], s60 offen lds
  s_add_u32 m0, s71, 125952
  s_add_u32 s60, s60, 32768
  buffer_load_dwordx4 v100, s[16:19], s60 offen lds
  s_add_u32 s37, s73, 2
  s_and_b32 s37, s37, 15
  s_lshl_b32 s38, s37, 18
  s_lshl_b32 s37, s37, 6
  s_add_u32 m0, s71, 142336
  s_add_u32 s60, s70, s38
  buffer_load_dwordx4 v100, s[16:19], s60 offen lds
  s_add_u32 m0, s71, 143360
  s_add_u32 s60, s60, 32768
  buffer_load_dwordx4 v100, s[16:19], s60 offen lds
  s_waitcnt vmcnt(4)
  s_barrier
  ds_read_b64_tr_b16 v[40:41], v243 offset:9216
  ds_read_b64_tr_b16 v[42:43], v243 offset:10240
  ds_read_b64_tr_b16 v[44:45], v243 offset:9224
  ds_read_b64_tr_b16 v[46:47], v243 offset:10248
  ds_read_b128 v[56:59], v245 offset:0
  ds_read_b128 v[60:63], v245 offset:1024
  ds_read_b128 v[64:67], v245 offset:2048
  ds_read_b128 v[68:71], v245 offset:3072
  ds_read_b128 v[72:75], v245 offset:4096
  s_waitcnt vmcnt(2)
  s_waitcnt lgkmcnt(0)
  s_barrier
  ds_read_b64_tr_b16 v[48:49], v243 offset:26624
  ds_read_b64_tr_b16 v[50:51], v243 offset:27648
  ds_read_b64_tr_b16 v[52:53], v243 offset:26632
  ds_read_b64_tr_b16 v[54:55], v243 offset:27656
  ds_read_b128 v[76:79], v245 offset:17408
  ds_read_b128 v[80:83], v245 offset:18432
  ds_read_b128 v[84:87], v245 offset:19456
  ds_read_b128 v[88:91], v245 offset:20480
  ds_read_b128 v[92:95], v245 offset:21504
  v_mfma_f32_16x16x32_bf16 v[0:3], v[40:43], v[56:59], v[0:3]
  v_mfma_f32_16x16x32_bf16 v[20:23], v[44:47], v[56:59], v[20:23]
  s_add_u32 s37, s73, 3
  s_and_b32 s37, s37, 15
  s_lshl_b32 s38, s37, 18
  s_lshl_b32 s37, s37, 6
  s_add_u32 m0, s71, 107520
  s_add_u32 s60, s70, s38
  buffer_load_dwordx4 v100, s[16:19], s60 offen lds
  v_mfma_f32_16x16x32_bf16 v[4:7], v[40:43], v[60:63], v[4:7]
  v_mfma_f32_16x16x32_bf16 v[24:27], v[44:47], v[60:63], v[24:27]
  s_add_u32 m0, s71, 108544
  s_add_u32 s60, s60, 32768
  buffer_load_dwordx4 v100, s[16:19], s60 offen lds
  v_mfma_f32_16x16x32_bf16 v[8:11], v[40:43], v[64:67], v[8:11]
  v_mfma_f32_16x16x32_bf16 v[28:31], v[44:47], v[64:67], v[28:31]
  v_mfma_f32_16x16x32_bf16 v[12:15], v[40:43], v[68:71], v[12:15]
  v_mfma_f32_16x16x32_bf16 v[32:35], v[44:47], v[68:71], v[32:35]
  v_mfma_f32_16x16x32_bf16 v[16:19], v[40:43], v[72:75], v[16:19]
  v_mfma_f32_16x16x32_bf16 v[36:39], v[44:47], v[72:75], v[36:39]
  s_waitcnt vmcnt(2)
  s_waitcnt lgkmcnt(0)
  s_barrier
  ds_read_b64_tr_b16 v[40:41], v243 offset:44032
  ds_read_b64_tr_b16 v[42:43], v243 offset:45056
  ds_read_b64_tr_b16 v[44:45], v243 offset:44040
  ds_read_b64_tr_b16 v[46:47], v243 offset:45064
  ds_read_b128 v[56:59], v245 offset:34816
  ds_read_b128 v[60:63], v245 offset:35840
  ds_read_b128 v[64:67], v245 offset:36864
  ds_read_b128 v[68:71], v245 offset:37888
  ds_read_b128 v[72:75], v245 offset:38912
  v_mfma_f32_16x16x32_bf16 v[0:3], v[48:51], v[76:79], v[0:3]
  v_mfma_f32_16x16x32_bf16 v[20:23], v[52:55], v[76:79], v[20:23]
  s_add_u32 s37, s73, 4
  s_and_b32 s37, s37, 15
  s_lshl_b32 s38, s37, 18
  s_lshl_b32 s37, s37, 6
  s_add_u32 m0, s71, 124928
  s_add_u32 s60, s70, s38
  buffer_load_dwordx4 v100, s[16:19], s60 offen lds
  v_mfma_f32_16x16x32_bf16 v[4:7], v[48:51], v[80:83], v[4:7]
  v_mfma_f32_16x16x32_bf16 v[24:27], v[52:55], v[80:83], v[24:27]
  s_add_u32 m0, s71, 125952
  s_add_u32 s60, s60, 32768
  buffer_load_dwordx4 v100, s[16:19], s60 offen lds
  v_mfma_f32_16x16x32_bf16 v[8:11], v[48:51], v[84:87], v[8:11]
  v_mfma_f32_16x16x32_bf16 v[28:31], v[52:55], v[84:87], v[28:31]
  v_mfma_f32_16x16x32_bf16 v[12:15], v[48:51], v[88:91], v[12:15]
  v_mfma_f32_16x16x32_bf16 v[32:35], v[52:55], v[88:91], v[32:35]
  v_mfma_f32_16x16x32_bf16 v[16:19], v[48:51], v[92:95], v[16:19]
  v_mfma_f32_16x16x32_bf16 v[36:39], v[52:55], v[92:95], v[36:39]
  s_waitcnt vmcnt(2)
  s_waitcnt lgkmcnt(0)
  s_barrier
  ds_read_b64_tr_b16 v[48:49], v243 offset:9216
  ds_read_b64_tr_b16 v[50:51], v243 offset:10240
  ds_read_b64_tr_b16 v[52:53], v243 offset:9224
  ds_read_b64_tr_b16 v[54:55], v243 offset:10248
  ds_read_b128 v[76:79], v245 offset:0
  ds_read_b128 v[80:83], v245 offset:1024
  ds_read_b128 v[84:87], v245 offset:2048
  ds_read_b128 v[88:91], v245 offset:3072
  ds_read_b128 v[92:95], v245 offset:4096
  v_mfma_f32_16x16x32_bf16 v[0:3], v[40:43], v[56:59], v[0:3]
  v_mfma_f32_16x16x32_bf16 v[20:23], v[44:47], v[56:59], v[20:23]
  s_add_u32 s37, s73, 5
  s_and_b32 s37, s37, 15
  s_lshl_b32 s38, s37, 18
  s_lshl_b32 s37, s37, 6
  s_add_u32 m0, s71, 142336
  s_add_u32 s60, s70, s38
  buffer_load_dwordx4 v100, s[16:19], s60 offen lds
  v_mfma_f32_16x16x32_bf16 v[4:7], v[40:43], v[60:63], v[4:7]
  v_mfma_f32_16x16x32_bf16 v[24:27], v[44:47], v[60:63], v[24:27]
  s_add_u32 m0, s71, 143360
  s_add_u32 s60, s60, 32768
  buffer_load_dwordx4 v100, s[16:19], s60 offen lds
  v_mfma_f32_16x16x32_bf16 v[8:11], v[40:43], v[64:67], v[8:11]
  v_mfma_f32_16x16x32_bf16 v[28:31], v[44:47], v[64:67], v[28:31]
  v_mfma_f32_16x16x32_bf16 v[12:15], v[40:43], v[68:71], v[12:15]
  v_mfma_f32_16x16x32_bf16 v[32:35], v[44:47], v[68:71], v[32:35]
  v_mfma_f32_16x16x32_bf16 v[16:19], v[40:43], v[72:75], v[16:19]
  v_mfma_f32_16x16x32_bf16 v[36:39], v[44:47], v[72:75], v[36:39]
  s_waitcnt vmcnt(2)
  s_waitcnt lgkmcnt(0)
  s_barrier
  ds_read_b64_tr_b16 v[40:41], v243 offset:26624
  ds_read_b64_tr_b16 v[42:43], v243 offset:27648
  ds_read_b64_tr_b16 v[44:45], v243 offset:26632
  ds_read_b64_tr_b16 v[46:47], v243 offset:27656
  ds_read_b128 v[56:59], v245 offset:17408
  ds_read_b128 v[60:63], v245 offset:18432
  ds_read_b128 v[64:67], v245 offset:19456
  ds_read_b128 v[68:71], v245 offset:20480
  ds_read_b128 v[72:75], v245 offset:21504
  v_mfma_f32_16x16x32_bf16 v[0:3], v[48:51], v[76:79], v[0:3]
  v_mfma_f32_16x16x32_bf16 v[20:23], v[52:55], v[76:79], v[20:23]
  s_add_u32 s37, s73, 6
  s_and_b32 s37, s37, 15
  s_lshl_b32 s38, s37, 18
  s_lshl_b32 s37, s37, 6
  s_add_u32 m0, s71, 107520
  s_add_u32 s60, s70, s38
  buffer_load_dwordx4 v100, s[16:19], s60 offen lds
  v_mfma_f32_16x16x32_bf16 v[4:7], v[48:51], v[80:83], v[4:7]
  v_mfma_f32_16x16x32_bf16 v[24:27], v[52:55], v[80:83], v[24:27]
  s_add_u32 m0, s71, 108544
  s_add_u32 s60, s60, 32768
  buffer_load_dwordx4 v100, s[16:19], s60 offen lds
  v_mfma_f32_16x16x32_bf16 v[8:11], v[48:51], v[84:87], v[8:11]
  v_mfma_f32_16x16x32_bf16 v[28:31], v[52:55], v[84:87], v[28:31]
  v_mfma_f32_16x16x32_bf16 v[12:15], v[48:51], v[88:91], v[12:15]
  v_mfma_f32_16x16x32_bf16 v[32:35], v[52:55], v[88:91], v[32:35]
  v_mfma_f32_16x16x32_bf16 v[16:19], v[48:51], v[92:95], v[16:19]
  v_mfma_f32_16x16x32_bf16 v[36:39], v[52:55], v[92:95], v[36:39]
  s_waitcnt vmcnt(2)
  s_waitcnt lgkmcnt(0)
  s_barrier
  ds_read_b64_tr_b16 v[48:49], v243 offset:44032
  ds_read_b64_tr_b16 v[50:51], v243 offset:45056
  ds_read_b64_tr_b16 v[52:53], v243 offset:44040
  ds_read_b64_tr_b16 v[54:55], v243 offset:45064
  ds_read_b128 v[76:79], v245 offset:34816
  ds_read_b128 v[80:83], v245 offset:35840
  ds_read_b128 v[84:87], v245 offset:36864
  ds_read_b128 v[88:91], v245 offset:37888
  ds_read_b128 v[92:95], v245 offset:38912
  v_mfma_f32_16x16x32_bf16 v[0:3], v[40:43], v[56:59], v[0:3]
  v_mfma_f32_16x16x32_bf16 v[20:23], v[44:47], v[56:59], v[20:23]
  s_add_u32 s37, s73, 7
  s_and_b32 s37, s37, 15
  s_lshl_b32 s38, s37, 18
  s_lshl_b32 s37, s37, 6
  s_add_u32 m0, s71, 124928
  s_add_u32 s60, s70, s38
  buffer_load_dwordx4 v100, s[16:19], s60 offen lds
  v_mfma_f32_16x16x32_bf16 v[4:7], v[40:43], v[60:63], v[4:7]
  v_mfma_f32_16x16x32_bf16 v[24:27], v[44:47], v[60:63], v[24:27]
  s_add_u32 m0, s71, 125952
  s_add_u32 s60, s60, 32768
  buffer_load_dwordx4 v100, s[16:19], s60 offen lds
  v_mfma_f32_16x16x32_bf16 v[8:11], v[40:43], v[64:67], v[8:11]
  v_mfma_f32_16x16x32_bf16 v[28:31], v[44:47], v[64:67], v[28:31]
  v_mfma_f32_16x16x32_bf16 v[12:15], v[40:43], v[68:71], v[12:15]
  v_mfma_f32_16x16x32_bf16 v[32:35], v[44:47], v[68:71], v[32:35]
  v_mfma_f32_16x16x32_bf16 v[16:19], v[40:43], v[72:75], v[16:19]
  v_mfma_f32_16x16x32_bf16 v[36:39], v[44:47], v[72:75], v[36:39]
  s_waitcnt vmcnt(2)
  s_waitcnt lgkmcnt(0)
  s_barrier
  ds_read_b64_tr_b16 v[40:41], v243 offset:9216
  ds_read_b64_tr_b16 v[42:43], v243 offset:10240
  ds_read_b64_tr_b16 v[44:45], v243 offset:9224
  ds_read_b64_tr_b16 v[46:47], v243 offset:10248
  ds_read_b128 v[56:59], v245 offset:0
  ds_read_b128 v[60:63], v245 offset:1024
  ds_read_b128 v[64:67], v245 offset:2048
  ds_read_b128 v[68:71], v245 offset:3072
  ds_read_b128 v[72:75], v245 offset:4096
  v_mfma_f32_16x16x32_bf16 v[0:3], v[48:51], v[76:79], v[0:3]
  v_mfma_f32_16x16x32_bf16 v[20:23], v[52:55], v[76:79], v[20:23]
  s_add_u32 s37, s73, 8
  s_and_b32 s37, s37, 15
  s_lshl_b32 s38, s37, 18
  s_lshl_b32 s37, s37, 6
  s_add_u32 m0, s71, 142336
  s_add_u32 s60, s70, s38
  buffer_load_dwordx4 v100, s[16:19], s60 offen lds
  v_mfma_f32_16x16x32_bf16 v[4:7], v[48:51], v[80:83], v[4:7]
  v_mfma_f32_16x16x32_bf16 v[24:27], v[52:55], v[80:83], v[24:27]
  s_add_u32 m0, s71, 143360
  s_add_u32 s60, s60, 32768
  buffer_load_dwordx4 v100, s[16:19], s60 offen lds
  v_mfma_f32_16x16x32_bf16 v[8:11], v[48:51], v[84:87], v[8:11]
  v_mfma_f32_16x16x32_bf16 v[28:31], v[52:55], v[84:87], v[28:31]
  v_mfma_f32_16x16x32_bf16 v[12:15], v[48:51], v[88:91], v[12:15]
  v_mfma_f32_16x16x32_bf16 v[32:35], v[52:55], v[88:91], v[32:35]
  v_mfma_f32_16x16x32_bf16 v[16:19], v[48:51], v[92:95], v[16:19]
  v_mfma_f32_16x16x32_bf16 v[36:39], v[52:55], v[92:95], v[36:39]
  s_waitcnt vmcnt(2)
  s_waitcnt lgkmcnt(0)
  s_barrier
  ds_read_b64_tr_b16 v[48:49], v243 offset:26624
  ds_read_b64_tr_b16 v[50:51], v243 offset:27648
  ds_read_b64_tr_b16 v[52:53], v243 offset:26632
  ds_read_b64_tr_b16 v[54:55], v243 offset:27656
  ds_read_b128 v[76:79], v245 offset:17408
  ds_read_b128 v[80:83], v245 offset:18432
  ds_read_b128 v[84:87], v245 offset:19456
  ds_read_b128 v[88:91], v245 offset:20480
  ds_read_b128 v[92:95], v245 offset:21504
  v_mfma_f32_16x16x32_bf16 v[0:3], v[40:43], v[56:59], v[0:3]
  v_mfma_f32_16x16x32_bf16 v[20:23], v[44:47], v[56:59], v[20:23]
  s_add_u32 s37, s73, 9
  s_and_b32 s37, s37, 15
  s_lshl_b32 s38, s37, 18
  s_lshl_b32 s37, s37, 6
  s_add_u32 m0, s71, 107520
  s_add_u32 s60, s70, s38
  buffer_load_dwordx4 v100, s[16:19], s60 offen lds
  v_mfma_f32_16x16x32_bf16 v[4:7], v[40:43], v[60:63], v[4:7]
  v_mfma_f32_16x16x32_bf16 v[24:27], v[44:47], v[60:63], v[24:27]
  s_add_u32 m0, s71, 108544
  s_add_u32 s60, s60, 32768
  buffer_load_dwordx4 v100, s[16:19], s60 offen lds
  v_mfma_f32_16x16x32_bf16 v[8:11], v[40:43], v[64:67], v[8:11]
  v_mfma_f32_16x16x32_bf16 v[28:31], v[44:47], v[64:67], v[28:31]
  v_mfma_f32_16x16x32_bf16 v[12:15], v[40:43], v[68:71], v[12:15]
  v_mfma_f32_16x16x32_bf16 v[32:35], v[44:47], v[68:71], v[32:35]
  v_mfma_f32_16x16x32_bf16 v[16:19], v[40:43], v[72:75], v[16:19]
  v_mfma_f32_16x16x32_bf16 v[36:39], v[44:47], v[72:75], v[36:39]
  s_waitcnt vmcnt(2)
  s_waitcnt lgkmcnt(0)
  s_barrier
  ds_read_b64_tr_b16 v[40:41], v243 offset:44032
  ds_read_b64_tr_b16 v[42:43], v243 offset:45056
  ds_read_b64_tr_b16 v[44:45], v243 offset:44040
  ds_read_b64_tr_b16 v[46:47], v243 offset:45064
  ds_read_b128 v[56:59], v245 offset:34816
  ds_read_b128 v[60:63], v245 offset:35840
  ds_read_b128 v[64:67], v245 offset:36864
  ds_read_b128 v[68:71], v245 offset:37888
  ds_read_b128 v[72:75], v245 offset:38912
  v_mfma_f32_16x16x32_bf16 v[0:3], v[48:51], v[76:79], v[0:3]
  v_mfma_f32_16x16x32_bf16 v[20:23], v[52:55], v[76:79], v[20:23]
  s_add_u32 s37, s73, 10
  s_and_b32 s37, s37, 15
  s_lshl_b32 s38, s37, 18
  s_lshl_b32 s37, s37, 6
  s_add_u32 m0, s71, 124928
  s_add_u32 s60, s70, s38
  buffer_load_dwordx4 v100, s[16:19], s60 offen lds
  v_mfma_f32_16x16x32_bf16 v[4:7], v[48:51], v[80:83], v[4:7]
  v_mfma_f32_16x16x32_bf16 v[24:27], v[52:55], v[80:83], v[24:27]
  s_add_u32 m0, s71, 125952
  s_add_u32 s60, s60, 32768
  buffer_load_dwordx4 v100, s[16:19], s60 offen lds
  v_mfma_f32_16x16x32_bf16 v[8:11], v[48:51], v[84:87], v[8:11]
  v_mfma_f32_16x16x32_bf16 v[28:31], v[52:55], v[84:87], v[28:31]
  v_mfma_f32_16x16x32_bf16 v[12:15], v[48:51], v[88:91], v[12:15]
  v_mfma_f32_16x16x32_bf16 v[32:35], v[52:55], v[88:91], v[32:35]
  v_mfma_f32_16x16x32_bf16 v[16:19], v[48:51], v[92:95], v[16:19]
  v_mfma_f32_16x16x32_bf16 v[36:39], v[52:55], v[92:95], v[36:39]
  s_waitcnt vmcnt(2)
  s_waitcnt lgkmcnt(0)
  s_barrier
  ds_read_b64_tr_b16 v[48:49], v243 offset:9216
  ds_read_b64_tr_b16 v[50:51], v243 offset:10240
  ds_read_b64_tr_b16 v[52:53], v243 offset:9224
  ds_read_b64_tr_b16 v[54:55], v243 offset:10248
  ds_read_b128 v[76:79], v245 offset:0
  ds_read_b128 v[80:83], v245 offset:1024
  ds_read_b128 v[84:87], v245 offset:2048
  ds_read_b128 v[88:91], v245 offset:3072
  ds_read_b128 v[92:95], v245 offset:4096
  v_mfma_f32_16x16x32_bf16 v[0:3], v[40:43], v[56:59], v[0:3]
  v_mfma_f32_16x16x32_bf16 v[20:23], v[44:47], v[56:59], v[20:23]
  s_add_u32 s37, s73, 11
  s_and_b32 s37, s37, 15
  s_lshl_b32 s38, s37, 18
  s_lshl_b32 s37, s37, 6
  s_add_u32 m0, s71, 142336
  s_add_u32 s60, s70, s38
  buffer_load_dwordx4 v100, s[16:19], s60 offen lds
  v_mfma_f32_16x16x32_bf16 v[4:7], v[40:43], v[60:63], v[4:7]
  v_mfma_f32_16x16x32_bf16 v[24:27], v[44:47], v[60:63], v[24:27]
  s_add_u32 m0, s71, 143360
  s_add_u32 s60, s60, 32768
  buffer_load_dwordx4 v100, s[16:19], s60 offen lds
  v_mfma_f32_16x16x32_bf16 v[8:11], v[40:43], v[64:67], v[8:11]
  v_mfma_f32_16x16x32_bf16 v[28:31], v[44:47], v[64:67], v[28:31]
  v_mfma_f32_16x16x32_bf16 v[12:15], v[40:43], v[68:71], v[12:15]
  v_mfma_f32_16x16x32_bf16 v[32:35], v[44:47], v[68:71], v[32:35]
  v_mfma_f32_16x16x32_bf16 v[16:19], v[40:43], v[72:75], v[16:19]
  v_mfma_f32_16x16x32_bf16 v[36:39], v[44:47], v[72:75], v[36:39]
  s_waitcnt vmcnt(2)
  s_waitcnt lgkmcnt(0)
  s_barrier
  ds_read_b64_tr_b16 v[40:41], v243 offset:26624
  ds_read_b64_tr_b16 v[42:43], v243 offset:27648
  ds_read_b64_tr_b16 v[44:45], v243 offset:26632
  ds_read_b64_tr_b16 v[46:47], v243 offset:27656
  ds_read_b128 v[56:59], v245 offset:17408
  ds_read_b128 v[60:63], v245 offset:18432
  ds_read_b128 v[64:67], v245 offset:19456
  ds_read_b128 v[68:71], v245 offset:20480
  ds_read_b128 v[72:75], v245 offset:21504
  v_mfma_f32_16x16x32_bf16 v[0:3], v[48:51], v[76:79], v[0:3]
  v_mfma_f32_16x16x32_bf16 v[20:23], v[52:55], v[76:79], v[20:23]
  s_add_u32 s37, s73, 12
  s_and_b32 s37, s37, 15
  s_lshl_b32 s38, s37, 18
  s_lshl_b32 s37, s37, 6
  s_add_u32 m0, s71, 107520
  s_add_u32 s60, s70, s38
  buffer_load_dwordx4 v100, s[16:19], s60 offen lds
  v_mfma_f32_16x16x32_bf16 v[4:7], v[48:51], v[80:83], v[4:7]
  v_mfma_f32_16x16x32_bf16 v[24:27], v[52:55], v[80:83], v[24:27]
  s_add_u32 m0, s71, 108544
  s_add_u32 s60, s60, 32768
  buffer_load_dwordx4 v100, s[16:19], s60 offen lds
  v_mfma_f32_16x16x32_bf16 v[8:11], v[48:51], v[84:87], v[8:11]
  v_mfma_f32_16x16x32_bf16 v[28:31], v[52:55], v[84:87], v[28:31]
  v_mfma_f32_16x16x32_bf16 v[12:15], v[48:51], v[88:91], v[12:15]
  v_mfma_f32_16x16x32_bf16 v[32:35], v[52:55], v[88:91], v[32:35]
  v_mfma_f32_16x16x32_bf16 v[16:19], v[48:51], v[92:95], v[16:19]
  v_mfma_f32_16x16x32_bf16 v[36:39], v[52:55], v[92:95], v[36:39]
  s_waitcnt vmcnt(2)
  s_waitcnt lgkmcnt(0)
  s_barrier
  ds_read_b64_tr_b16 v[48:49], v243 offset:44032
  ds_read_b64_tr_b16 v[50:51], v243 offset:45056
  ds_read_b64_tr_b16 v[52:53], v243 offset:44040
  ds_read_b64_tr_b16 v[54:55], v243 offset:45064
  ds_read_b128 v[76:79], v245 offset:34816
  ds_read_b128 v[80:83], v245 offset:35840
  ds_read_b128 v[84:87], v245 offset:36864
  ds_read_b128 v[88:91], v245 offset:37888
  ds_read_b128 v[92:95], v245 offset:38912
  v_mfma_f32_16x16x32_bf16 v[0:3], v[40:43], v[56:59], v[0:3]
  v_mfma_f32_16x16x32_bf16 v[20:23], v[44:47], v[56:59], v[20:23]
  s_add_u32 s37, s73, 13
  s_and_b32 s37, s37, 15
  s_lshl_b32 s38, s37, 18
  s_lshl_b32 s37, s37, 6
  s_add_u32 m0, s71, 124928
  s_add_u32 s60, s70, s38
  buffer_load_dwordx4 v100, s[16:19], s60 offen lds
  v_mfma_f32_16x16x32_bf16 v[4:7], v[40:43], v[60:63], v[4:7]
  v_mfma_f32_16x16x32_bf16 v[24:27], v[44:47], v[60:63], v[24:27]
  s_add_u32 m0, s71, 125952
  s_add_u32 s60, s60, 32768
  buffer_load_dwordx4 v100, s[16:19], s60 offen lds
  v_mfma_f32_16x16x32_bf16 v[8:11], v[40:43], v[64:67], v[8:11]
  v_mfma_f32_16x16x32_bf16 v[28:31], v[44:47], v[64:67], v[28:31]
  v_mfma_f32_16x16x32_bf16 v[12:15], v[40:43], v[68:71], v[12:15]
  v_mfma_f32_16x16x32_bf16 v[32:35], v[44:47], v[68:71], v[32:35]
  v_mfma_f32_16x16x32_bf16 v[16:19], v[40:43], v[72:75], v[16:19]
  v_mfma_f32_16x16x32_bf16 v[36:39], v[44:47], v[72:75], v[36:39]
  s_waitcnt vmcnt(2)
  s_waitcnt lgkmcnt(0)
  s_barrier
  ds_read_b64_tr_b16 v[40:41], v243 offset:9216
  ds_read_b64_tr_b16 v[42:43], v243 offset:10240
  ds_read_b64_tr_b16 v[44:45], v243 offset:9224
  ds_read_b64_tr_b16 v[46:47], v243 offset:10248
  ds_read_b128 v[56:59], v245 offset:0
  ds_read_b128 v[60:63], v245 offset:1024
  ds_read_b128 v[64:67], v245 offset:2048
  ds_read_b128 v[68:71], v245 offset:3072
  ds_read_b128 v[72:75], v245 offset:4096
  v_mfma_f32_16x16x32_bf16 v[0:3], v[48:51], v[76:79], v[0:3]
  v_mfma_f32_16x16x32_bf16 v[20:23], v[52:55], v[76:79], v[20:23]
  s_add_u32 s37, s73, 14
  s_and_b32 s37, s37, 15
  s_lshl_b32 s38, s37, 18
  s_lshl_b32 s37, s37, 6
  s_add_u32 m0, s71, 142336
  s_add_u32 s60, s70, s38
  buffer_load_dwordx4 v100, s[16:19], s60 offen lds
  v_mfma_f32_16x16x32_bf16 v[4:7], v[48:51], v[80:83], v[4:7]
  v_mfma_f32_16x16x32_bf16 v[24:27], v[52:55], v[80:83], v[24:27]
  s_add_u32 m0, s71, 143360
  s_add_u32 s60, s60, 32768
  buffer_load_dwordx4 v100, s[16:19], s60 offen lds
  v_mfma_f32_16x16x32_bf16 v[8:11], v[48:51], v[84:87], v[8:11]
  v_mfma_f32_16x16x32_bf16 v[28:31], v[52:55], v[84:87], v[28:31]
  v_mfma_f32_16x16x32_bf16 v[12:15], v[48:51], v[88:91], v[12:15]
  v_mfma_f32_16x16x32_bf16 v[32:35], v[52:55], v[88:91], v[32:35]
  v_mfma_f32_16x16x32_bf16 v[16:19], v[48:51], v[92:95], v[16:19]
  v_mfma_f32_16x16x32_bf16 v[36:39], v[52:55], v[92:95], v[36:39]
  s_waitcnt vmcnt(2)
  s_waitcnt lgkmcnt(0)
  s_barrier
  ds_read_b64_tr_b16 v[48:49], v243 offset:26624
  ds_read_b64_tr_b16 v[50:51], v243 offset:27648
  ds_read_b64_tr_b16 v[52:53], v243 offset:26632
  ds_read_b64_tr_b16 v[54:55], v243 offset:27656
  ds_read_b128 v[76:79], v245 offset:17408
  ds_read_b128 v[80:83], v245 offset:18432
  ds_read_b128 v[84:87], v245 offset:19456
  ds_read_b128 v[88:91], v245 offset:20480
  ds_read_b128 v[92:95], v245 offset:21504
  v_mfma_f32_16x16x32_bf16 v[0:3], v[40:43], v[56:59], v[0:3]
  v_mfma_f32_16x16x32_bf16 v[20:23], v[44:47], v[56:59], v[20:23]
  s_add_u32 s37, s73, 15
  s_and_b32 s37, s37, 15
  s_lshl_b32 s38, s37, 18
  s_lshl_b32 s37, s37, 6
  s_add_u32 m0, s71, 107520
  s_add_u32 s60, s70, s38
  buffer_load_dwordx4 v100, s[16:19], s60 offen lds
  v_mfma_f32_16x16x32_bf16 v[4:7], v[40:43], v[60:63], v[4:7]
  v_mfma_f32_16x16x32_bf16 v[24:27], v[44:47], v[60:63], v[24:27]
  s_add_u32 m0, s71, 108544
  s_add_u32 s60, s60, 32768
  buffer_load_dwordx4 v100, s[16:19], s60 offen lds
  v_mfma_f32_16x16x32_bf16 v[8:11], v[40:43], v[64:67], v[8:11]
  v_mfma_f32_16x16x32_bf16 v[28:31], v[44:47], v[64:67], v[28:31]
  v_mfma_f32_16x16x32_bf16 v[12:15], v[40:43], v[68:71], v[12:15]
  v_mfma_f32_16x16x32_bf16 v[32:35], v[44:47], v[68:71], v[32:35]
  v_mfma_f32_16x16x32_bf16 v[16:19], v[40:43], v[72:75], v[16:19]
  v_mfma_f32_16x16x32_bf16 v[36:39], v[44:47], v[72:75], v[36:39]
  s_waitcnt vmcnt(2)
  s_waitcnt lgkmcnt(0)
  s_barrier
  ds_read_b64_tr_b16 v[40:41], v243 offset:44032
  ds_read_b64_tr_b16 v[42:43], v243 offset:45056
  ds_read_b64_tr_b16 v[44:45], v243 offset:44040
  ds_read_b64_tr_b16 v[46:47], v243 offset:45064
  ds_read_b128 v[56:59], v245 offset:34816
  ds_read_b128 v[60:63], v245 offset:35840
  ds_read_b128 v[64:67], v245 offset:36864
  ds_read_b128 v[68:71], v245 offset:37888
  ds_read_b128 v[72:75], v245 offset:38912
  v_mfma_f32_16x16x32_bf16 v[0:3], v[48:51], v[76:79], v[0:3]
  v_mfma_f32_16x16x32_bf16 v[20:23], v[52:55], v[76:79], v[20:23]
  v_mfma_f32_16x16x32_bf16 v[4:7], v[48:51], v[80:83], v[4:7]
  v_mfma_f32_16x16x32_bf16 v[24:27], v[52:55], v[80:83], v[24:27]
  v_mfma_f32_16x16x32_bf16 v[8:11], v[48:51], v[84:87], v[8:11]
  v_mfma_f32_16x16x32_bf16 v[28:31], v[52:55], v[84:87], v[28:31]
  v_mfma_f32_16x16x32_bf16 v[12:15], v[48:51], v[88:91], v[12:15]
  v_mfma_f32_16x16x32_bf16 v[32:35], v[52:55], v[88:91], v[32:35]
  v_mfma_f32_16x16x32_bf16 v[16:19], v[48:51], v[92:95], v[16:19]
  v_mfma_f32_16x16x32_bf16 v[36:39], v[52:55], v[92:95], v[36:39]
  s_waitcnt vmcnt(0)
  s_waitcnt lgkmcnt(0)
  s_barrier
  ds_read_b64_tr_b16 v[48:49], v243 offset:9216
  ds_read_b64_tr_b16 v[50:51], v243 offset:10240
  ds_read_b64_tr_b16 v[52:53], v243 offset:9224
  ds_read_b64_tr_b16 v[54:55], v243 offset:10248
  ds_read_b128 v[76:79], v245 offset:0
  ds_read_b128 v[80:83], v245 offset:1024
  ds_read_b128 v[84:87], v245 offset:2048
  ds_read_b128 v[88:91], v245 offset:3072
  ds_read_b128 v[92:95], v245 offset:4096
  s_cmp_eq_u32 s24, 0
  s_cbranch_scc0 L10
  s_lshl_b32 s60, s39, 12
  s_add_u32 s61, s28, s60
  s_add_u32 s62, s27, s60
  s_mov_b32 m0, s61
  s_nop 0
  buffer_load_dwordx4 v240, s[4:7], s62 offen offset:0 nt lds
  buffer_load_dwordx4 v241, s[4:7], s62 offen offset:1024 nt lds
  buffer_load_dwordx4 v240, s[4:7], s62 offen offset:2048 nt lds
  buffer_load_dwordx4 v241, s[4:7], s62 offen offset:3072 nt lds
  s_add_u32 m0, s61, 16384
  s_nop 0
  buffer_load_dwordx4 v240, s[8:11], s62 offen offset:0 nt lds
  buffer_load_dwordx4 v241, s[8:11], s62 offen offset:1024 nt lds
  buffer_load_dwordx4 v240, s[8:11], s62 offen offset:2048 nt lds
  buffer_load_dwordx4 v241, s[8:11], s62 offen offset:3072 nt lds
  s_add_u32 s28, s28, 32768
  s_cmp_eq_u32 s28, 131072
  s_cselect_b32 s28, 0, s28
  s_add_u32 s27, s27, 16384
  s_cmp_lg_u32 s27, 262144
  s_cbranch_scc1 L11
  s_mov_b32 s27, 0
  s_mov_b32 s4, s42
  s_mov_b32 s5, s43
  s_mov_b32 s8, s46
  s_mov_b32 s9, s47
  s_add_u32 s29, s29, 1
  s_cmp_eq_u32 s29, 1
  s_cselect_b32 s6, 262144, 0
  s_cselect_b32 s10, 262144, 0
L11:
  s_lshl_b32 s60, s39, 12
  s_add_u32 s61, s28, s60
  s_add_u32 s62, s27, s60
  s_mov_b32 m0, s61
  s_nop 0
  buffer_load_dwordx4 v240, s[4:7], s62 offen offset:0 nt lds
  buffer_load_dwordx4 v241, s[4:7], s62 offen offset:1024 nt lds
  buffer_load_dwordx4 v240, s[4:7], s62 offen offset:2048 nt lds
  buffer_load_dwordx4 v241, s[4:7], s62 offen offset:3072 nt lds
  s_add_u32 m0, s61, 16384
  s_nop 0
  buffer_load_dwordx4 v240, s[8:11], s62 offen offset:0 nt lds
  buffer_load_dwordx4 v241, s[8:11], s62 offen offset:1024 nt lds
  buffer_load_dwordx4 v240, s[8:11], s62 offen offset:2048 nt lds
  buffer_load_dwordx4 v241, s[8:11], s62 offen offset:3072 nt lds
  s_add_u32 s28, s28, 32768
  s_cmp_eq_u32 s28, 131072
  s_cselect_b32 s28, 0, s28
  s_add_u32 s27, s27, 16384
  s_cmp_lg_u32 s27, 262144
  s_cbranch_scc1 L12
  s_mov_b32 s27, 0
  s_mov_b32 s4, s42
  s_mov_b32 s5, s43
  s_mov_b32 s8, s46
  s_mov_b32 s9, s47
  s_add_u32 s29, s29, 1
  s_cmp_eq_u32 s29, 1
  s_cselect_b32 s6, 262144, 0
  s_cselect_b32 s10, 262144, 0
L12:
  s_lshl_b32 s60, s39, 12
  s_add_u32 s61, s28, s60
  s_add_u32 s62, s27, s60
  s_mov_b32 m0, s61
  s_nop 0
  buffer_load_dwordx4 v240, s[4:7], s62 offen offset:0 nt lds
  buffer_load_dwordx4 v241, s[4:7], s62 offen offset:1024 nt lds
  buffer_load_dwordx4 v240, s[4:7], s62 offen offset:2048 nt lds
  buffer_load_dwordx4 v241, s[4:7], s62 offen offset:3072 nt lds
  s_add_u32 m0, s61, 16384
  s_nop 0
  buffer_load_dwordx4 v240, s[8:11], s62 offen offset:0 nt lds
  buffer_load_dwordx4 v241, s[8:11], s62 offen offset:1024 nt lds
  buffer_load_dwordx4 v240, s[8:11], s62 offen offset:2048 nt lds
  buffer_load_dwordx4 v241, s[8:11], s62 offen offset:3072 nt lds
  s_add_u32 s28, s28, 32768
  s_cmp_eq_u32 s28, 131072
  s_cselect_b32 s28, 0, s28
  s_add_u32 s27, s27, 16384
  s_cmp_lg_u32 s27, 262144
  s_cbranch_scc1 L13
  s_mov_b32 s27, 0
  s_mov_b32 s4, s42
  s_mov_b32 s5, s43
  s_mov_b32 s8, s46
  s_mov_b32 s9, s47
  s_add_u32 s29, s29, 1
  s_cmp_eq_u32 s29, 1
  s_cselect_b32 s6, 262144, 0
  s_cselect_b32 s10, 262144, 0
L13:
L10:
  v_mfma_f32_16x16x32_bf16 v[0:3], v[40:43], v[56:59], v[0:3]
  v_mfma_f32_16x16x32_bf16 v[20:23], v[44:47], v[56:59], v[20:23]
  v_mfma_f32_16x16x32_bf16 v[4:7], v[40:43], v[60:63], v[4:7]
  v_mfma_f32_16x16x32_bf16 v[24:27], v[44:47], v[60:63], v[24:27]
  v_mfma_f32_16x16x32_bf16 v[8:11], v[40:43], v[64:67], v[8:11]
  v_mfma_f32_16x16x32_bf16 v[28:31], v[44:47], v[64:67], v[28:31]
  v_mfma_f32_16x16x32_bf16 v[12:15], v[40:43], v[68:71], v[12:15]
  v_mfma_f32_16x16x32_bf16 v[32:35], v[44:47], v[68:71], v[32:35]
  v_mfma_f32_16x16x32_bf16 v[16:19], v[40:43], v[72:75], v[16:19]
  v_mfma_f32_16x16x32_bf16 v[36:39], v[44:47], v[72:75], v[36:39]
  s_waitcnt lgkmcnt(0)
  v_mfma_f32_16x16x32_bf16 v[0:3], v[48:51], v[76:79], v[0:3]
  v_mfma_f32_16x16x32_bf16 v[20:23], v[52:55], v[76:79], v[20:23]
  v_mfma_f32_16x16x32_bf16 v[4:7], v[48:51], v[80:83], v[4:7]
  v_mfma_f32_16x16x32_bf16 v[24:27], v[52:55], v[80:83], v[24:27]
  v_mfma_f32_16x16x32_bf16 v[8:11], v[48:51], v[84:87], v[8:11]
  v_mfma_f32_16x16x32_bf16 v[28:31], v[52:55], v[84:87], v[28:31]
  v_mfma_f32_16x16x32_bf16 v[12:15], v[48:51], v[88:91], v[12:15]
  v_mfma_f32_16x16x32_bf16 v[32:35], v[52:55], v[88:91], v[32:35]
  v_mfma_f32_16x16x32_bf16 v[16:19], v[48:51], v[92:95], v[16:19]
  v_mfma_f32_16x16x32_bf16 v[36:39], v[52:55], v[92:95], v[36:39]
  s_barrier
  s_and_b32 s60, s3, 3
  s_lshl_b32 s60, s60, 10
  s_add_u32 s60, s60, 98304
  v_add_u32 v245, s60, v242
  v_mul_f32 v0, s65, v0
  v_mul_f32 v1, s65, v1
  v_mul_f32 v2, s65, v2
  v_mul_f32 v3, s65, v3
  v_mul_f32 v20, s65, v20
  v_mul_f32 v21, s65, v21
  v_mul_f32 v22, s65, v22
  v_mul_f32 v23, s65, v23
  v_cvt_pk_bf16_f32 v40, v0, v1
  v_cvt_pk_bf16_f32 v41, v2, v3
  v_cvt_pk_bf16_f32 v42, v20, v21
  v_cvt_pk_bf16_f32 v43, v22, v23
  ds_write_b128 v245, v[40:43] offset:0
  v_mul_f32 v4, s65, v4
  v_mul_f32 v5, s65, v5
  v_mul_f32 v6, s65, v6
  v_mul_f32 v7, s65, v7
  v_mul_f32 v24, s65, v24
  v_mul_f32 v25, s65, v25
  v_mul_f32 v26, s65, v26
  v_mul_f32 v27, s65, v27
  v_cvt_pk_bf16_f32 v44, v4, v5
  v_cvt_pk_bf16_f32 v45, v6, v7
  v_cvt_pk_bf16_f32 v46, v24, v25
  v_cvt_pk_bf16_f32 v47, v26, v27
  ds_write_b128 v245, v[44:47] offset:4096
  v_mul_f32 v8, s65, v8
  v_mul_f32 v9, s65, v9
  v_mul_f32 v10, s65, v10
  v_mul_f32 v11, s65, v11
  v_mul_f32 v28, s65, v28
  v_mul_f32 v29, s65, v29
  v_mul_f32 v30, s65, v30
  v_mul_f32 v31, s65, v31
  v_cvt_pk_bf16_f32 v48, v8, v9
  v_cvt_pk_bf16_f32 v49, v10, v11
  v_cvt_pk_bf16_f32 v50, v28, v29
  v_cvt_pk_bf16_f32 v51, v30, v31
  ds_write_b128 v245, v[48:51] offset:8192
  v_mul_f32 v12, s65, v12
  v_mul_f32 v13, s65, v13
  v_mul_f32 v14, s65, v14
  v_mul_f32 v15, s65, v15
  v_mul_f32 v32, s65, v32
  v_mul_f32 v33, s65, v33
  v_mul_f32 v34, s65, v34
  v_mul_f32 v35, s65, v35
  v_cvt_pk_bf16_f32 v52, v12, v13
  v_cvt_pk_bf16_f32 v53, v14, v15
  v_cvt_pk_bf16_f32 v54, v32, v33
  v_cvt_pk_bf16_f32 v55, v34, v35
  ds_write_b128 v245, v[52:55] offset:12288
  v_mul_f32 v16, s65, v16
  v_mul_f32 v17, s65, v17
  v_mul_f32 v18, s65, v18
  v_mul_f32 v19, s65, v19
  v_mul_f32 v36, s65, v36
  v_mul_f32 v37, s65, v37
  v_mul_f32 v38, s65, v38
  v_mul_f32 v39, s65, v39
  v_cvt_pk_bf16_f32 v56, v16, v17
  v_cvt_pk_bf16_f32 v57, v18, v19
  v_cvt_pk_bf16_f32 v58, v36, v37
  v_cvt_pk_bf16_f32 v59, v38, v39
  ds_write_b128 v245, v[56:59] offset:16384
  s_waitcnt lgkmcnt(0)
  s_barrier
  s_cmp_lg_u32 s58, s24
  s_cbranch_scc1 INIT_B
  s_lshl_b32 s60, s35, 12
  s_add_u32 s60, s60, 98304
  v_add_u32 v245, s60, v242
  ds_read_b128 v[108:111], v245 offset:0
  ds_read_b128 v[112:115], v245 offset:1024
  ds_read_b128 v[116:119], v245 offset:2048
  ds_read_b128 v[120:123], v245 offset:3072
  ds_read_b128 v[124:127], v245 offset:4096
  ds_read_b128 v[128:131], v245 offset:5120
  ds_read_b128 v[132:135], v245 offset:6144
  ds_read_b128 v[136:139], v245 offset:7168
  s_cmp_eq_u32 s26, 0
  s_cbranch_scc1 INIT_B
  s_waitcnt lgkmcnt(0)
  s_barrier
  s_mov_b32 s58, 1
  s_branch QP_B
INIT_B:
  v_mov_b32 v0, 0
  v_mov_b32 v1, 0
  v_mov_b32 v2, 0
  v_mov_b32 v3, 0
  v_mov_b32 v4, 0
  v_mov_b32 v5, 0
  v_mov_b32 v6, 0
  v_mov_b32 v7, 0
  v_mov_b32 v8, 0
  v_mov_b32 v9, 0
  v_mov_b32 v10, 0
  v_mov_b32 v11, 0
  v_mov_b32 v12, 0
  v_mov_b32 v13, 0
  v_mov_b32 v14, 0
  v_mov_b32 v15, 0
  v_mov_b32 v16, 0
  v_mov_b32 v17, 0
  v_mov_b32 v18, 0
  v_mov_b32 v19, 0
  v_mov_b32 v20, 0
  v_mov_b32 v21, 0
  v_mov_b32 v22, 0
  v_mov_b32 v23, 0
  v_mov_b32 v24, 0
  v_mov_b32 v25, 0
  v_mov_b32 v26, 0
  v_mov_b32 v27, 0
  v_mov_b32 v28, 0
  v_mov_b32 v29, 0
  v_mov_b32 v30, 0
  v_mov_b32 v31, 0
  v_mov_b32 v32, 0
  v_mov_b32 v33, 0
  v_mov_b32 v34, 0
  v_mov_b32 v35, 0
  v_mov_b32 v36, 0
  v_mov_b32 v37, 0
  v_mov_b32 v38, 0
  v_mov_b32 v39, 0
  v_mov_b32 v40, 0
  v_mov_b32 v41, 0
  v_mov_b32 v42, 0
  v_mov_b32 v43, 0
  v_mov_b32 v44, 0
  v_mov_b32 v45, 0
  v_mov_b32 v46, 0
  v_mov_b32 v47, 0
  v_mov_b32 v48, 0
  v_mov_b32 v49, 0
  v_mov_b32 v50, 0
  v_mov_b32 v51, 0
  v_mov_b32 v52, 0
  v_mov_b32 v53, 0
  v_mov_b32 v54, 0
  v_mov_b32 v55, 0
  v_mov_b32 v56, 0
  v_mov_b32 v57, 0
  v_mov_b32 v58, 0
  v_mov_b32 v59, 0
  v_mov_b32 v60, 0
  v_mov_b32 v61, 0
  v_mov_b32 v62, 0
  v_mov_b32 v63, 0
  v_mov_b32 v96, 0
  v_mov_b32 v180, 0
  v_mov_b32 v97, 0
  v_mov_b32 v181, 0
  v_mov_b32 v98, 0
  v_mov_b32 v182, 0
  v_mov_b32 v99, 0
  v_mov_b32 v183, 0
  v_mov_b32 v100, 0
  v_mov_b32 v184, 0
  v_mov_b32 v101, 0
  v_mov_b32 v185, 0
  v_mov_b32 v102, 0
  v_mov_b32 v186, 0
  v_mov_b32 v103, 0
  v_mov_b32 v187, 0
  s_waitcnt vmcnt(16)
  s_waitcnt lgkmcnt(0)
  s_barrier
  ds_read_b128 v[192:195], v224 offset:0
  ds_read_b128 v[196:199], v225 offset:0
  ds_read_b128 v[200:203], v226 offset:0
  ds_read_b128 v[204:207], v227 offset:0
  ds_read_b128 v[208:211], v224 offset:4096
  ds_read_b128 v[212:215], v225 offset:4096
  ds_read_b128 v[216:219], v226 offset:4096
  ds_read_b128 v[220:223], v227 offset:4096
  s_waitcnt lgkmcnt(7)
  v_mfma_f32_16x16x32_bf16 v[156:159], v[192:195], v[108:111], v[180:183]
  v_mfma_f32_16x16x32_bf16 v[164:167], v[192:195], v[124:127], v[184:187]
  s_lshl_b32 s60, s39, 12
  s_add_u32 s61, s28, s60
  s_add_u32 s62, s27, s60
  s_mov_b32 m0, s61
  s_nop 0
  buffer_load_dwordx4 v240, s[4:7], s62 offen offset:0 nt lds
  s_waitcnt lgkmcnt(6)
  v_mfma_f32_16x16x32_bf16 v[156:159], v[196:199], v[112:115], v[156:159]
  v_mfma_f32_16x16x32_bf16 v[164:167], v[196:199], v[128:131], v[164:167]
  ds_read_b64_tr_b16 v[192:193], v228 offset:0
  ds_read_b64_tr_b16 v[194:195], v228 offset:4096
  buffer_load_dwordx4 v241, s[4:7], s62 offen offset:1024 nt lds
  s_waitcnt lgkmcnt(7)
  v_mfma_f32_16x16x32_bf16 v[156:159], v[200:203], v[116:119], v[156:159]
  v_mfma_f32_16x16x32_bf16 v[164:167], v[200:203], v[132:135], v[164:167]
  ds_read_b64_tr_b16 v[196:197], v229 offset:0
  ds_read_b64_tr_b16 v[198:199], v229 offset:4096
  buffer_load_dwordx4 v240, s[4:7], s62 offen offset:2048 nt lds
  s_waitcnt lgkmcnt(8)
  v_mfma_f32_16x16x32_bf16 v[156:159], v[204:207], v[120:123], v[156:159]
  v_mfma_f32_16x16x32_bf16 v[164:167], v[204:207], v[136:139], v[164:167]
  ds_read_b64_tr_b16 v[200:201], v230 offset:0
  ds_read_b64_tr_b16 v[202:203], v230 offset:4096
  buffer_load_dwordx4 v241, s[4:7], s62 offen offset:3072 nt lds
  s_waitcnt lgkmcnt(9)
  v_mfma_f32_16x16x32_bf16 v[160:163], v[208:211], v[108:111], v[180:183]
  v_mfma_f32_16x16x32_bf16 v[168:171], v[208:211], v[124:127], v[184:187]
  ds_read_b64_tr_b16 v[204:205], v231 offset:0
  ds_read_b64_tr_b16 v[206:207], v231 offset:4096
  s_add_u32 m0, s61, 16384
  s_nop 0
  buffer_load_dwordx4 v240, s[8:11], s62 offen offset:0 nt lds
  s_waitcnt lgkmcnt(10)
  v_mfma_f32_16x16x32_bf16 v[160:163], v[212:215], v[112:115], v[160:163]
  v_mfma_f32_16x16x32_bf16 v[168:171], v[212:215], v[128:131], v[168:171]
  ds_read_b64_tr_b16 v[208:209], v232 offset:0
  ds_read_b64_tr_b16 v[210:211], v232 offset:4096
  buffer_load_dwordx4 v241, s[8:11], s62 offen offset:1024 nt lds
  s_waitcnt lgkmcnt(11)
  v_mfma_f32_16x16x32_bf16 v[160:163], v[216:219], v[116:119], v[160:163]
  v_mfma_f32_16x16x32_bf16 v[168:171], v[216:219], v[132:135], v[168:171]
  ds_read_b64_tr_b16 v[212:213], v233 offset:0
  ds_read_b64_tr_b16 v[214:215], v233 offset:4096
  buffer_load_dwordx4 v240, s[8:11], s62 offen offset:2048 nt lds
  s_waitcnt lgkmcnt(12)
  v_mfma_f32_16x16x32_bf16 v[160:163], v[220:223], v[120:123], v[160:163]
  v_mfma_f32_16x16x32_bf16 v[168:171], v[220:223], v[136:139], v[168:171]
  ds_read_b64_tr_b16 v[216:217], v234 offset:0
  ds_read_b64_tr_b16 v[218:219], v234 offset:4096
  buffer_load_dwordx4 v241, s[8:11], s62 offen offset:3072 nt lds
  s_add_u32 s28, s28, 32768
  s_cmp_eq_u32 s28, 131072
  s_cselect_b32 s28, 0, s28
  s_add_u32 s27, s27, 16384
  s_cmp_lg_u32 s27, 262144
  s_cbranch_scc1 L14
  s_mov_b32 s27, 0
  s_mov_b32 s4, s42
  s_mov_b32 s5, s43
  s_mov_b32 s8, s46
  s_mov_b32 s9, s47
  s_add_u32 s29, s29, 1
  s_cmp_eq_u32 s29, 1
  s_cselect_b32 s6, 262144, 0
  s_cselect_b32 s10, 262144, 0
L14:
  s_add_u32 s31, s31, 1
  s_cmp_eq_u32 s31, 4
  s_cselect_b32 s31, 0, s31
  s_mov_b32 s30, 32768
  s_cselect_b32 s30, 0xfffe8000, s30
  v_add_u32 v224, s30, v224
  v_add_u32 v225, s30, v225
  v_add_u32 v226, s30, v226
  v_add_u32 v227, s30, v227
  ds_read_b64_tr_b16 v[220:221], v235 offset:0
  ds_read_b64_tr_b16 v[222:223], v235 offset:4096
  v_xor_b32 v245, 16, v244
  v_lshlrev_b32 v245, 2, v245
  v_xor_b32 v246, 32, v244
  v_lshlrev_b32 v246, 2, v246
  v_max3_f32 v247, v156, v157, v158
  v_max3_f32 v247, v247, v159, v160
  v_max3_f32 v247, v247, v161, v162
  v_max_f32 v247, v247, v163
  ds_bpermute_b32 v252, v245, v247
  s_waitcnt lgkmcnt(0)
  v_max_f32 v247, v247, v252
  ds_bpermute_b32 v252, v246, v247
  s_waitcnt lgkmcnt(0)
  v_max_f32 v247, v247, v252
  v_sub_f32 v156, v156, v247
  v_sub_f32 v157, v157, v247
  v_sub_f32 v158, v158, v247
  v_sub_f32 v159, v159, v247
  v_sub_f32 v160, v160, v247
  v_sub_f32 v161, v161, v247
  v_sub_f32 v162, v162, v247
  v_sub_f32 v163, v163, v247
  v_sub_f32 v180, v180, v247
  v_sub_f32 v181, v181, v247
  v_sub_f32 v182, v182, v247
  v_sub_f32 v183, v183, v247
  v_max3_f32 v248, v164, v165, v166
  v_max3_f32 v248, v248, v167, v168
  v_max3_f32 v248, v248, v169, v170
  v_max_f32 v248, v248, v171
  ds_bpermute_b32 v252, v245, v248
  s_waitcnt lgkmcnt(0)
  v_max_f32 v248, v248, v252
  ds_bpermute_b32 v252, v246, v248
  s_waitcnt lgkmcnt(0)
  v_max_f32 v248, v248, v252
  v_sub_f32 v164, v164, v248
  v_sub_f32 v165, v165, v248
  v_sub_f32 v166, v166, v248
  v_sub_f32 v167, v167, v248
  v_sub_f32 v168, v168, v248
  v_sub_f32 v169, v169, v248
  v_sub_f32 v170, v170, v248
  v_sub_f32 v171, v171, v248
  v_sub_f32 v184, v184, v248
  v_sub_f32 v185, v185, v248
  v_sub_f32 v186, v186, v248
  v_sub_f32 v187, v187, v248
  v_exp_f32 v156, v156
  v_exp_f32 v157, v157
  v_exp_f32 v158, v158
  v_exp_f32 v159, v159
  v_exp_f32 v160, v160
  v_exp_f32 v161, v161
  v_exp_f32 v162, v162
  v_exp_f32 v163, v163
  v_cvt_pk_bf16_f32 v156, v156, v157
  v_cvt_pk_bf16_f32 v157, v158, v159
  v_cvt_pk_bf16_f32 v158, v160, v161
  v_cvt_pk_bf16_f32 v159, v162, v163
  v_exp_f32 v164, v164
  v_exp_f32 v165, v165
  v_exp_f32 v166, v166
  v_exp_f32 v167, v167
  v_exp_f32 v168, v168
  v_exp_f32 v169, v169
  v_exp_f32 v170, v170
  v_exp_f32 v171, v171
  v_cvt_pk_bf16_f32 v164, v164, v165
  v_cvt_pk_bf16_f32 v165, v166, v167
  v_cvt_pk_bf16_f32 v166, v168, v169
  v_cvt_pk_bf16_f32 v167, v170, v171
  s_waitcnt lgkmcnt(14)
  v_mfma_f32_16x16x32_bf16 v[0:3], v[192:195], v[156:159], v[0:3]
  v_mfma_f32_16x16x32_bf16 v[4:7], v[192:195], v[164:167], v[4:7]
  v_mfma_f32_16x16x32_bf16 v[96:99], v[236:239], v[156:159], v[96:99]
  v_mfma_f32_16x16x32_bf16 v[100:103], v[236:239], v[164:167], v[100:103]
  s_waitcnt lgkmcnt(12)
  v_mfma_f32_16x16x32_bf16 v[8:11], v[196:199], v[156:159], v[8:11]
  v_mfma_f32_16x16x32_bf16 v[12:15], v[196:199], v[164:167], v[12:15]
  s_waitcnt lgkmcnt(10)
  v_mfma_f32_16x16x32_bf16 v[16:19], v[200:203], v[156:159], v[16:19]
  v_mfma_f32_16x16x32_bf16 v[20:23], v[200:203], v[164:167], v[20:23]
  s_waitcnt lgkmcnt(8)
  v_mfma_f32_16x16x32_bf16 v[24:27], v[204:207], v[156:159], v[24:27]
  v_mfma_f32_16x16x32_bf16 v[28:31], v[204:207], v[164:167], v[28:31]
  s_waitcnt lgkmcnt(6)
  v_mfma_f32_16x16x32_bf16 v[32:35], v[208:211], v[156:159], v[32:35]
  v_mfma_f32_16x16x32_bf16 v[36:39], v[208:211], v[164:167], v[36:39]
  s_waitcnt lgkmcnt(4)
  v_mfma_f32_16x16x32_bf16 v[40:43], v[212:215], v[156:159], v[40:43]
  v_mfma_f32_16x16x32_bf16 v[44:47], v[212:215], v[164:167], v[44:47]
  s_waitcnt lgkmcnt(2)
  v_mfma_f32_16x16x32_bf16 v[48:51], v[216:219], v[156:159], v[48:51]
  v_mfma_f32_16x16x32_bf16 v[52:55], v[216:219], v[164:167], v[52:55]
  s_waitcnt lgkmcnt(0)
  v_mfma_f32_16x16x32_bf16 v[56:59], v[220:223], v[156:159], v[56:59]
  v_mfma_f32_16x16x32_bf16 v[60:63], v[220:223], v[164:167], v[60:63]
  v_add_u32 v228, s30, v228
  v_add_u32 v229, s30, v229
  v_add_u32 v230, s30, v230
  v_add_u32 v231, s30, v231
  v_add_u32 v232, s30, v232
  v_add_u32 v233, s30, v233
  v_add_u32 v234, s30, v234
  v_add_u32 v235, s30, v235
  s_mov_b32 s25, 1
LOOP_B:
  s_waitcnt vmcnt(16)
  s_waitcnt lgkmcnt(0)
  s_barrier
  ds_read_b128 v[192:195], v224 offset:0
  ds_read_b128 v[196:199], v225 offset:0
  ds_read_b128 v[200:203], v226 offset:0
  ds_read_b128 v[204:207], v227 offset:0
  ds_read_b128 v[208:211], v224 offset:4096
  ds_read_b128 v[212:215], v225 offset:4096
  ds_read_b128 v[216:219], v226 offset:4096
  ds_read_b128 v[220:223], v227 offset:4096
  s_waitcnt lgkmcnt(7)
  v_mfma_f32_16x16x32_bf16 v[156:159], v[192:195], v[108:111], v[180:183]
  v_mfma_f32_16x16x32_bf16 v[164:167], v[192:195], v[124:127], v[184:187]
  s_lshl_b32 s60, s39, 12
  s_add_u32 s61, s28, s60
  s_add_u32 s62, s27, s60
  s_mov_b32 m0, s61
  s_nop 0
  buffer_load_dwordx4 v240, s[4:7], s62 offen offset:0 nt lds
  s_waitcnt lgkmcnt(6)
  v_mfma_f32_16x16x32_bf16 v[156:159], v[196:199], v[112:115], v[156:159]
  v_mfma_f32_16x16x32_bf16 v[164:167], v[196:199], v[128:131], v[164:167]
  ds_read_b64_tr_b16 v[192:193], v228 offset:0
  ds_read_b64_tr_b16 v[194:195], v228 offset:4096
  buffer_load_dwordx4 v241, s[4:7], s62 offen offset:1024 nt lds
  s_waitcnt lgkmcnt(7)
  v_mfma_f32_16x16x32_bf16 v[156:159], v[200:203], v[116:119], v[156:159]
  v_mfma_f32_16x16x32_bf16 v[164:167], v[200:203], v[132:135], v[164:167]
  ds_read_b64_tr_b16 v[196:197], v229 offset:0
  ds_read_b64_tr_b16 v[198:199], v229 offset:4096
  buffer_load_dwordx4 v240, s[4:7], s62 offen offset:2048 nt lds
  s_waitcnt lgkmcnt(8)
  v_mfma_f32_16x16x32_bf16 v[156:159], v[204:207], v[120:123], v[156:159]
  v_mfma_f32_16x16x32_bf16 v[164:167], v[204:207], v[136:139], v[164:167]
  ds_read_b64_tr_b16 v[200:201], v230 offset:0
  ds_read_b64_tr_b16 v[202:203], v230 offset:4096
  buffer_load_dwordx4 v241, s[4:7], s62 offen offset:3072 nt lds
  s_waitcnt lgkmcnt(9)
  v_mfma_f32_16x16x32_bf16 v[160:163], v[208:211], v[108:111], v[180:183]
  v_mfma_f32_16x16x32_bf16 v[168:171], v[208:211], v[124:127], v[184:187]
  ds_read_b64_tr_b16 v[204:205], v231 offset:0
  ds_read_b64_tr_b16 v[206:207], v231 offset:4096
  s_add_u32 m0, s61, 16384
  s_nop 0
  buffer_load_dwordx4 v240, s[8:11], s62 offen offset:0 nt lds
  s_waitcnt lgkmcnt(10)
  v_mfma_f32_16x16x32_bf16 v[160:163], v[212:215], v[112:115], v[160:163]
  v_mfma_f32_16x16x32_bf16 v[168:171], v[212:215], v[128:131], v[168:171]
  ds_read_b64_tr_b16 v[208:209], v232 offset:0
  ds_read_b64_tr_b16 v[210:211], v232 offset:4096
  buffer_load_dwordx4 v241, s[8:11], s62 offen offset:1024 nt lds
  s_waitcnt lgkmcnt(11)
  v_mfma_f32_16x16x32_bf16 v[160:163], v[216:219], v[116:119], v[160:163]
  v_mfma_f32_16x16x32_bf16 v[168:171], v[216:219], v[132:135], v[168:171]
  ds_read_b64_tr_b16 v[212:213], v233 offset:0
  ds_read_b64_tr_b16 v[214:215], v233 offset:4096
  buffer_load_dwordx4 v240, s[8:11], s62 offen offset:2048 nt lds
  s_waitcnt lgkmcnt(12)
  v_mfma_f32_16x16x32_bf16 v[160:163], v[220:223], v[120:123], v[160:163]
  v_mfma_f32_16x16x32_bf16 v[168:171], v[220:223], v[136:139], v[168:171]
  ds_read_b64_tr_b16 v[216:217], v234 offset:0
  ds_read_b64_tr_b16 v[218:219], v234 offset:4096
  buffer_load_dwordx4 v241, s[8:11], s62 offen offset:3072 nt lds
  s_add_u32 s28, s28, 32768
  s_cmp_eq_u32 s28, 131072
  s_cselect_b32 s28, 0, s28
  s_add_u32 s27, s27, 16384
  s_cmp_lg_u32 s27, 262144
  s_cbranch_scc1 L15
  s_mov_b32 s27, 0
  s_mov_b32 s4, s42
  s_mov_b32 s5, s43
  s_mov_b32 s8, s46
  s_mov_b32 s9, s47
  s_add_u32 s29, s29, 1
  s_cmp_eq_u32 s29, 1
  s_cselect_b32 s6, 262144, 0
  s_cselect_b32 s10, 262144, 0
L15:
  s_add_u32 s31, s31, 1
  s_cmp_eq_u32 s31, 4
  s_cselect_b32 s31, 0, s31
  s_mov_b32 s30, 32768
  s_cselect_b32 s30, 0xfffe8000, s30
  v_add_u32 v224, s30, v224
  v_add_u32 v225, s30, v225
  v_add_u32 v226, s30, v226
  v_add_u32 v227, s30, v227
  v_max3_f32 v252, v156, v157, v158
  v_max3_f32 v252, v252, v159, v164
  v_max3_f32 v252, v252, v165, v166
  v_max3_f32 v252, v252, v167, v160
  v_max3_f32 v252, v252, v161, v162
  v_max3_f32 v252, v252, v163, v168
  v_max3_f32 v252, v252, v169, v170
  v_max_f32 v252, v252, v171
  v_cmp_lt_f32 vcc, s64, v252
  ds_read_b64_tr_b16 v[220:221], v235 offset:0
  ds_read_b64_tr_b16 v[222:223], v235 offset:4096
  s_nop 2
  s_cbranch_vccnz SLOW_B
BACK_B:
  v_exp_f32 v156, v156
  v_exp_f32 v157, v157
  v_exp_f32 v158, v158
  v_exp_f32 v159, v159
  v_exp_f32 v160, v160
  v_exp_f32 v161, v161
  v_exp_f32 v162, v162
  v_exp_f32 v163, v163
  v_cvt_pk_bf16_f32 v156, v156, v157
  v_cvt_pk_bf16_f32 v157, v158, v159
  v_cvt_pk_bf16_f32 v158, v160, v161
  v_cvt_pk_bf16_f32 v159, v162, v163
  v_exp_f32 v164, v164
  v_exp_f32 v165, v165
  v_exp_f32 v166, v166
  v_exp_f32 v167, v167
  v_exp_f32 v168, v168
  v_exp_f32 v169, v169
  v_exp_f32 v170, v170
  v_exp_f32 v171, v171
  v_cvt_pk_bf16_f32 v164, v164, v165
  v_cvt_pk_bf16_f32 v165, v166, v167
  v_cvt_pk_bf16_f32 v166, v168, v169
  v_cvt_pk_bf16_f32 v167, v170, v171
  s_waitcnt lgkmcnt(14)
  v_mfma_f32_16x16x32_bf16 v[0:3], v[192:195], v[156:159], v[0:3]
  v_mfma_f32_16x16x32_bf16 v[4:7], v[192:195], v[164:167], v[4:7]
  v_mfma_f32_16x16x32_bf16 v[96:99], v[236:239], v[156:159], v[96:99]
  v_mfma_f32_16x16x32_bf16 v[100:103], v[236:239], v[164:167], v[100:103]
  s_waitcnt lgkmcnt(12)
  v_mfma_f32_16x16x32_bf16 v[8:11], v[196:199], v[156:159], v[8:11]
  v_mfma_f32_16x16x32_bf16 v[12:15], v[196:199], v[164:167], v[12:15]
  s_waitcnt lgkmcnt(10)
  v_mfma_f32_16x16x32_bf16 v[16:19], v[200:203], v[156:159], v[16:19]
  v_mfma_f32_16x16x32_bf16 v[20:23], v[200:203], v[164:167], v[20:23]
  s_waitcnt lgkmcnt(8)
  v_mfma_f32_16x16x32_bf16 v[24:27], v[204:207], v[156:159], v[24:27]
  v_mfma_f32_16x16x32_bf16 v[28:31], v[204:207], v[164:167], v[28:31]
  s_waitcnt lgkmcnt(6)
  v_mfma_f32_16x16x32_bf16 v[32:35], v[208:211], v[156:159], v[32:35]
  v_mfma_f32_16x16x32_bf16 v[36:39], v[208:211], v[164:167], v[36:39]
  s_waitcnt lgkmcnt(4)
  v_mfma_f32_16x16x32_bf16 v[40:43], v[212:215], v[156:159], v[40:43]
  v_mfma_f32_16x16x32_bf16 v[44:47], v[212:215], v[164:167], v[44:47]
  s_waitcnt lgkmcnt(2)
  v_mfma_f32_16x16x32_bf16 v[48:51], v[216:219], v[156:159], v[48:51]
  v_mfma_f32_16x16x32_bf16 v[52:55], v[216:219], v[164:167], v[52:55]
  s_waitcnt lgkmcnt(0)
  v_mfma_f32_16x16x32_bf16 v[56:59], v[220:223], v[156:159], v[56:59]
  v_mfma_f32_16x16x32_bf16 v[60:63], v[220:223], v[164:167], v[60:63]
  v_add_u32 v228, s30, v228
  v_add_u32 v229, s30, v229
  v_add_u32 v230, s30, v230
  v_add_u32 v231, s30, v231
  v_add_u32 v232, s30, v232
  v_add_u32 v233, s30, v233
  v_add_u32 v234, s30, v234
  v_add_u32 v235, s30, v235
  s_add_u32 s25, s25, 1
  s_cmp_lt_u32 s25, 16
  s_cbranch_scc1 LOOP_B
  s_cmp_gt_u32 s26, s24
  s_cbranch_scc0 L16
  s_lshl_b32 s60, s35, 12
  s_add_u32 s60, s60, 98304
  v_add_u32 v245, s60, v242
  ds_read_b128 v[108:111], v245 offset:0
  ds_read_b128 v[112:115], v245 offset:1024
  ds_read_b128 v[116:119], v245 offset:2048
  ds_read_b128 v[120:123], v245 offset:3072
  ds_read_b128 v[124:127], v245 offset:4096
  ds_read_b128 v[128:131], v245 offset:5120
  ds_read_b128 v[132:135], v245 offset:6144
  ds_read_b128 v[136:139], v245 offset:7168
  s_waitcnt lgkmcnt(0)
L16:
  s_barrier
  s_cmp_lg_u32 s24, 0
  s_cbranch_scc1 L17
  s_lshr_b32 s60, s2, 3
  s_lshl_b32 s60, s60, 3
  s_add_u32 s60, s60, s3
  s_cmp_lt_u32 s60, 64
  s_cbranch_scc0 L18
  s_mov_b32 s12, s90
  s_mov_b32 s13, s91
  s_mov_b32 s14, 4194304
  s_lshl_b32 s60, s60, 16
  s_and_b32 s61, s2, 7
  s_lshl_b32 s61, s61, 10
  s_add_u32 s60, s60, s61
  v_lshrrev_b32 v253, 3, v244
  v_and_b32 v254, 7, v244
  v_lshlrev_b32 v254, 7, v254
  v_lshl_add_u32 v253, v253, 13, v254
  buffer_load_dword v255, v253, s[12:15], s60 offen
  s_branch L19
L18:
  s_mov_b32 s12, s84
  s_mov_b32 s13, s85
  s_mov_b32 s14, 1179648
  s_sub_u32 s60, s60, 64
  s_lshl_b32 s60, s60, 13
  v_lshlrev_b32 v253, 7, v244
  buffer_load_dword v255, v253, s[12:15], s60 offen
L19:
  s_mov_b32 s14, 147456
L17:
  s_cmp_eq_u32 s24, 0
  s_cbranch_scc1 L20
  s_and_b32 s60, s2, 1
  s_mul_i32 s60, s60, 40
  s_add_u32 s62, s0, s60
  s_addc_u32 s63, s1, 0
  s_load_dwordx2 s[12:13], s[62:63], 32
  s_lshr_b32 s60, s2, 3
  s_lshl_b32 s60, s60, 3
  s_add_u32 s60, s60, s3
  s_lshl_b32 s60, s60, 14
  s_bfe_u32 s61, s2, 0x10001
  s_lshl_b32 s61, s61, 9
  s_add_u32 s60, s60, s61
  v_lshrrev_b32 v253, 2, v244
  v_and_b32 v254, 3, v244
  v_lshlrev_b32 v254, 7, v254
  v_lshl_add_u32 v253, v253, 10, v254
  s_mov_b32 s14, 4194304
  s_waitcnt lgkmcnt(0)
  buffer_load_dword v255, v253, s[12:15], s60 offen
L20:
  v_and_b32 v247, 15, v244
  v_lshlrev_b32 v247, 2, v247
  s_mul_i32 s60, s3, 384
  s_add_u32 s60, s60, 147456
  v_add_u32 v245, s60, v247
  s_mul_i32 s60, s36, 384
  s_add_u32 s60, s60, 147456
  v_add_u32 v246, s60, v247
  s_nop 7
  ds_write_b32 v245, v180 offset:0
  ds_write_b32 v245, v96 offset:64
  ds_write_b32 v245, v184 offset:128
  ds_write_b32 v245, v100 offset:192
  s_waitcnt lgkmcnt(0)
  s_barrier
  ds_read_b32 v156, v246 offset:0
  ds_read_b32 v157, v246 offset:64
  ds_read_b32 v164, v246 offset:128
  ds_read_b32 v165, v246 offset:192
  s_waitcnt lgkmcnt(0)
  v_min_f32 v158, v156, v180
  v_sub_f32 v159, v158, v180
  v_sub_f32 v160, v158, v156
  v_exp_f32 v159, v159
  v_exp_f32 v160, v160
  v_mul_f32 v161, v159, v96
  v_fma_f32 v161, v160, v157, v161
  v_rcp_f32 v161, v161
  s_nop 0
  v_mul_f32 v162, v159, v161
  v_mul_f32 v0, v162, v0
  v_mul_f32 v1, v162, v1
  v_mul_f32 v2, v162, v2
  v_mul_f32 v3, v162, v3
  v_mul_f32 v8, v162, v8
  v_mul_f32 v9, v162, v9
  v_mul_f32 v10, v162, v10
  v_mul_f32 v11, v162, v11
  v_mul_f32 v16, v162, v16
  v_mul_f32 v17, v162, v17
  v_mul_f32 v18, v162, v18
  v_mul_f32 v19, v162, v19
  v_mul_f32 v24, v162, v24
  v_mul_f32 v25, v162, v25
  v_mul_f32 v26, v162, v26
  v_mul_f32 v27, v162, v27
  v_mul_f32 v32, v162, v32
  v_mul_f32 v33, v162, v33
  v_mul_f32 v34, v162, v34
  v_mul_f32 v35, v162, v35
  v_mul_f32 v40, v162, v40
  v_mul_f32 v41, v162, v41
  v_mul_f32 v42, v162, v42
  v_mul_f32 v43, v162, v43
  v_mul_f32 v48, v162, v48
  v_mul_f32 v49, v162, v49
  v_mul_f32 v50, v162, v50
  v_mul_f32 v51, v162, v51
  v_mul_f32 v56, v162, v56
  v_mul_f32 v57, v162, v57
  v_mul_f32 v58, v162, v58
  v_mul_f32 v59, v162, v59
  v_min_f32 v166, v164, v184
  v_sub_f32 v167, v166, v184
  v_sub_f32 v168, v166, v164
  v_exp_f32 v167, v167
  v_exp_f32 v168, v168
  v_mul_f32 v169, v167, v100
  v_fma_f32 v169, v168, v165, v169
  v_rcp_f32 v169, v169
  s_nop 0
  v_mul_f32 v170, v167, v169
  v_mul_f32 v4, v170, v4
  v_mul_f32 v5, v170, v5
  v_mul_f32 v6, v170, v6
  v_mul_f32 v7, v170, v7
  v_mul_f32 v12, v170, v12
  v_mul_f32 v13, v170, v13
  v_mul_f32 v14, v170, v14
  v_mul_f32 v15, v170, v15
  v_mul_f32 v20, v170, v20
  v_mul_f32 v21, v170, v21
  v_mul_f32 v22, v170, v22
  v_mul_f32 v23, v170, v23
  v_mul_f32 v28, v170, v28
  v_mul_f32 v29, v170, v29
  v_mul_f32 v30, v170, v30
  v_mul_f32 v31, v170, v31
  v_mul_f32 v36, v170, v36
  v_mul_f32 v37, v170, v37
  v_mul_f32 v38, v170, v38
  v_mul_f32 v39, v170, v39
  v_mul_f32 v44, v170, v44
  v_mul_f32 v45, v170, v45
  v_mul_f32 v46, v170, v46
  v_mul_f32 v47, v170, v47
  v_mul_f32 v52, v170, v52
  v_mul_f32 v53, v170, v53
  v_mul_f32 v54, v170, v54
  v_mul_f32 v55, v170, v55
  v_mul_f32 v60, v170, v60
  v_mul_f32 v61, v170, v61
  v_mul_f32 v62, v170, v62
  v_mul_f32 v63, v170, v63
  s_mul_i32 s60, s3, 6144
  s_add_u32 s60, s60, 98304
  v_add_u32 v245, s60, v242
  s_mul_i32 s60, s36, 6144
  s_add_u32 s60, s60, 98304
  v_add_u32 v246, s60, v242
  s_cmp_lg_u32 s34, 0
  s_cbranch_scc1 L21
  ds_write_b128 v245, v[32:35] offset:0
  ds_write_b128 v245, v[40:43] offset:1024
  ds_write_b128 v245, v[36:39] offset:2048
  ds_write_b128 v245, v[44:47] offset:3072
  s_waitcnt lgkmcnt(0)
  s_barrier
  ds_read_b128 v[192:195], v246 offset:0
  ds_read_b128 v[196:199], v246 offset:1024
  ds_read_b128 v[200:203], v246 offset:2048
  ds_read_b128 v[204:207], v246 offset:3072
  s_waitcnt lgkmcnt(0)
  s_barrier
  v_add_f32 v0, v0, v192
  v_add_f32 v1, v1, v193
  v_add_f32 v2, v2, v194
  v_add_f32 v3, v3, v195
  v_add_f32 v8, v8, v196
  v_add_f32 v9, v9, v197
  v_add_f32 v10, v10, v198
  v_add_f32 v11, v11, v199
  v_add_f32 v4, v4, v200
  v_add_f32 v5, v5, v201
  v_add_f32 v6, v6, v202
  v_add_f32 v7, v7, v203
  v_add_f32 v12, v12, v204
  v_add_f32 v13, v13, v205
  v_add_f32 v14, v14, v206
  v_add_f32 v15, v15, v207
  ds_write_b128 v245, v[48:51] offset:0
  ds_write_b128 v245, v[56:59] offset:1024
  ds_write_b128 v245, v[52:55] offset:2048
  ds_write_b128 v245, v[60:63] offset:3072
  s_waitcnt lgkmcnt(0)
  s_barrier
  ds_read_b128 v[192:195], v246 offset:0
  ds_read_b128 v[196:199], v246 offset:1024
  ds_read_b128 v[200:203], v246 offset:2048
  ds_read_b128 v[204:207], v246 offset:3072
  s_waitcnt lgkmcnt(0)
  s_barrier
  v_add_f32 v16, v16, v192
  v_add_f32 v17, v17, v193
  v_add_f32 v18, v18, v194
  v_add_f32 v19, v19, v195
  v_add_f32 v24, v24, v196
  v_add_f32 v25, v25, v197
  v_add_f32 v26, v26, v198
  v_add_f32 v27, v27, v199
  v_add_f32 v20, v20, v200
  v_add_f32 v21, v21, v201
  v_add_f32 v22, v22, v202
  v_add_f32 v23, v23, v203
  v_add_f32 v28, v28, v204
  v_add_f32 v29, v29, v205
  v_add_f32 v30, v30, v206
  v_add_f32 v31, v31, v207
  s_mul_i32 s60, s32, 9
  s_add_u32 s60, s60, s35
  s_lshl_b32 s60, s60, 7
  s_lshl_b32 s61, s33, 2
  s_add_u32 s60, s60, s61
  s_add_u32 s60, s60, 0
  s_lshl_b32 s60, s60, 10
  v_cvt_pk_bf16_f32 v192, v0, v1
  v_cvt_pk_bf16_f32 v193, v2, v3
  v_cvt_pk_bf16_f32 v194, v8, v9
  v_cvt_pk_bf16_f32 v195, v10, v11
  s_add_u32 s61, s60, 0
  buffer_store_dwordx4 v[192:195], v242, s[20:23], s61 offen
  v_cvt_pk_bf16_f32 v196, v16, v17
  v_cvt_pk_bf16_f32 v197, v18, v19
  v_cvt_pk_bf16_f32 v198, v24, v25
  v_cvt_pk_bf16_f32 v199, v26, v27
  s_add_u32 s61, s60, 1024
  buffer_store_dwordx4 v[196:199], v242, s[20:23], s61 offen
  v_cvt_pk_bf16_f32 v200, v4, v5
  v_cvt_pk_bf16_f32 v201, v6, v7
  v_cvt_pk_bf16_f32 v202, v12, v13
  v_cvt_pk_bf16_f32 v203, v14, v15
  s_add_u32 s61, s60, 131072
  buffer_store_dwordx4 v[200:203], v242, s[20:23], s61 offen
  v_cvt_pk_bf16_f32 v204, v20, v21
  v_cvt_pk_bf16_f32 v205, v22, v23
  v_cvt_pk_bf16_f32 v206, v28, v29
  v_cvt_pk_bf16_f32 v207, v30, v31
  s_add_u32 s61, s60, 132096
  buffer_store_dwordx4 v[204:207], v242, s[20:23], s61 offen
  s_branch L22
L21:
  ds_write_b128 v245, v[0:3] offset:0
  ds_write_b128 v245, v[8:11] offset:1024
  ds_write_b128 v245, v[4:7] offset:2048
  ds_write_b128 v245, v[12:15] offset:3072
  s_waitcnt lgkmcnt(0)
  s_barrier
  ds_read_b128 v[192:195], v246 offset:0
  ds_read_b128 v[196:199], v246 offset:1024
  ds_read_b128 v[200:203], v246 offset:2048
  ds_read_b128 v[204:207], v246 offset:3072
  s_waitcnt lgkmcnt(0)
  s_barrier
  v_add_f32 v32, v32, v192
  v_add_f32 v33, v33, v193
  v_add_f32 v34, v34, v194
  v_add_f32 v35, v35, v195
  v_add_f32 v40, v40, v196
  v_add_f32 v41, v41, v197
  v_add_f32 v42, v42, v198
  v_add_f32 v43, v43, v199
  v_add_f32 v36, v36, v200
  v_add_f32 v37, v37, v201
  v_add_f32 v38, v38, v202
  v_add_f32 v39, v39, v203
  v_add_f32 v44, v44, v204
  v_add_f32 v45, v45, v205
  v_add_f32 v46, v46, v206
  v_add_f32 v47, v47, v207
  ds_write_b128 v245, v[16:19] offset:0
  ds_write_b128 v245, v[24:27] offset:1024
  ds_write_b128 v245, v[20:23] offset:2048
  ds_write_b128 v245, v[28:31] offset:3072
  s_waitcnt lgkmcnt(0)
  s_barrier
  ds_read_b128 v[192:195], v246 offset:0
  ds_read_b128 v[196:199], v246 offset:1024
  ds_read_b128 v[200:203], v246 offset:2048
  ds_read_b128 v[204:207], v246 offset:3072
  s_waitcnt lgkmcnt(0)
  s_barrier
  v_add_f32 v48, v48, v192
  v_add_f32 v49, v49, v193
  v_add_f32 v50, v50, v194
  v_add_f32 v51, v51, v195
  v_add_f32 v56, v56, v196
  v_add_f32 v57, v57, v197
  v_add_f32 v58, v58, v198
  v_add_f32 v59, v59, v199
  v_add_f32 v52, v52, v200
  v_add_f32 v53, v53, v201
  v_add_f32 v54, v54, v202
  v_add_f32 v55, v55, v203
  v_add_f32 v60, v60, v204
  v_add_f32 v61, v61, v205
  v_add_f32 v62, v62, v206
  v_add_f32 v63, v63, v207
  s_mul_i32 s60, s32, 9
  s_add_u32 s60, s60, s35
  s_lshl_b32 s60, s60, 7
  s_lshl_b32 s61, s33, 2
  s_add_u32 s60, s60, s61
  s_add_u32 s60, s60, 2
  s_lshl_b32 s60, s60, 10
  v_cvt_pk_bf16_f32 v192, v32, v33
  v_cvt_pk_bf16_f32 v193, v34, v35
  v_cvt_pk_bf16_f32 v194, v40, v41
  v_cvt_pk_bf16_f32 v195, v42, v43
  s_add_u32 s61, s60, 0
  buffer_store_dwordx4 v[192:195], v242, s[20:23], s61 offen
  v_cvt_pk_bf16_f32 v196, v48, v49
  v_cvt_pk_bf16_f32 v197, v50, v51
  v_cvt_pk_bf16_f32 v198, v56, v57
  v_cvt_pk_bf16_f32 v199, v58, v59
  s_add_u32 s61, s60, 1024
  buffer_store_dwordx4 v[196:199], v242, s[20:23], s61 offen
  v_cvt_pk_bf16_f32 v200, v36, v37
  v_cvt_pk_bf16_f32 v201, v38, v39
  v_cvt_pk_bf16_f32 v202, v44, v45
  v_cvt_pk_bf16_f32 v203, v46, v47
  s_add_u32 s61, s60, 131072
  buffer_store_dwordx4 v[200:203], v242, s[20:23], s61 offen
  v_cvt_pk_bf16_f32 v204, v52, v53
  v_cvt_pk_bf16_f32 v205, v54, v55
  v_cvt_pk_bf16_f32 v206, v60, v61
  v_cvt_pk_bf16_f32 v207, v62, v63
  s_add_u32 s61, s60, 132096
  buffer_store_dwordx4 v[204:207], v242, s[20:23], s61 offen
L22:
  s_add_u32 s24, s24, 1
  s_cmp_lt_u32 s24, 2
  s_cbranch_scc1 UNIT_B
  s_waitcnt vmcnt(0)
  s_waitcnt vmcnt(0)
  s_endpgm
SLOW_B:
  v_xor_b32 v245, 16, v244
  v_lshlrev_b32 v245, 2, v245
  v_xor_b32 v246, 32, v244
  v_lshlrev_b32 v246, 2, v246
  v_max3_f32 v247, v156, v157, v158
  v_max3_f32 v247, v247, v159, v160
  v_max3_f32 v247, v247, v161, v162
  v_max_f32 v247, v247, v163
  ds_bpermute_b32 v252, v245, v247
  s_waitcnt lgkmcnt(0)
  v_max_f32 v247, v247, v252
  ds_bpermute_b32 v252, v246, v247
  s_waitcnt lgkmcnt(0)
  v_max_f32 v247, v247, v252
  v_max_f32 v247, 0, v247
  v_sub_f32 v156, v156, v247
  v_sub_f32 v157, v157, v247
  v_sub_f32 v158, v158, v247
  v_sub_f32 v159, v159, v247
  v_sub_f32 v160, v160, v247
  v_sub_f32 v161, v161, v247
  v_sub_f32 v162, v162, v247
  v_sub_f32 v163, v163, v247
  v_sub_f32 v180, v180, v247
  v_sub_f32 v181, v181, v247
  v_sub_f32 v182, v182, v247
  v_sub_f32 v183, v183, v247
  v_max3_f32 v248, v164, v165, v166
  v_max3_f32 v248, v248, v167, v168
  v_max3_f32 v248, v248, v169, v170
  v_max_f32 v248, v248, v171
  ds_bpermute_b32 v252, v245, v248
  s_waitcnt lgkmcnt(0)
  v_max_f32 v248, v248, v252
  ds_bpermute_b32 v252, v246, v248
  s_waitcnt lgkmcnt(0)
  v_max_f32 v248, v248, v252
  v_max_f32 v248, 0, v248
  v_sub_f32 v164, v164, v248
  v_sub_f32 v165, v165, v248
  v_sub_f32 v166, v166, v248
  v_sub_f32 v167, v167, v248
  v_sub_f32 v168, v168, v248
  v_sub_f32 v169, v169, v248
  v_sub_f32 v170, v170, v248
  v_sub_f32 v171, v171, v248
  v_sub_f32 v184, v184, v248
  v_sub_f32 v185, v185, v248
  v_sub_f32 v186, v186, v248
  v_sub_f32 v187, v187, v248
  v_sub_f32 v247, 0, v247
  v_exp_f32 v247, v247
  s_nop 0
  v_mul_f32 v0, v247, v0
  v_mul_f32 v1, v247, v1
  v_mul_f32 v2, v247, v2
  v_mul_f32 v3, v247, v3
  v_mul_f32 v8, v247, v8
  v_mul_f32 v9, v247, v9
  v_mul_f32 v10, v247, v10
  v_mul_f32 v11, v247, v11
  v_mul_f32 v16, v247, v16
  v_mul_f32 v17, v247, v17
  v_mul_f32 v18, v247, v18
  v_mul_f32 v19, v247, v19
  v_mul_f32 v24, v247, v24
  v_mul_f32 v25, v247, v25
  v_mul_f32 v26, v247, v26
  v_mul_f32 v27, v247, v27
  v_mul_f32 v32, v247, v32
  v_mul_f32 v33, v247, v33
  v_mul_f32 v34, v247, v34
  v_mul_f32 v35, v247, v35
  v_mul_f32 v40, v247, v40
  v_mul_f32 v41, v247, v41
  v_mul_f32 v42, v247, v42
  v_mul_f32 v43, v247, v43
  v_mul_f32 v48, v247, v48
  v_mul_f32 v49, v247, v49
  v_mul_f32 v50, v247, v50
  v_mul_f32 v51, v247, v51
  v_mul_f32 v56, v247, v56
  v_mul_f32 v57, v247, v57
  v_mul_f32 v58, v247, v58
  v_mul_f32 v59, v247, v59
  v_mul_f32 v96, v247, v96
  v_mul_f32 v97, v247, v97
  v_mul_f32 v98, v247, v98
  v_mul_f32 v99, v247, v99
  v_sub_f32 v248, 0, v248
  v_exp_f32 v248, v248
  s_nop 0
  v_mul_f32 v4, v248, v4
  v_mul_f32 v5, v248, v5
  v_mul_f32 v6, v248, v6
  v_mul_f32 v7, v248, v7
  v_mul_f32 v12, v248, v12
  v_mul_f32 v13, v248, v13
  v_mul_f32 v14, v248, v14
  v_mul_f32 v15, v248, v15
  v_mul_f32 v20, v248, v20
  v_mul_f32 v21, v248, v21
  v_mul_f32 v22, v248, v22
  v_mul_f32 v23, v248, v23
  v_mul_f32 v28, v248, v28
  v_mul_f32 v29, v248, v29
  v_mul_f32 v30, v248, v30
  v_mul_f32 v31, v248, v31
  v_mul_f32 v36, v248, v36
  v_mul_f32 v37, v248, v37
  v_mul_f32 v38, v248, v38
  v_mul_f32 v39, v248, v39
  v_mul_f32 v44, v248, v44
  v_mul_f32 v45, v248, v45
  v_mul_f32 v46, v248, v46
  v_mul_f32 v47, v248, v47
  v_mul_f32 v52, v248, v52
  v_mul_f32 v53, v248, v53
  v_mul_f32 v54, v248, v54
  v_mul_f32 v55, v248, v55
  v_mul_f32 v60, v248, v60
  v_mul_f32 v61, v248, v61
  v_mul_f32 v62, v248, v62
  v_mul_f32 v63, v248, v63
  v_mul_f32 v100, v248, v100
  v_mul_f32 v101, v248, v101
  v_mul_f32 v102, v248, v102
  v_mul_f32 v103, v248, v103
  s_nop 1
  s_branch BACK_B
K1_C:
  v_lshrrev_b32 v245, 4, v244
  v_and_b32 v246, 15, v244
  v_lshrrev_b32 v247, 2, v244
  v_sub_u32 v248, 0, v245
  v_xor_b32 v248, v248, v244
  v_and_b32 v248, 3, v248
  v_lshlrev_b32 v248, 4, v248
  v_lshl_add_u32 v240, v247, 10, v248
  v_lshlrev_b32 v247, 2, v245
  v_xor_b32 v248, v246, v247
  v_lshlrev_b32 v248, 4, v248
  v_lshl_add_u32 v241, v245, 13, v248
  s_mov_b32 s60, s39
  s_lshl_b32 s66, s60, 14
  s_lshl_b32 s67, s60, 10
  s_lshl_b32 s70, s60, 16
  s_lshl_b32 s71, s60, 11
  s_lshl_b32 s61, s60, 4
  s_mov_b64 s[68:69], 0xffff
  s_lshl_b64 s[68:69], s[68:69], s61
UNIT_C:
  s_mul_i32 s60, s24, 9437184
  s_add_u32 s20, s56, s60
  s_addc_u32 s21, s57, 0
  s_mov_b32 s58, s24
  s_and_b32 s60, s26, s24
  s_cmp_lg_u32 s60, 0
  s_cbranch_scc1 INIT_C
QP_C:
  s_cmp_eq_u32 s58, 0
  s_cselect_b32 s12, s48, s50
  s_cselect_b32 s13, s49, s51
  s_cselect_b32 s16, s52, s54
  s_cselect_b32 s17, s53, s55
  v_mov_b32 v0, 0
  v_mov_b32 v1, 0
  v_mov_b32 v2, 0
  v_mov_b32 v3, 0
  v_mov_b32 v4, 0
  v_mov_b32 v5, 0
  v_mov_b32 v6, 0
  v_mov_b32 v7, 0
  v_mov_b32 v8, 0
  v_mov_b32 v9, 0
  v_mov_b32 v10, 0
  v_mov_b32 v11, 0
  v_mov_b32 v12, 0
  v_mov_b32 v13, 0
  v_mov_b32 v14, 0
  v_mov_b32 v15, 0
  v_mov_b32 v16, 0
  v_mov_b32 v17, 0
  v_mov_b32 v18, 0
  v_mov_b32 v19, 0
  v_mov_b32 v20, 0
  v_mov_b32 v21, 0
  v_mov_b32 v22, 0
  v_mov_b32 v23, 0
  v_mov_b32 v24, 0
  v_mov_b32 v25, 0
  v_mov_b32 v26, 0
  v_mov_b32 v27, 0
  v_mov_b32 v28, 0
  v_mov_b32 v29, 0
  v_mov_b32 v30, 0
  v_mov_b32 v31, 0
  v_mov_b32 v32, 0
  v_mov_b32 v33, 0
  v_mov_b32 v34, 0
  v_mov_b32 v35, 0
  v_mov_b32 v36, 0
  v_mov_b32 v37, 0
  v_mov_b32 v38, 0
  v_mov_b32 v39, 0
  v_and_b32 v245, 15, v244
  v_lshrrev_b32 v246, 2, v245
  v_sub_u32 v246, 0, v246
  v_lshrrev_b32 v247, 4, v244
  v_xor_b32 v246, v246, v247
  v_and_b32 v246, 3, v246
  v_lshlrev_b32 v246, 4, v246
  v_lshl_add_u32 v245, v245, 6, v246
  v_add_u32 v245, 98304, v245
  s_add_u32 s37, s73, 0
  s_and_b32 s37, s37, 15
  s_lshl_b32 s38, s37, 18
  s_lshl_b32 s37, s37, 6
  s_add_u32 m0, s67, 98304
  s_add_u32 s60, s66, s37
  buffer_load_dwordx4 v240, s[12:15], s60 offen lds
  s_add_u32 m0, s67, 102400
  s_add_u32 s60, s60, 65536
  buffer_load_dwordx4 v240, s[12:15], s60 offen lds
  s_mov_b32 m0, 106496
  s_add_u32 s60, s37, 131072
  s_mov_b64 exec, s[68:69]
  buffer_load_dwordx4 v240, s[12:15], s60 offen lds
  s_mov_b64 exec, -1
  s_add_u32 s37, s73, 1
  s_and_b32 s37, s37, 15
  s_lshl_b32 s38, s37, 18
  s_lshl_b32 s37, s37, 6
  s_add_u32 m0, s67, 115712
  s_add_u32 s60, s66, s37
  buffer_load_dwordx4 v240, s[12:15], s60 offen lds
  s_add_u32 m0, s67, 119808
  s_add_u32 s60, s60, 65536
  buffer_load_dwordx4 v240, s[12:15], s60 offen lds
  s_mov_b32 m0, 123904
  s_add_u32 s60, s37, 131072
  s_mov_b64 exec, s[68:69]
  buffer_load_dwordx4 v240, s[12:15], s60 offen lds
  s_mov_b64 exec, -1
  s_add_u32 s37, s73, 2
  s_and_b32 s37, s37, 15
  s_lshl_b32 s38, s37, 18
  s_lshl_b32 s37, s37, 6
  s_add_u32 m0, s67, 133120
  s_add_u32 s60, s66, s37
  buffer_load_dwordx4 v240, s[12:15], s60 offen lds
  s_add_u32 m0, s67, 137216
  s_add_u32 s60, s60, 65536
  buffer_load_dwordx4 v240, s[12:15], s60 offen lds
  s_mov_b32 m0, 141312
  s_add_u32 s60, s37, 131072
  s_mov_b64 exec, s[68:69]
  buffer_load_dwordx4 v240, s[12:15], s60 offen lds
  s_mov_b64 exec, -1
  s_waitcnt vmcnt(6)
  s_barrier
  ds_read_b64_tr_b16 v[40:41], v243 offset:9216
  ds_read_b64_tr_b16 v[42:43], v243 offset:10240
  ds_read_b64_tr_b16 v[44:45], v243 offset:9224
  ds_read_b64_tr_b16 v[46:47], v243 offset:10248
  ds_read_b128 v[56:59], v245 offset:5120
  ds_read_b128 v[60:63], v245 offset:6144
  ds_read_b128 v[64:67], v245 offset:7168
  ds_read_b128 v[68:71], v245 offset:8192
  s_waitcnt vmcnt(3)
  s_waitcnt lgkmcnt(0)
  s_barrier
  ds_read_b64_tr_b16 v[48:49], v243 offset:26624
  ds_read_b64_tr_b16 v[50:51], v243 offset:27648
  ds_read_b64_tr_b16 v[52:53], v243 offset:26632
  ds_read_b64_tr_b16 v[54:55], v243 offset:27656
  ds_read_b128 v[76:79], v245 offset:22528
  ds_read_b128 v[80:83], v245 offset:23552
  ds_read_b128 v[84:87], v245 offset:24576
  ds_read_b128 v[88:91], v245 offset:25600
  v_mfma_f32_16x16x32_bf16 v[0:3], v[40:43], v[56:59], v[0:3]
  v_mfma_f32_16x16x32_bf16 v[20:23], v[44:47], v[56:59], v[20:23]
  s_add_u32 s37, s73, 3
  s_and_b32 s37, s37, 15
  s_lshl_b32 s38, s37, 18
  s_lshl_b32 s37, s37, 6
  s_add_u32 m0, s67, 98304
  s_add_u32 s60, s66, s37
  buffer_load_dwordx4 v240, s[12:15], s60 offen lds
  v_mfma_f32_16x16x32_bf16 v[4:7], v[40:43], v[60:63], v[4:7]
  v_mfma_f32_16x16x32_bf16 v[24:27], v[44:47], v[60:63], v[24:27]
  s_add_u32 m0, s67, 102400
  s_add_u32 s60, s60, 65536
  buffer_load_dwordx4 v240, s[12:15], s60 offen lds
  v_mfma_f32_16x16x32_bf16 v[8:11], v[40:43], v[64:67], v[8:11]
  v_mfma_f32_16x16x32_bf16 v[28:31], v[44:47], v[64:67], v[28:31]
  s_mov_b32 m0, 106496
  s_add_u32 s60, s37, 131072
  s_mov_b64 exec, s[68:69]
  buffer_load_dwordx4 v240, s[12:15], s60 offen lds
  s_mov_b64 exec, -1
  v_mfma_f32_16x16x32_bf16 v[12:15], v[40:43], v[68:71], v[12:15]
  v_mfma_f32_16x16x32_bf16 v[32:35], v[44:47], v[68:71], v[32:35]
  s_waitcnt vmcnt(3)
  s_waitcnt lgkmcnt(0)
  s_barrier
  ds_read_b64_tr_b16 v[40:41], v243 offset:44032
  ds_read_b64_tr_b16 v[42:43], v243 offset:45056
  ds_read_b64_tr_b16 v[44:45], v243 offset:44040
  ds_read_b64_tr_b16 v[46:47], v243 offset:45064
  ds_read_b128 v[56:59], v245 offset:39936
  ds_read_b128 v[60:63], v245 offset:40960
  ds_read_b128 v[64:67], v245 offset:41984
  ds_read_b128 v[68:71], v245 offset:43008
  v_mfma_f32_16x16x32_bf16 v[0:3], v[48:51], v[76:79], v[0:3]
  v_mfma_f32_16x16x32_bf16 v[20:23], v[52:55], v[76:79], v[20:23]
  s_add_u32 s37, s73, 4
  s_and_b32 s37, s37, 15
  s_lshl_b32 s38, s37, 18
  s_lshl_b32 s37, s37, 6
  s_add_u32 m0, s67, 115712
  s_add_u32 s60, s66, s37
  buffer_load_dwordx4 v240, s[12:15], s60 offen lds
  v_mfma_f32_16x16x32_bf16 v[4:7], v[48:51], v[80:83], v[4:7]
  v_mfma_f32_16x16x32_bf16 v[24:27], v[52:55], v[80:83], v[24:27]
  s_add_u32 m0, s67, 119808
  s_add_u32 s60, s60, 65536
  buffer_load_dwordx4 v240, s[12:15], s60 offen lds
  v_mfma_f32_16x16x32_bf16 v[8:11], v[48:51], v[84:87], v[8:11]
  v_mfma_f32_16x16x32_bf16 v[28:31], v[52:55], v[84:87], v[28:31]
  s_mov_b32 m0, 123904
  s_add_u32 s60, s37, 131072
  s_mov_b64 exec, s[68:69]
  buffer_load_dwordx4 v240, s[12:15], s60 offen lds
  s_mov_b64 exec, -1
  v_mfma_f32_16x16x32_bf16 v[12:15], v[48:51], v[88:91], v[12:15]
  v_mfma_f32_16x16x32_bf16 v[32:35], v[52:55], v[88:91], v[32:35]
  s_waitcnt vmcnt(3)
  s_waitcnt lgkmcnt(0)
  s_barrier
  ds_read_b64_tr_b16 v[48:49], v243 offset:9216
  ds_read_b64_tr_b16 v[50:51], v243 offset:10240
  ds_read_b64_tr_b16 v[52:53], v243 offset:9224
  ds_read_b64_tr_b16 v[54:55], v243 offset:10248
  ds_read_b128 v[76:79], v245 offset:5120
  ds_read_b128 v[80:83], v245 offset:6144
  ds_read_b128 v[84:87], v245 offset:7168
  ds_read_b128 v[88:91], v245 offset:8192
  v_mfma_f32_16x16x32_bf16 v[0:3], v[40:43], v[56:59], v[0:3]
  v_mfma_f32_16x16x32_bf16 v[20:23], v[44:47], v[56:59], v[20:23]
  s_add_u32 s37, s73, 5
  s_and_b32 s37, s37, 15
  s_lshl_b32 s38, s37, 18
  s_lshl_b32 s37, s37, 6
  s_add_u32 m0, s67, 133120
  s_add_u32 s60, s66, s37
  buffer_load_dwordx4 v240, s[12:15], s60 offen lds
  v_mfma_f32_16x16x32_bf16 v[4:7], v[40:43], v[60:63], v[4:7]
  v_mfma_f32_16x16x32_bf16 v[24:27], v[44:47], v[60:63], v[24:27]
  s_add_u32 m0, s67, 137216
  s_add_u32 s60, s60, 65536
  buffer_load_dwordx4 v240, s[12:15], s60 offen lds
  v_mfma_f32_16x16x32_bf16 v[8:11], v[40:43], v[64:67], v[8:11]
  v_mfma_f32_16x16x32_bf16 v[28:31], v[44:47], v[64:67], v[28:31]
  s_mov_b32 m0, 141312
  s_add_u32 s60, s37, 131072
  s_mov_b64 exec, s[68:69]
  buffer_load_dwordx4 v240, s[12:15], s60 offen lds
  s_mov_b64 exec, -1
  v_mfma_f32_16x16x32_bf16 v[12:15], v[40:43], v[68:71], v[12:15]
  v_mfma_f32_16x16x32_bf16 v[32:35], v[44:47], v[68:71], v[32:35]
  s_waitcnt vmcnt(3)
  s_waitcnt lgkmcnt(0)
  s_barrier
  ds_read_b64_tr_b16 v[40:41], v243 offset:26624
  ds_read_b64_tr_b16 v[42:43], v243 offset:27648
  ds_read_b64_tr_b16 v[44:45], v243 offset:26632
  ds_read_b64_tr_b16 v[46:47], v243 offset:27656
  ds_read_b128 v[56:59], v245 offset:22528
  ds_read_b128 v[60:63], v245 offset:23552
  ds_read_b128 v[64:67], v245 offset:24576
  ds_read_b128 v[68:71], v245 offset:25600
  v_mfma_f32_16x16x32_bf16 v[0:3], v[48:51], v[76:79], v[0:3]
  v_mfma_f32_16x16x32_bf16 v[20:23], v[52:55], v[76:79], v[20:23]
  s_add_u32 s37, s73, 6
  s_and_b32 s37, s37, 15
  s_lshl_b32 s38, s37, 18
  s_lshl_b32 s37, s37, 6
  s_add_u32 m0, s67, 98304
  s_add_u32 s60, s66, s37
  buffer_load_dwordx4 v240, s[12:15], s60 offen lds
  v_mfma_f32_16x16x32_bf16 v[4:7], v[48:51], v[80:83], v[4:7]
  v_mfma_f32_16x16x32_bf16 v[24:27], v[52:55], v[80:83], v[24:27]
  s_add_u32 m0, s67, 102400
  s_add_u32 s60, s60, 65536
  buffer_load_dwordx4 v240, s[12:15], s60 offen lds
  v_mfma_f32_16x16x32_bf16 v[8:11], v[48:51], v[84:87], v[8:11]
  v_mfma_f32_16x16x32_bf16 v[28:31], v[52:55], v[84:87], v[28:31]
  s_mov_b32 m0, 106496
  s_add_u32 s60, s37, 131072
  s_mov_b64 exec, s[68:69]
  buffer_load_dwordx4 v240, s[12:15], s60 offen lds
  s_mov_b64 exec, -1
  v_mfma_f32_16x16x32_bf16 v[12:15], v[48:51], v[88:91], v[12:15]
  v_mfma_f32_16x16x32_bf16 v[32:35], v[52:55], v[88:91], v[32:35]
  s_waitcnt vmcnt(3)
  s_waitcnt lgkmcnt(0)
  s_barrier
  ds_read_b64_tr_b16 v[48:49], v243 offset:44032
  ds_read_b64_tr_b16 v[50:51], v243 offset:45056
  ds_read_b64_tr_b16 v[52:53], v243 offset:44040
  ds_read_b64_tr_b16 v[54:55], v243 offset:45064
  ds_read_b128 v[76:79], v245 offset:39936
  ds_read_b128 v[80:83], v245 offset:40960
  ds_read_b128 v[84:87], v245 offset:41984
  ds_read_b128 v[88:91], v245 offset:43008
  v_mfma_f32_16x16x32_bf16 v[0:3], v[40:43], v[56:59], v[0:3]
  v_mfma_f32_16x16x32_bf16 v[20:23], v[44:47], v[56:59], v[20:23]
  s_add_u32 s37, s73, 7
  s_and_b32 s37, s37, 15
  s_lshl_b32 s38, s37, 18
  s_lshl_b32 s37, s37, 6
  s_add_u32 m0, s67, 115712
  s_add_u32 s60, s66, s37
  buffer_load_dwordx4 v240, s[12:15], s60 offen lds
  v_mfma_f32_16x16x32_bf16 v[4:7], v[40:43], v[60:63], v[4:7]
  v_mfma_f32_16x16x32_bf16 v[24:27], v[44:47], v[60:63], v[24:27]
  s_add_u32 m0, s67, 119808
  s_add_u32 s60, s60, 65536
  buffer_load_dwordx4 v240, s[12:15], s60 offen lds
  v_mfma_f32_16x16x32_bf16 v[8:11], v[40:43], v[64:67], v[8:11]
  v_mfma_f32_16x16x32_bf16 v[28:31], v[44:47], v[64:67], v[28:31]
  s_mov_b32 m0, 123904
  s_add_u32 s60, s37, 131072
  s_mov_b64 exec, s[68:69]
  buffer_load_dwordx4 v240, s[12:15], s60 offen lds
  s_mov_b64 exec, -1
  v_mfma_f32_16x16x32_bf16 v[12:15], v[40:43], v[68:71], v[12:15]
  v_mfma_f32_16x16x32_bf16 v[32:35], v[44:47], v[68:71], v[32:35]
  s_waitcnt vmcnt(3)
  s_waitcnt lgkmcnt(0)
  s_barrier
  ds_read_b64_tr_b16 v[40:41], v243 offset:9216
  ds_read_b64_tr_b16 v[42:43], v243 offset:10240
  ds_read_b64_tr_b16 v[44:45], v243 offset:9224
  ds_read_b64_tr_b16 v[46:47], v243 offset:10248
  ds_read_b128 v[56:59], v245 offset:5120
  ds_read_b128 v[60:63], v245 offset:6144
  ds_read_b128 v[64:67], v245 offset:7168
  ds_read_b128 v[68:71], v245 offset:8192
  v_mfma_f32_16x16x32_bf16 v[0:3], v[48:51], v[76:79], v[0:3]
  v_mfma_f32_16x16x32_bf16 v[20:23], v[52:55], v[76:79], v[20:23]
  s_add_u32 s37, s73, 8
  s_and_b32 s37, s37, 15
  s_lshl_b32 s38, s37, 18
  s_lshl_b32 s37, s37, 6
  s_add_u32 m0, s67, 133120
  s_add_u32 s60, s66, s37
  buffer_load_dwordx4 v240, s[12:15], s60 offen lds
  v_mfma_f32_16x16x32_bf16 v[4:7], v[48:51], v[80:83], v[4:7]
  v_mfma_f32_16x16x32_bf16 v[24:27], v[52:55], v[80:83], v[24:27]
  s_add_u32 m0, s67, 137216
  s_add_u32 s60, s60, 65536
  buffer_load_dwordx4 v240, s[12:15], s60 offen lds
  v_mfma_f32_16x16x32_bf16 v[8:11], v[48:51], v[84:87], v[8:11]
  v_mfma_f32_16x16x32_bf16 v[28:31], v[52:55], v[84:87], v[28:31]
  s_mov_b32 m0, 141312
  s_add_u32 s60, s37, 131072
  s_mov_b64 exec, s[68:69]
  buffer_load_dwordx4 v240, s[12:15], s60 offen lds
  s_mov_b64 exec, -1
  v_mfma_f32_16x16x32_bf16 v[12:15], v[48:51], v[88:91], v[12:15]
  v_mfma_f32_16x16x32_bf16 v[32:35], v[52:55], v[88:91], v[32:35]
  s_waitcnt vmcnt(3)
  s_waitcnt lgkmcnt(0)
  s_barrier
  ds_read_b64_tr_b16 v[48:49], v243 offset:26624
  ds_read_b64_tr_b16 v[50:51], v243 offset:27648
  ds_read_b64_tr_b16 v[52:53], v243 offset:26632
  ds_read_b64_tr_b16 v[54:55], v243 offset:27656
  ds_read_b128 v[76:79], v245 offset:22528
  ds_read_b128 v[80:83], v245 offset:23552
  ds_read_b128 v[84:87], v245 offset:24576
  ds_read_b128 v[88:91], v245 offset:25600
  v_mfma_f32_16x16x32_bf16 v[0:3], v[40:43], v[56:59], v[0:3]
  v_mfma_f32_16x16x32_bf16 v[20:23], v[44:47], v[56:59], v[20:23]
  s_add_u32 s37, s73, 9
  s_and_b32 s37, s37, 15
  s_lshl_b32 s38, s37, 18
  s_lshl_b32 s37, s37, 6
  s_add_u32 m0, s67, 98304
  s_add_u32 s60, s66, s37
  buffer_load_dwordx4 v240, s[12:15], s60 offen lds
  v_mfma_f32_16x16x32_bf16 v[4:7], v[40:43], v[60:63], v[4:7]
  v_mfma_f32_16x16x32_bf16 v[24:27], v[44:47], v[60:63], v[24:27]
  s_add_u32 m0, s67, 102400
  s_add_u32 s60, s60, 65536
  buffer_load_dwordx4 v240, s[12:15], s60 offen lds
  v_mfma_f32_16x16x32_bf16 v[8:11], v[40:43], v[64:67], v[8:11]
  v_mfma_f32_16x16x32_bf16 v[28:31], v[44:47], v[64:67], v[28:31]
  s_mov_b32 m0, 106496
  s_add_u32 s60, s37, 131072
  s_mov_b64 exec, s[68:69]
  buffer_load_dwordx4 v240, s[12:15], s60 offen lds
  s_mov_b64 exec, -1
  v_mfma_f32_16x16x32_bf16 v[12:15], v[40:43], v[68:71], v[12:15]
  v_mfma_f32_16x16x32_bf16 v[32:35], v[44:47], v[68:71], v[32:35]
  s_waitcnt vmcnt(3)
  s_waitcnt lgkmcnt(0)
  s_barrier
  ds_read_b64_tr_b16 v[40:41], v243 offset:44032
  ds_read_b64_tr_b16 v[42:43], v243 offset:45056
  ds_read_b64_tr_b16 v[44:45], v243 offset:44040
  ds_read_b64_tr_b16 v[46:47], v243 offset:45064
  ds_read_b128 v[56:59], v245 offset:39936
  ds_read_b128 v[60:63], v245 offset:40960
  ds_read_b128 v[64:67], v245 offset:41984
  ds_read_b128 v[68:71], v245 offset:43008
  v_mfma_f32_16x16x32_bf16 v[0:3], v[48:51], v[76:79], v[0:3]
  v_mfma_f32_16x16x32_bf16 v[20:23], v[52:55], v[76:79], v[20:23]
  s_add_u32 s37, s73, 10
  s_and_b32 s37, s37, 15
  s_lshl_b32 s38, s37, 18
  s_lshl_b32 s37, s37, 6
  s_add_u32 m0, s67, 115712
  s_add_u32 s60, s66, s37
  buffer_load_dwordx4 v240, s[12:15], s60 offen lds
  v_mfma_f32_16x16x32_bf16 v[4:7], v[48:51], v[80:83], v[4:7]
  v_mfma_f32_16x16x32_bf16 v[24:27], v[52:55], v[80:83], v[24:27]
  s_add_u32 m0, s67, 119808
  s_add_u32 s60, s60, 65536
  buffer_load_dwordx4 v240, s[12:15], s60 offen lds
  v_mfma_f32_16x16x32_bf16 v[8:11], v[48:51], v[84:87], v[8:11]
  v_mfma_f32_16x16x32_bf16 v[28:31], v[52:55], v[84:87], v[28:31]
  s_mov_b32 m0, 123904
  s_add_u32 s60, s37, 131072
  s_mov_b64 exec, s[68:69]
  buffer_load_dwordx4 v240, s[12:15], s60 offen lds
  s_mov_b64 exec, -1
  v_mfma_f32_16x16x32_bf16 v[12:15], v[48:51], v[88:91], v[12:15]
  v_mfma_f32_16x16x32_bf16 v[32:35], v[52:55], v[88:91], v[32:35]
  s_waitcnt vmcnt(3)
  s_waitcnt lgkmcnt(0)
  s_barrier
  ds_read_b64_tr_b16 v[48:49], v243 offset:9216
  ds_read_b64_tr_b16 v[50:51], v243 offset:10240
  ds_read_b64_tr_b16 v[52:53], v243 offset:9224
  ds_read_b64_tr_b16 v[54:55], v243 offset:10248
  ds_read_b128 v[76:79], v245 offset:5120
  ds_read_b128 v[80:83], v245 offset:6144
  ds_read_b128 v[84:87], v245 offset:7168
  ds_read_b128 v[88:91], v245 offset:8192
  v_mfma_f32_16x16x32_bf16 v[0:3], v[40:43], v[56:59], v[0:3]
  v_mfma_f32_16x16x32_bf16 v[20:23], v[44:47], v[56:59], v[20:23]
  s_add_u32 s37, s73, 11
  s_and_b32 s37, s37, 15
  s_lshl_b32 s38, s37, 18
  s_lshl_b32 s37, s37, 6
  s_add_u32 m0, s67, 133120
  s_add_u32 s60, s66, s37
  buffer_load_dwordx4 v240, s[12:15], s60 offen lds
  v_mfma_f32_16x16x32_bf16 v[4:7], v[40:43], v[60:63], v[4:7]
  v_mfma_f32_16x16x32_bf16 v[24:27], v[44:47], v[60:63], v[24:27]
  s_add_u32 m0, s67, 137216
  s_add_u32 s60, s60, 65536
  buffer_load_dwordx4 v240, s[12:15], s60 offen lds
  v_mfma_f32_16x16x32_bf16 v[8:11], v[40:43], v[64:67], v[8:11]
  v_mfma_f32_16x16x32_bf16 v[28:31], v[44:47], v[64:67], v[28:31]
  s_mov_b32 m0, 141312
  s_add_u32 s60, s37, 131072
  s_mov_b64 exec, s[68:69]
  buffer_load_dwordx4 v240, s[12:15], s60 offen lds
  s_mov_b64 exec, -1
  v_mfma_f32_16x16x32_bf16 v[12:15], v[40:43], v[68:71], v[12:15]
  v_mfma_f32_16x16x32_bf16 v[32:35], v[44:47], v[68:71], v[32:35]
  s_waitcnt vmcnt(3)
  s_waitcnt lgkmcnt(0)
  s_barrier
  ds_read_b64_tr_b16 v[40:41], v243 offset:26624
  ds_read_b64_tr_b16 v[42:43], v243 offset:27648
  ds_read_b64_tr_b16 v[44:45], v243 offset:26632
  ds_read_b64_tr_b16 v[46:47], v243 offset:27656
  ds_read_b128 v[56:59], v245 offset:22528
  ds_read_b128 v[60:63], v245 offset:23552
  ds_read_b128 v[64:67], v245 offset:24576
  ds_read_b128 v[68:71], v245 offset:25600
  v_mfma_f32_16x16x32_bf16 v[0:3], v[48:51], v[76:79], v[0:3]
  v_mfma_f32_16x16x32_bf16 v[20:23], v[52:55], v[76:79], v[20:23]
  s_add_u32 s37, s73, 12
  s_and_b32 s37, s37, 15
  s_lshl_b32 s38, s37, 18
  s_lshl_b32 s37, s37, 6
  s_add_u32 m0, s67, 98304
  s_add_u32 s60, s66, s37
  buffer_load_dwordx4 v240, s[12:15], s60 offen lds
  v_mfma_f32_16x16x32_bf16 v[4:7], v[48:51], v[80:83], v[4:7]
  v_mfma_f32_16x16x32_bf16 v[24:27], v[52:55], v[80:83], v[24:27]
  s_add_u32 m0, s67, 102400
  s_add_u32 s60, s60, 65536
  buffer_load_dwordx4 v240, s[12:15], s60 offen lds
  v_mfma_f32_16x16x32_bf16 v[8:11], v[48:51], v[84:87], v[8:11]
  v_mfma_f32_16x16x32_bf16 v[28:31], v[52:55], v[84:87], v[28:31]
  s_mov_b32 m0, 106496
  s_add_u32 s60, s37, 131072
  s_mov_b64 exec, s[68:69]
  buffer_load_dwordx4 v240, s[12:15], s60 offen lds
  s_mov_b64 exec, -1
  v_mfma_f32_16x16x32_bf16 v[12:15], v[48:51], v[88:91], v[12:15]
  v_mfma_f32_16x16x32_bf16 v[32:35], v[52:55], v[88:91], v[32:35]
  s_waitcnt vmcnt(3)
  s_waitcnt lgkmcnt(0)
  s_barrier
  ds_read_b64_tr_b16 v[48:49], v243 offset:44032
  ds_read_b64_tr_b16 v[50:51], v243 offset:45056
  ds_read_b64_tr_b16 v[52:53], v243 offset:44040
  ds_read_b64_tr_b16 v[54:55], v243 offset:45064
  ds_read_b128 v[76:79], v245 offset:39936
  ds_read_b128 v[80:83], v245 offset:40960
  ds_read_b128 v[84:87], v245 offset:41984
  ds_read_b128 v[88:91], v245 offset:43008
  v_mfma_f32_16x16x32_bf16 v[0:3], v[40:43], v[56:59], v[0:3]
  v_mfma_f32_16x16x32_bf16 v[20:23], v[44:47], v[56:59], v[20:23]
  s_add_u32 s37, s73, 13
  s_and_b32 s37, s37, 15
  s_lshl_b32 s38, s37, 18
  s_lshl_b32 s37, s37, 6
  s_add_u32 m0, s67, 115712
  s_add_u32 s60, s66, s37
  buffer_load_dwordx4 v240, s[12:15], s60 offen lds
  v_mfma_f32_16x16x32_bf16 v[4:7], v[40:43], v[60:63], v[4:7]
  v_mfma_f32_16x16x32_bf16 v[24:27], v[44:47], v[60:63], v[24:27]
  s_add_u32 m0, s67, 119808
  s_add_u32 s60, s60, 65536
  buffer_load_dwordx4 v240, s[12:15], s60 offen lds
  v_mfma_f32_16x16x32_bf16 v[8:11], v[40:43], v[64:67], v[8:11]
  v_mfma_f32_16x16x32_bf16 v[28:31], v[44:47], v[64:67], v[28:31]
  s_mov_b32 m0, 123904
  s_add_u32 s60, s37, 131072
  s_mov_b64 exec, s[68:69]
  buffer_load_dwordx4 v240, s[12:15], s60 offen lds
  s_mov_b64 exec, -1
  v_mfma_f32_16x16x32_bf16 v[12:15], v[40:43], v[68:71], v[12:15]
  v_mfma_f32_16x16x32_bf16 v[32:35], v[44:47], v[68:71], v[32:35]
  s_waitcnt vmcnt(3)
  s_waitcnt lgkmcnt(0)
  s_barrier
  ds_read_b64_tr_b16 v[40:41], v243 offset:9216
  ds_read_b64_tr_b16 v[42:43], v243 offset:10240
  ds_read_b64_tr_b16 v[44:45], v243 offset:9224
  ds_read_b64_tr_b16 v[46:47], v243 offset:10248
  ds_read_b128 v[56:59], v245 offset:5120
  ds_read_b128 v[60:63], v245 offset:6144
  ds_read_b128 v[64:67], v245 offset:7168
  ds_read_b128 v[68:71], v245 offset:8192
  v_mfma_f32_16x16x32_bf16 v[0:3], v[48:51], v[76:79], v[0:3]
  v_mfma_f32_16x16x32_bf16 v[20:23], v[52:55], v[76:79], v[20:23]
  s_add_u32 s37, s73, 14
  s_and_b32 s37, s37, 15
  s_lshl_b32 s38, s37, 18
  s_lshl_b32 s37, s37, 6
  s_add_u32 m0, s67, 133120
  s_add_u32 s60, s66, s37
  buffer_load_dwordx4 v240, s[12:15], s60 offen lds
  v_mfma_f32_16x16x32_bf16 v[4:7], v[48:51], v[80:83], v[4:7]
  v_mfma_f32_16x16x32_bf16 v[24:27], v[52:55], v[80:83], v[24:27]
  s_add_u32 m0, s67, 137216
  s_add_u32 s60, s60, 65536
  buffer_load_dwordx4 v240, s[12:15], s60 offen lds
  v_mfma_f32_16x16x32_bf16 v[8:11], v[48:51], v[84:87], v[8:11]
  v_mfma_f32_16x16x32_bf16 v[28:31], v[52:55], v[84:87], v[28:31]
  s_mov_b32 m0, 141312
  s_add_u32 s60, s37, 131072
  s_mov_b64 exec, s[68:69]
  buffer_load_dwordx4 v240, s[12:15], s60 offen lds
  s_mov_b64 exec, -1
  v_mfma_f32_16x16x32_bf16 v[12:15], v[48:51], v[88:91], v[12:15]
  v_mfma_f32_16x16x32_bf16 v[32:35], v[52:55], v[88:91], v[32:35]
  s_waitcnt vmcnt(3)
  s_waitcnt lgkmcnt(0)
  s_barrier
  ds_read_b64_tr_b16 v[48:49], v243 offset:26624
  ds_read_b64_tr_b16 v[50:51], v243 offset:27648
  ds_read_b64_tr_b16 v[52:53], v243 offset:26632
  ds_read_b64_tr_b16 v[54:55], v243 offset:27656
  ds_read_b128 v[76:79], v245 offset:22528
  ds_read_b128 v[80:83], v245 offset:23552
  ds_read_b128 v[84:87], v245 offset:24576
  ds_read_b128 v[88:91], v245 offset:25600
  v_mfma_f32_16x16x32_bf16 v[0:3], v[40:43], v[56:59], v[0:3]
  v_mfma_f32_16x16x32_bf16 v[20:23], v[44:47], v[56:59], v[20:23]
  s_add_u32 s37, s73, 15
  s_and_b32 s37, s37, 15
  s_lshl_b32 s38, s37, 18
  s_lshl_b32 s37, s37, 6
  s_add_u32 m0, s67, 98304
  s_add_u32 s60, s66, s37
  buffer_load_dwordx4 v240, s[12:15], s60 offen lds
  v_mfma_f32_16x16x32_bf16 v[4:7], v[40:43], v[60:63], v[4:7]
  v_mfma_f32_16x16x32_bf16 v[24:27], v[44:47], v[60:63], v[24:27]
  s_add_u32 m0, s67, 102400
  s_add_u32 s60, s60, 65536
  buffer_load_dwordx4 v240, s[12:15], s60 offen lds
  v_mfma_f32_16x16x32_bf16 v[8:11], v[40:43], v[64:67], v[8:11]
  v_mfma_f32_16x16x32_bf16 v[28:31], v[44:47], v[64:67], v[28:31]
  s_mov_b32 m0, 106496
  s_add_u32 s60, s37, 131072
  s_mov_b64 exec, s[68:69]
  buffer_load_dwordx4 v240, s[12:15], s60 offen lds
  s_mov_b64 exec, -1
  v_mfma_f32_16x16x32_bf16 v[12:15], v[40:43], v[68:71], v[12:15]
  v_mfma_f32_16x16x32_bf16 v[32:35], v[44:47], v[68:71], v[32:35]
  s_waitcnt vmcnt(3)
  s_waitcnt lgkmcnt(0)
  s_barrier
  ds_read_b64_tr_b16 v[40:41], v243 offset:44032
  ds_read_b64_tr_b16 v[42:43], v243 offset:45056
  ds_read_b64_tr_b16 v[44:45], v243 offset:44040
  ds_read_b64_tr_b16 v[46:47], v243 offset:45064
  ds_read_b128 v[56:59], v245 offset:39936
  ds_read_b128 v[60:63], v245 offset:40960
  ds_read_b128 v[64:67], v245 offset:41984
  ds_read_b128 v[68:71], v245 offset:43008
  v_mfma_f32_16x16x32_bf16 v[0:3], v[48:51], v[76:79], v[0:3]
  v_mfma_f32_16x16x32_bf16 v[20:23], v[52:55], v[76:79], v[20:23]
  v_mfma_f32_16x16x32_bf16 v[4:7], v[48:51], v[80:83], v[4:7]
  v_mfma_f32_16x16x32_bf16 v[24:27], v[52:55], v[80:83], v[24:27]
  v_mfma_f32_16x16x32_bf16 v[8:11], v[48:51], v[84:87], v[8:11]
  v_mfma_f32_16x16x32_bf16 v[28:31], v[52:55], v[84:87], v[28:31]
  v_mfma_f32_16x16x32_bf16 v[12:15], v[48:51], v[88:91], v[12:15]
  v_mfma_f32_16x16x32_bf16 v[32:35], v[52:55], v[88:91], v[32:35]
  s_waitcnt vmcnt(0)
  s_waitcnt lgkmcnt(0)
  s_barrier
  ds_read_b64_tr_b16 v[48:49], v243 offset:9216
  ds_read_b64_tr_b16 v[50:51], v243 offset:10240
  ds_read_b64_tr_b16 v[52:53], v243 offset:9224
  ds_read_b64_tr_b16 v[54:55], v243 offset:10248
  ds_read_b128 v[76:79], v245 offset:5120
  ds_read_b128 v[80:83], v245 offset:6144
  ds_read_b128 v[84:87], v245 offset:7168
  ds_read_b128 v[88:91], v245 offset:8192
  v_mfma_f32_16x16x32_bf16 v[0:3], v[40:43], v[56:59], v[0:3]
  v_mfma_f32_16x16x32_bf16 v[20:23], v[44:47], v[56:59], v[20:23]
  v_mfma_f32_16x16x32_bf16 v[4:7], v[40:43], v[60:63], v[4:7]
  v_mfma_f32_16x16x32_bf16 v[24:27], v[44:47], v[60:63], v[24:27]
  v_mfma_f32_16x16x32_bf16 v[8:11], v[40:43], v[64:67], v[8:11]
  v_mfma_f32_16x16x32_bf16 v[28:31], v[44:47], v[64:67], v[28:31]
  v_mfma_f32_16x16x32_bf16 v[12:15], v[40:43], v[68:71], v[12:15]
  v_mfma_f32_16x16x32_bf16 v[32:35], v[44:47], v[68:71], v[32:35]
  s_waitcnt lgkmcnt(0)
  v_mfma_f32_16x16x32_bf16 v[0:3], v[48:51], v[76:79], v[0:3]
  v_mfma_f32_16x16x32_bf16 v[20:23], v[52:55], v[76:79], v[20:23]
  v_mfma_f32_16x16x32_bf16 v[4:7], v[48:51], v[80:83], v[4:7]
  v_mfma_f32_16x16x32_bf16 v[24:27], v[52:55], v[80:83], v[24:27]
  v_mfma_f32_16x16x32_bf16 v[8:11], v[48:51], v[84:87], v[8:11]
  v_mfma_f32_16x16x32_bf16 v[28:31], v[52:55], v[84:87], v[28:31]
  v_mfma_f32_16x16x32_bf16 v[12:15], v[48:51], v[88:91], v[12:15]
  v_mfma_f32_16x16x32_bf16 v[32:35], v[52:55], v[88:91], v[32:35]
  s_barrier
  s_and_b32 s60, s3, 3
  s_lshl_b32 s60, s60, 10
  s_add_u32 s60, s60, 98304
  v_add_u32 v245, s60, v242
  v_mul_f32 v0, s65, v0
  v_mul_f32 v1, s65, v1
  v_mul_f32 v2, s65, v2
  v_mul_f32 v3, s65, v3
  v_mul_f32 v20, s65, v20
  v_mul_f32 v21, s65, v21
  v_mul_f32 v22, s65, v22
  v_mul_f32 v23, s65, v23
  v_cvt_pk_bf16_f32 v40, v0, v1
  v_cvt_pk_bf16_f32 v41, v2, v3
  v_cvt_pk_bf16_f32 v42, v20, v21
  v_cvt_pk_bf16_f32 v43, v22, v23
  ds_write_b128 v245, v[40:43] offset:20480
  v_mul_f32 v4, s65, v4
  v_mul_f32 v5, s65, v5
  v_mul_f32 v6, s65, v6
  v_mul_f32 v7, s65, v7
  v_mul_f32 v24, s65, v24
  v_mul_f32 v25, s65, v25
  v_mul_f32 v26, s65, v26
  v_mul_f32 v27, s65, v27
  v_cvt_pk_bf16_f32 v44, v4, v5
  v_cvt_pk_bf16_f32 v45, v6, v7
  v_cvt_pk_bf16_f32 v46, v24, v25
  v_cvt_pk_bf16_f32 v47, v26, v27
  ds_write_b128 v245, v[44:47] offset:24576
  v_mul_f32 v8, s65, v8
  v_mul_f32 v9, s65, v9
  v_mul_f32 v10, s65, v10
  v_mul_f32 v11, s65, v11
  v_mul_f32 v28, s65, v28
  v_mul_f32 v29, s65, v29
  v_mul_f32 v30, s65, v30
  v_mul_f32 v31, s65, v31
  v_cvt_pk_bf16_f32 v48, v8, v9
  v_cvt_pk_bf16_f32 v49, v10, v11
  v_cvt_pk_bf16_f32 v50, v28, v29
  v_cvt_pk_bf16_f32 v51, v30, v31
  ds_write_b128 v245, v[48:51] offset:28672
  v_mul_f32 v12, s65, v12
  v_mul_f32 v13, s65, v13
  v_mul_f32 v14, s65, v14
  v_mul_f32 v15, s65, v15
  v_mul_f32 v32, s65, v32
  v_mul_f32 v33, s65, v33
  v_mul_f32 v34, s65, v34
  v_mul_f32 v35, s65, v35
  v_cvt_pk_bf16_f32 v52, v12, v13
  v_cvt_pk_bf16_f32 v53, v14, v15
  v_cvt_pk_bf16_f32 v54, v32, v33
  v_cvt_pk_bf16_f32 v55, v34, v35
  ds_write_b128 v245, v[52:55] offset:32768
  s_waitcnt lgkmcnt(0)
  s_barrier
  s_cmp_lg_u32 s58, s24
  s_cbranch_scc1 INIT_C
  s_lshl_b32 s60, s35, 12
  s_add_u32 s60, s60, 98304
  v_add_u32 v245, s60, v242
  ds_read_b128 v[108:111], v245 offset:0
  ds_read_b128 v[112:115], v245 offset:1024
  ds_read_b128 v[116:119], v245 offset:2048
  ds_read_b128 v[120:123], v245 offset:3072
  ds_read_b128 v[124:127], v245 offset:4096
  ds_read_b128 v[128:131], v245 offset:5120
  ds_read_b128 v[132:135], v245 offset:6144
  ds_read_b128 v[136:139], v245 offset:7168
  s_cmp_eq_u32 s26, 0
  s_cbranch_scc1 INIT_C
  s_waitcnt lgkmcnt(0)
  s_barrier
  s_mov_b32 s58, 1
  s_branch QP_C
INIT_C:
  v_mov_b32 v0, 0
  v_mov_b32 v1, 0
  v_mov_b32 v2, 0
  v_mov_b32 v3, 0
  v_mov_b32 v4, 0
  v_mov_b32 v5, 0
  v_mov_b32 v6, 0
  v_mov_b32 v7, 0
  v_mov_b32 v8, 0
  v_mov_b32 v9, 0
  v_mov_b32 v10, 0
  v_mov_b32 v11, 0
  v_mov_b32 v12, 0
  v_mov_b32 v13, 0
  v_mov_b32 v14, 0
  v_mov_b32 v15, 0
  v_mov_b32 v16, 0
  v_mov_b32 v17, 0
  v_mov_b32 v18, 0
  v_mov_b32 v19, 0
  v_mov_b32 v20, 0
  v_mov_b32 v21, 0
  v_mov_b32 v22, 0
  v_mov_b32 v23, 0
  v_mov_b32 v24, 0
  v_mov_b32 v25, 0
  v_mov_b32 v26, 0
  v_mov_b32 v27, 0
  v_mov_b32 v28, 0
  v_mov_b32 v29, 0
  v_mov_b32 v30, 0
  v_mov_b32 v31, 0
  v_mov_b32 v32, 0
  v_mov_b32 v33, 0
  v_mov_b32 v34, 0
  v_mov_b32 v35, 0
  v_mov_b32 v36, 0
  v_mov_b32 v37, 0
  v_mov_b32 v38, 0
  v_mov_b32 v39, 0
  v_mov_b32 v40, 0
  v_mov_b32 v41, 0
  v_mov_b32 v42, 0
  v_mov_b32 v43, 0
  v_mov_b32 v44, 0
  v_mov_b32 v45, 0
  v_mov_b32 v46, 0
  v_mov_b32 v47, 0
  v_mov_b32 v48, 0
  v_mov_b32 v49, 0
  v_mov_b32 v50, 0
  v_mov_b32 v51, 0
  v_mov_b32 v52, 0
  v_mov_b32 v53, 0
  v_mov_b32 v54, 0
  v_mov_b32 v55, 0
  v_mov_b32 v56, 0
  v_mov_b32 v57, 0
  v_mov_b32 v58, 0
  v_mov_b32 v59, 0
  v_mov_b32 v60, 0
  v_mov_b32 v61, 0
  v_mov_b32 v62, 0
  v_mov_b32 v63, 0
  v_mov_b32 v96, 0
  v_mov_b32 v180, 0
  v_mov_b32 v97, 0
  v_mov_b32 v181, 0
  v_mov_b32 v98, 0
  v_mov_b32 v182, 0
  v_mov_b32 v99, 0
  v_mov_b32 v183, 0
  v_mov_b32 v100, 0
  v_mov_b32 v184, 0
  v_mov_b32 v101, 0
  v_mov_b32 v185, 0
  v_mov_b32 v102, 0
  v_mov_b32 v186, 0
  v_mov_b32 v103, 0
  v_mov_b32 v187, 0
  s_waitcnt lgkmcnt(0)
  s_barrier
  ds_read_b128 v[192:195], v224 offset:0
  ds_read_b128 v[196:199], v225 offset:0
  ds_read_b128 v[200:203], v226 offset:0
  ds_read_b128 v[204:207], v227 offset:0
  ds_read_b128 v[208:211], v224 offset:4096
  ds_read_b128 v[212:215], v225 offset:4096
  ds_read_b128 v[216:219], v226 offset:4096
  ds_read_b128 v[220:223], v227 offset:4096
  s_waitcnt lgkmcnt(7)
  v_mfma_f32_16x16x32_bf16 v[156:159], v[192:195], v[108:111], v[180:183]
  v_mfma_f32_16x16x32_bf16 v[164:167], v[192:195], v[124:127], v[184:187]
  s_waitcnt lgkmcnt(6)
  v_mfma_f32_16x16x32_bf16 v[156:159], v[196:199], v[112:115], v[156:159]
  v_mfma_f32_16x16x32_bf16 v[164:167], v[196:199], v[128:131], v[164:167]
  ds_read_b64_tr_b16 v[192:193], v228 offset:0
  ds_read_b64_tr_b16 v[194:195], v228 offset:4096
  s_waitcnt lgkmcnt(7)
  v_mfma_f32_16x16x32_bf16 v[156:159], v[200:203], v[116:119], v[156:159]
  v_mfma_f32_16x16x32_bf16 v[164:167], v[200:203], v[132:135], v[164:167]
  ds_read_b64_tr_b16 v[196:197], v229 offset:0
  ds_read_b64_tr_b16 v[198:199], v229 offset:4096
  s_waitcnt lgkmcnt(8)
  v_mfma_f32_16x16x32_bf16 v[156:159], v[204:207], v[120:123], v[156:159]
  v_mfma_f32_16x16x32_bf16 v[164:167], v[204:207], v[136:139], v[164:167]
  ds_read_b64_tr_b16 v[200:201], v230 offset:0
  ds_read_b64_tr_b16 v[202:203], v230 offset:4096
  s_waitcnt lgkmcnt(9)
  v_mfma_f32_16x16x32_bf16 v[160:163], v[208:211], v[108:111], v[180:183]
  v_mfma_f32_16x16x32_bf16 v[168:171], v[208:211], v[124:127], v[184:187]
  ds_read_b64_tr_b16 v[204:205], v231 offset:0
  ds_read_b64_tr_b16 v[206:207], v231 offset:4096
  s_waitcnt lgkmcnt(10)
  v_mfma_f32_16x16x32_bf16 v[160:163], v[212:215], v[112:115], v[160:163]
  v_mfma_f32_16x16x32_bf16 v[168:171], v[212:215], v[128:131], v[168:171]
  ds_read_b64_tr_b16 v[208:209], v232 offset:0
  ds_read_b64_tr_b16 v[210:211], v232 offset:4096
  s_waitcnt lgkmcnt(11)
  v_mfma_f32_16x16x32_bf16 v[160:163], v[216:219], v[116:119], v[160:163]
  v_mfma_f32_16x16x32_bf16 v[168:171], v[216:219], v[132:135], v[168:171]
  ds_read_b64_tr_b16 v[212:213], v233 offset:0
  ds_read_b64_tr_b16 v[214:215], v233 offset:4096
  s_waitcnt lgkmcnt(12)
  v_mfma_f32_16x16x32_bf16 v[160:163], v[220:223], v[120:123], v[160:163]
  v_mfma_f32_16x16x32_bf16 v[168:171], v[220:223], v[136:139], v[168:171]
  ds_read_b64_tr_b16 v[216:217], v234 offset:0
  ds_read_b64_tr_b16 v[218:219], v234 offset:4096
  s_add_u32 s31, s31, 1
  s_cmp_eq_u32 s31, 4
  s_cselect_b32 s31, 0, s31
  s_mov_b32 s30, 32768
  s_cselect_b32 s30, 0xfffe8000, s30
  v_add_u32 v224, s30, v224
  v_add_u32 v225, s30, v225
  v_add_u32 v226, s30, v226
  v_add_u32 v227, s30, v227
  ds_read_b64_tr_b16 v[220:221], v235 offset:0
  ds_read_b64_tr_b16 v[222:223], v235 offset:4096
  v_xor_b32 v245, 16, v244
  v_lshlrev_b32 v245, 2, v245
  v_xor_b32 v246, 32, v244
  v_lshlrev_b32 v246, 2, v246
  v_max3_f32 v247, v156, v157, v158
  v_max3_f32 v247, v247, v159, v160
  v_max3_f32 v247, v247, v161, v162
  v_max_f32 v247, v247, v163
  ds_bpermute_b32 v252, v245, v247
  s_waitcnt lgkmcnt(0)
  v_max_f32 v247, v247, v252
  ds_bpermute_b32 v252, v246, v247
  s_waitcnt lgkmcnt(0)
  v_max_f32 v247, v247, v252
  v_sub_f32 v156, v156, v247
  v_sub_f32 v157, v157, v247
  v_sub_f32 v158, v158, v247
  v_sub_f32 v159, v159, v247
  v_sub_f32 v160, v160, v247
  v_sub_f32 v161, v161, v247
  v_sub_f32 v162, v162, v247
  v_sub_f32 v163, v163, v247
  v_sub_f32 v180, v180, v247
  v_sub_f32 v181, v181, v247
  v_sub_f32 v182, v182, v247
  v_sub_f32 v183, v183, v247
  v_max3_f32 v248, v164, v165, v166
  v_max3_f32 v248, v248, v167, v168
  v_max3_f32 v248, v248, v169, v170
  v_max_f32 v248, v248, v171
  ds_bpermute_b32 v252, v245, v248
  s_waitcnt lgkmcnt(0)
  v_max_f32 v248, v248, v252
  ds_bpermute_b32 v252, v246, v248
  s_waitcnt lgkmcnt(0)
  v_max_f32 v248, v248, v252
  v_sub_f32 v164, v164, v248
  v_sub_f32 v165, v165, v248
  v_sub_f32 v166, v166, v248
  v_sub_f32 v167, v167, v248
  v_sub_f32 v168, v168, v248
  v_sub_f32 v169, v169, v248
  v_sub_f32 v170, v170, v248
  v_sub_f32 v171, v171, v248
  v_sub_f32 v184, v184, v248
  v_sub_f32 v185, v185, v248
  v_sub_f32 v186, v186, v248
  v_sub_f32 v187, v187, v248
  v_exp_f32 v156, v156
  v_exp_f32 v157, v157
  v_exp_f32 v158, v158
  v_exp_f32 v159, v159
  v_exp_f32 v160, v160
  v_exp_f32 v161, v161
  v_exp_f32 v162, v162
  v_exp_f32 v163, v163
  v_cvt_pk_bf16_f32 v156, v156, v157
  v_cvt_pk_bf16_f32 v157, v158, v159
  v_cvt_pk_bf16_f32 v158, v160, v161
  v_cvt_pk_bf16_f32 v159, v162, v163
  v_exp_f32 v164, v164
  v_exp_f32 v165, v165
  v_exp_f32 v166, v166
  v_exp_f32 v167, v167
  v_exp_f32 v168, v168
  v_exp_f32 v169, v169
  v_exp_f32 v170, v170
  v_exp_f32 v171, v171
  v_cvt_pk_bf16_f32 v164, v164, v165
  v_cvt_pk_bf16_f32 v165, v166, v167
  v_cvt_pk_bf16_f32 v166, v168, v169
  v_cvt_pk_bf16_f32 v167, v170, v171
  v_add_u32 v228, s30, v228
  v_add_u32 v229, s30, v229
  v_add_u32 v230, s30, v230
  v_add_u32 v231, s30, v231
  v_add_u32 v232, s30, v232
  v_add_u32 v233, s30, v233
  v_add_u32 v234, s30, v234
  v_add_u32 v235, s30, v235
  s_mov_b32 s25, 1
LOOP_C:
  s_waitcnt lgkmcnt(0)
  s_barrier
  v_mfma_f32_16x16x32_bf16 v[0:3], v[192:195], v[156:159], v[0:3]
  v_mfma_f32_16x16x32_bf16 v[4:7], v[192:195], v[164:167], v[4:7]
  v_mfma_f32_16x16x32_bf16 v[96:99], v[236:239], v[156:159], v[96:99]
  v_mfma_f32_16x16x32_bf16 v[100:103], v[236:239], v[164:167], v[100:103]
  ds_read_b128 v[192:195], v224 offset:0
  v_mfma_f32_16x16x32_bf16 v[8:11], v[196:199], v[156:159], v[8:11]
  v_mfma_f32_16x16x32_bf16 v[12:15], v[196:199], v[164:167], v[12:15]
  ds_read_b128 v[196:199], v225 offset:0
  v_mfma_f32_16x16x32_bf16 v[16:19], v[200:203], v[156:159], v[16:19]
  v_mfma_f32_16x16x32_bf16 v[20:23], v[200:203], v[164:167], v[20:23]
  ds_read_b128 v[200:203], v226 offset:0
  v_mfma_f32_16x16x32_bf16 v[24:27], v[204:207], v[156:159], v[24:27]
  v_mfma_f32_16x16x32_bf16 v[28:31], v[204:207], v[164:167], v[28:31]
  ds_read_b128 v[204:207], v227 offset:0
  v_mfma_f32_16x16x32_bf16 v[32:35], v[208:211], v[156:159], v[32:35]
  v_mfma_f32_16x16x32_bf16 v[36:39], v[208:211], v[164:167], v[36:39]
  ds_read_b128 v[208:211], v224 offset:4096
  v_mfma_f32_16x16x32_bf16 v[40:43], v[212:215], v[156:159], v[40:43]
  v_mfma_f32_16x16x32_bf16 v[44:47], v[212:215], v[164:167], v[44:47]
  ds_read_b128 v[212:215], v225 offset:4096
  v_mfma_f32_16x16x32_bf16 v[48:51], v[216:219], v[156:159], v[48:51]
  v_mfma_f32_16x16x32_bf16 v[52:55], v[216:219], v[164:167], v[52:55]
  ds_read_b128 v[216:219], v226 offset:4096
  v_mfma_f32_16x16x32_bf16 v[56:59], v[220:223], v[156:159], v[56:59]
  v_mfma_f32_16x16x32_bf16 v[60:63], v[220:223], v[164:167], v[60:63]
  ds_read_b128 v[220:223], v227 offset:4096
  s_waitcnt lgkmcnt(7)
  v_mfma_f32_16x16x32_bf16 v[156:159], v[192:195], v[108:111], v[180:183]
  v_mfma_f32_16x16x32_bf16 v[164:167], v[192:195], v[124:127], v[184:187]
  s_waitcnt lgkmcnt(6)
  v_mfma_f32_16x16x32_bf16 v[156:159], v[196:199], v[112:115], v[156:159]
  v_mfma_f32_16x16x32_bf16 v[164:167], v[196:199], v[128:131], v[164:167]
  ds_read_b64_tr_b16 v[192:193], v228 offset:0
  ds_read_b64_tr_b16 v[194:195], v228 offset:4096
  s_waitcnt lgkmcnt(7)
  v_mfma_f32_16x16x32_bf16 v[156:159], v[200:203], v[116:119], v[156:159]
  v_mfma_f32_16x16x32_bf16 v[164:167], v[200:203], v[132:135], v[164:167]
  ds_read_b64_tr_b16 v[196:197], v229 offset:0
  ds_read_b64_tr_b16 v[198:199], v229 offset:4096
  s_waitcnt lgkmcnt(8)
  v_mfma_f32_16x16x32_bf16 v[156:159], v[204:207], v[120:123], v[156:159]
  v_mfma_f32_16x16x32_bf16 v[164:167], v[204:207], v[136:139], v[164:167]
  ds_read_b64_tr_b16 v[200:201], v230 offset:0
  ds_read_b64_tr_b16 v[202:203], v230 offset:4096
  s_waitcnt lgkmcnt(9)
  v_mfma_f32_16x16x32_bf16 v[160:163], v[208:211], v[108:111], v[180:183]
  v_mfma_f32_16x16x32_bf16 v[168:171], v[208:211], v[124:127], v[184:187]
  ds_read_b64_tr_b16 v[204:205], v231 offset:0
  ds_read_b64_tr_b16 v[206:207], v231 offset:4096
  s_waitcnt lgkmcnt(10)
  v_mfma_f32_16x16x32_bf16 v[160:163], v[212:215], v[112:115], v[160:163]
  v_mfma_f32_16x16x32_bf16 v[168:171], v[212:215], v[128:131], v[168:171]
  ds_read_b64_tr_b16 v[208:209], v232 offset:0
  ds_read_b64_tr_b16 v[210:211], v232 offset:4096
  s_waitcnt lgkmcnt(11)
  v_mfma_f32_16x16x32_bf16 v[160:163], v[216:219], v[116:119], v[160:163]
  v_mfma_f32_16x16x32_bf16 v[168:171], v[216:219], v[132:135], v[168:171]
  ds_read_b64_tr_b16 v[212:213], v233 offset:0
  ds_read_b64_tr_b16 v[214:215], v233 offset:4096
  s_waitcnt lgkmcnt(12)
  v_mfma_f32_16x16x32_bf16 v[160:163], v[220:223], v[120:123], v[160:163]
  v_mfma_f32_16x16x32_bf16 v[168:171], v[220:223], v[136:139], v[168:171]
  ds_read_b64_tr_b16 v[216:217], v234 offset:0
  ds_read_b64_tr_b16 v[218:219], v234 offset:4096
  s_add_u32 s31, s31, 1
  s_cmp_eq_u32 s31, 4
  s_cselect_b32 s31, 0, s31
  s_mov_b32 s30, 32768
  s_cselect_b32 s30, 0xfffe8000, s30
  v_add_u32 v224, s30, v224
  v_add_u32 v225, s30, v225
  v_add_u32 v226, s30, v226
  v_add_u32 v227, s30, v227
  v_max3_f32 v252, v156, v157, v158
  v_max3_f32 v252, v252, v159, v164
  v_max3_f32 v252, v252, v165, v166
  v_max3_f32 v252, v252, v167, v160
  v_max3_f32 v252, v252, v161, v162
  v_max3_f32 v252, v252, v163, v168
  v_max3_f32 v252, v252, v169, v170
  v_max_f32 v252, v252, v171
  v_cmp_lt_f32 vcc, s64, v252
  ds_read_b64_tr_b16 v[220:221], v235 offset:0
  ds_read_b64_tr_b16 v[222:223], v235 offset:4096
  s_nop 2
  s_cbranch_vccnz SLOW_C
BACK_C:
  v_exp_f32 v156, v156
  v_exp_f32 v157, v157
  v_exp_f32 v158, v158
  v_exp_f32 v159, v159
  v_exp_f32 v160, v160
  v_exp_f32 v161, v161
  v_exp_f32 v162, v162
  v_exp_f32 v163, v163
  v_cvt_pk_bf16_f32 v156, v156, v157
  v_cvt_pk_bf16_f32 v157, v158, v159
  v_cvt_pk_bf16_f32 v158, v160, v161
  v_cvt_pk_bf16_f32 v159, v162, v163
  v_exp_f32 v164, v164
  v_exp_f32 v165, v165
  v_exp_f32 v166, v166
  v_exp_f32 v167, v167
  v_exp_f32 v168, v168
  v_exp_f32 v169, v169
  v_exp_f32 v170, v170
  v_exp_f32 v171, v171
  v_cvt_pk_bf16_f32 v164, v164, v165
  v_cvt_pk_bf16_f32 v165, v166, v167
  v_cvt_pk_bf16_f32 v166, v168, v169
  v_cvt_pk_bf16_f32 v167, v170, v171
  v_add_u32 v228, s30, v228
  v_add_u32 v229, s30, v229
  v_add_u32 v230, s30, v230
  v_add_u32 v231, s30, v231
  v_add_u32 v232, s30, v232
  v_add_u32 v233, s30, v233
  v_add_u32 v234, s30, v234
  v_add_u32 v235, s30, v235
  s_add_u32 s25, s25, 1
  s_cmp_lt_u32 s25, 16
  s_cbranch_scc1 LOOP_C
  s_waitcnt lgkmcnt(0)
  v_mfma_f32_16x16x32_bf16 v[0:3], v[192:195], v[156:159], v[0:3]
  v_mfma_f32_16x16x32_bf16 v[4:7], v[192:195], v[164:167], v[4:7]
  v_mfma_f32_16x16x32_bf16 v[96:99], v[236:239], v[156:159], v[96:99]
  v_mfma_f32_16x16x32_bf16 v[100:103], v[236:239], v[164:167], v[100:103]
  v_mfma_f32_16x16x32_bf16 v[8:11], v[196:199], v[156:159], v[8:11]
  v_mfma_f32_16x16x32_bf16 v[12:15], v[196:199], v[164:167], v[12:15]
  v_mfma_f32_16x16x32_bf16 v[16:19], v[200:203], v[156:159], v[16:19]
  v_mfma_f32_16x16x32_bf16 v[20:23], v[200:203], v[164:167], v[20:23]
  v_mfma_f32_16x16x32_bf16 v[24:27], v[204:207], v[156:159], v[24:27]
  v_mfma_f32_16x16x32_bf16 v[28:31], v[204:207], v[164:167], v[28:31]
  v_mfma_f32_16x16x32_bf16 v[32:35], v[208:211], v[156:159], v[32:35]
  v_mfma_f32_16x16x32_bf16 v[36:39], v[208:211], v[164:167], v[36:39]
  v_mfma_f32_16x16x32_bf16 v[40:43], v[212:215], v[156:159], v[40:43]
  v_mfma_f32_16x16x32_bf16 v[44:47], v[212:215], v[164:167], v[44:47]
  v_mfma_f32_16x16x32_bf16 v[48:51], v[216:219], v[156:159], v[48:51]
  v_mfma_f32_16x16x32_bf16 v[52:55], v[216:219], v[164:167], v[52:55]
  v_mfma_f32_16x16x32_bf16 v[56:59], v[220:223], v[156:159], v[56:59]
  v_mfma_f32_16x16x32_bf16 v[60:63], v[220:223], v[164:167], v[60:63]
  s_cmp_gt_u32 s26, s24
  s_cbranch_scc0 L23
  s_lshl_b32 s60, s35, 12
  s_add_u32 s60, s60, 98304
  v_add_u32 v245, s60, v242
  ds_read_b128 v[108:111], v245 offset:0
  ds_read_b128 v[112:115], v245 offset:1024
  ds_read_b128 v[116:119], v245 offset:2048
  ds_read_b128 v[120:123], v245 offset:3072
  ds_read_b128 v[124:127], v245 offset:4096
  ds_read_b128 v[128:131], v245 offset:5120
  ds_read_b128 v[132:135], v245 offset:6144
  ds_read_b128 v[136:139], v245 offset:7168
  s_waitcnt lgkmcnt(0)
L23:
  s_barrier
  s_cmp_lg_u32 s24, 0
  s_cbranch_scc1 L24
  s_lshr_b32 s60, s2, 3
  s_lshl_b32 s60, s60, 3
  s_add_u32 s60, s60, s3
  s_cmp_lt_u32 s60, 64
  s_cbranch_scc0 L25
  s_mov_b32 s12, s90
  s_mov_b32 s13, s91
  s_mov_b32 s14, 4194304
  s_lshl_b32 s60, s60, 16
  s_and_b32 s61, s2, 7
  s_lshl_b32 s61, s61, 10
  s_add_u32 s60, s60, s61
  v_lshrrev_b32 v253, 3, v244
  v_and_b32 v254, 7, v244
  v_lshlrev_b32 v254, 7, v254
  v_lshl_add_u32 v253, v253, 13, v254
  buffer_load_dword v255, v253, s[12:15], s60 offen
  s_branch L26
L25:
  s_mov_b32 s12, s84
  s_mov_b32 s13, s85
  s_mov_b32 s14, 1179648
  s_sub_u32 s60, s60, 64
  s_lshl_b32 s60, s60, 13
  v_lshlrev_b32 v253, 7, v244
  buffer_load_dword v255, v253, s[12:15], s60 offen
L26:
  s_mov_b32 s14, 147456
L24:
  s_cmp_eq_u32 s24, 0
  s_cbranch_scc1 L27
  s_and_b32 s60, s2, 1
  s_mul_i32 s60, s60, 40
  s_add_u32 s62, s0, s60
  s_addc_u32 s63, s1, 0
  s_load_dwordx2 s[12:13], s[62:63], 32
  s_lshr_b32 s60, s2, 3
  s_lshl_b32 s60, s60, 3
  s_add_u32 s60, s60, s3
  s_lshl_b32 s60, s60, 14
  s_bfe_u32 s61, s2, 0x10001
  s_lshl_b32 s61, s61, 9
  s_add_u32 s60, s60, s61
  v_lshrrev_b32 v253, 2, v244
  v_and_b32 v254, 3, v244
  v_lshlrev_b32 v254, 7, v254
  v_lshl_add_u32 v253, v253, 10, v254
  s_mov_b32 s14, 4194304
  s_waitcnt lgkmcnt(0)
  buffer_load_dword v255, v253, s[12:15], s60 offen
L27:
  v_and_b32 v247, 15, v244
  v_lshlrev_b32 v247, 2, v247
  s_mul_i32 s60, s3, 384
  s_add_u32 s60, s60, 147456
  v_add_u32 v245, s60, v247
  s_mul_i32 s60, s36, 384
  s_add_u32 s60, s60, 147456
  v_add_u32 v246, s60, v247
  s_nop 7
  ds_write_b32 v245, v180 offset:0
  ds_write_b32 v245, v96 offset:64
  ds_write_b32 v245, v184 offset:128
  ds_write_b32 v245, v100 offset:192
  s_waitcnt lgkmcnt(0)
  s_barrier
  ds_read_b32 v156, v246 offset:0
  ds_read_b32 v157, v246 offset:64
  ds_read_b32 v164, v246 offset:128
  ds_read_b32 v165, v246 offset:192
  s_waitcnt lgkmcnt(0)
  v_min_f32 v158, v156, v180
  v_sub_f32 v159, v158, v180
  v_sub_f32 v160, v158, v156
  v_exp_f32 v159, v159
  v_exp_f32 v160, v160
  v_mul_f32 v161, v159, v96
  v_fma_f32 v161, v160, v157, v161
  v_rcp_f32 v161, v161
  s_nop 0
  v_mul_f32 v162, v159, v161
  v_mul_f32 v0, v162, v0
  v_mul_f32 v1, v162, v1
  v_mul_f32 v2, v162, v2
  v_mul_f32 v3, v162, v3
  v_mul_f32 v8, v162, v8
  v_mul_f32 v9, v162, v9
  v_mul_f32 v10, v162, v10
  v_mul_f32 v11, v162, v11
  v_mul_f32 v16, v162, v16
  v_mul_f32 v17, v162, v17
  v_mul_f32 v18, v162, v18
  v_mul_f32 v19, v162, v19
  v_mul_f32 v24, v162, v24
  v_mul_f32 v25, v162, v25
  v_mul_f32 v26, v162, v26
  v_mul_f32 v27, v162, v27
  v_mul_f32 v32, v162, v32
  v_mul_f32 v33, v162, v33
  v_mul_f32 v34, v162, v34
  v_mul_f32 v35, v162, v35
  v_mul_f32 v40, v162, v40
  v_mul_f32 v41, v162, v41
  v_mul_f32 v42, v162, v42
  v_mul_f32 v43, v162, v43
  v_mul_f32 v48, v162, v48
  v_mul_f32 v49, v162, v49
  v_mul_f32 v50, v162, v50
  v_mul_f32 v51, v162, v51
  v_mul_f32 v56, v162, v56
  v_mul_f32 v57, v162, v57
  v_mul_f32 v58, v162, v58
  v_mul_f32 v59, v162, v59
  v_min_f32 v166, v164, v184
  v_sub_f32 v167, v166, v184
  v_sub_f32 v168, v166, v164
  v_exp_f32 v167, v167
  v_exp_f32 v168, v168
  v_mul_f32 v169, v167, v100
  v_fma_f32 v169, v168, v165, v169
  v_rcp_f32 v169, v169
  s_nop 0
  v_mul_f32 v170, v167, v169
  v_mul_f32 v4, v170, v4
  v_mul_f32 v5, v170, v5
  v_mul_f32 v6, v170, v6
  v_mul_f32 v7, v170, v7
  v_mul_f32 v12, v170, v12
  v_mul_f32 v13, v170, v13
  v_mul_f32 v14, v170, v14
  v_mul_f32 v15, v170, v15
  v_mul_f32 v20, v170, v20
  v_mul_f32 v21, v170, v21
  v_mul_f32 v22, v170, v22
  v_mul_f32 v23, v170, v23
  v_mul_f32 v28, v170, v28
  v_mul_f32 v29, v170, v29
  v_mul_f32 v30, v170, v30
  v_mul_f32 v31, v170, v31
  v_mul_f32 v36, v170, v36
  v_mul_f32 v37, v170, v37
  v_mul_f32 v38, v170, v38
  v_mul_f32 v39, v170, v39
  v_mul_f32 v44, v170, v44
  v_mul_f32 v45, v170, v45
  v_mul_f32 v46, v170, v46
  v_mul_f32 v47, v170, v47
  v_mul_f32 v52, v170, v52
  v_mul_f32 v53, v170, v53
  v_mul_f32 v54, v170, v54
  v_mul_f32 v55, v170, v55
  v_mul_f32 v60, v170, v60
  v_mul_f32 v61, v170, v61
  v_mul_f32 v62, v170, v62
  v_mul_f32 v63, v170, v63
  s_mul_i32 s60, s3, 6144
  s_add_u32 s60, s60, 98304
  v_add_u32 v245, s60, v242
  s_mul_i32 s60, s36, 6144
  s_add_u32 s60, s60, 98304
  v_add_u32 v246, s60, v242
  s_cmp_lg_u32 s34, 0
  s_cbranch_scc1 L28
  ds_write_b128 v245, v[32:35] offset:0
  ds_write_b128 v245, v[40:43] offset:1024
  ds_write_b128 v245, v[36:39] offset:2048
  ds_write_b128 v245, v[44:47] offset:3072
  s_waitcnt lgkmcnt(0)
  s_barrier
  ds_read_b128 v[192:195], v246 offset:0
  ds_read_b128 v[196:199], v246 offset:1024
  ds_read_b128 v[200:203], v246 offset:2048
  ds_read_b128 v[204:207], v246 offset:3072
  s_waitcnt lgkmcnt(0)
  s_barrier
  v_add_f32 v0, v0, v192
  v_add_f32 v1, v1, v193
  v_add_f32 v2, v2, v194
  v_add_f32 v3, v3, v195
  v_add_f32 v8, v8, v196
  v_add_f32 v9, v9, v197
  v_add_f32 v10, v10, v198
  v_add_f32 v11, v11, v199
  v_add_f32 v4, v4, v200
  v_add_f32 v5, v5, v201
  v_add_f32 v6, v6, v202
  v_add_f32 v7, v7, v203
  v_add_f32 v12, v12, v204
  v_add_f32 v13, v13, v205
  v_add_f32 v14, v14, v206
  v_add_f32 v15, v15, v207
  ds_write_b128 v245, v[48:51] offset:0
  ds_write_b128 v245, v[56:59] offset:1024
  ds_write_b128 v245, v[52:55] offset:2048
  ds_write_b128 v245, v[60:63] offset:3072
  s_waitcnt lgkmcnt(0)
  s_barrier
  ds_read_b128 v[192:195], v246 offset:0
  ds_read_b128 v[196:199], v246 offset:1024
  ds_read_b128 v[200:203], v246 offset:2048
  ds_read_b128 v[204:207], v246 offset:3072
  s_waitcnt lgkmcnt(0)
  s_barrier
  v_add_f32 v16, v16, v192
  v_add_f32 v17, v17, v193
  v_add_f32 v18, v18, v194
  v_add_f32 v19, v19, v195
  v_add_f32 v24, v24, v196
  v_add_f32 v25, v25, v197
  v_add_f32 v26, v26, v198
  v_add_f32 v27, v27, v199
  v_add_f32 v20, v20, v200
  v_add_f32 v21, v21, v201
  v_add_f32 v22, v22, v202
  v_add_f32 v23, v23, v203
  v_add_f32 v28, v28, v204
  v_add_f32 v29, v29, v205
  v_add_f32 v30, v30, v206
  v_add_f32 v31, v31, v207
  s_mul_i32 s60, s32, 9
  s_add_u32 s60, s60, s35
  s_lshl_b32 s60, s60, 7
  s_lshl_b32 s61, s33, 2
  s_add_u32 s60, s60, s61
  s_add_u32 s60, s60, 0
  s_lshl_b32 s60, s60, 10
  v_cvt_pk_bf16_f32 v192, v0, v1
  v_cvt_pk_bf16_f32 v193, v2, v3
  v_cvt_pk_bf16_f32 v194, v8, v9
  v_cvt_pk_bf16_f32 v195, v10, v11
  s_add_u32 s61, s60, 0
  buffer_store_dwordx4 v[192:195], v242, s[20:23], s61 offen
  v_cvt_pk_bf16_f32 v196, v16, v17
  v_cvt_pk_bf16_f32 v197, v18, v19
  v_cvt_pk_bf16_f32 v198, v24, v25
  v_cvt_pk_bf16_f32 v199, v26, v27
  s_add_u32 s61, s60, 1024
  buffer_store_dwordx4 v[196:199], v242, s[20:23], s61 offen
  v_cvt_pk_bf16_f32 v200, v4, v5
  v_cvt_pk_bf16_f32 v201, v6, v7
  v_cvt_pk_bf16_f32 v202, v12, v13
  v_cvt_pk_bf16_f32 v203, v14, v15
  s_add_u32 s61, s60, 131072
  buffer_store_dwordx4 v[200:203], v242, s[20:23], s61 offen
  v_cvt_pk_bf16_f32 v204, v20, v21
  v_cvt_pk_bf16_f32 v205, v22, v23
  v_cvt_pk_bf16_f32 v206, v28, v29
  v_cvt_pk_bf16_f32 v207, v30, v31
  s_add_u32 s61, s60, 132096
  buffer_store_dwordx4 v[204:207], v242, s[20:23], s61 offen
  s_branch L29
L28:
  ds_write_b128 v245, v[0:3] offset:0
  ds_write_b128 v245, v[8:11] offset:1024
  ds_write_b128 v245, v[4:7] offset:2048
  ds_write_b128 v245, v[12:15] offset:3072
  s_waitcnt lgkmcnt(0)
  s_barrier
  ds_read_b128 v[192:195], v246 offset:0
  ds_read_b128 v[196:199], v246 offset:1024
  ds_read_b128 v[200:203], v246 offset:2048
  ds_read_b128 v[204:207], v246 offset:3072
  s_waitcnt lgkmcnt(0)
  s_barrier
  v_add_f32 v32, v32, v192
  v_add_f32 v33, v33, v193
  v_add_f32 v34, v34, v194
  v_add_f32 v35, v35, v195
  v_add_f32 v40, v40, v196
  v_add_f32 v41, v41, v197
  v_add_f32 v42, v42, v198
  v_add_f32 v43, v43, v199
  v_add_f32 v36, v36, v200
  v_add_f32 v37, v37, v201
  v_add_f32 v38, v38, v202
  v_add_f32 v39, v39, v203
  v_add_f32 v44, v44, v204
  v_add_f32 v45, v45, v205
  v_add_f32 v46, v46, v206
  v_add_f32 v47, v47, v207
  ds_write_b128 v245, v[16:19] offset:0
  ds_write_b128 v245, v[24:27] offset:1024
  ds_write_b128 v245, v[20:23] offset:2048
  ds_write_b128 v245, v[28:31] offset:3072
  s_waitcnt lgkmcnt(0)
  s_barrier
  ds_read_b128 v[192:195], v246 offset:0
  ds_read_b128 v[196:199], v246 offset:1024
  ds_read_b128 v[200:203], v246 offset:2048
  ds_read_b128 v[204:207], v246 offset:3072
  s_waitcnt lgkmcnt(0)
  s_barrier
  v_add_f32 v48, v48, v192
  v_add_f32 v49, v49, v193
  v_add_f32 v50, v50, v194
  v_add_f32 v51, v51, v195
  v_add_f32 v56, v56, v196
  v_add_f32 v57, v57, v197
  v_add_f32 v58, v58, v198
  v_add_f32 v59, v59, v199
  v_add_f32 v52, v52, v200
  v_add_f32 v53, v53, v201
  v_add_f32 v54, v54, v202
  v_add_f32 v55, v55, v203
  v_add_f32 v60, v60, v204
  v_add_f32 v61, v61, v205
  v_add_f32 v62, v62, v206
  v_add_f32 v63, v63, v207
  s_mul_i32 s60, s32, 9
  s_add_u32 s60, s60, s35
  s_lshl_b32 s60, s60, 7
  s_lshl_b32 s61, s33, 2
  s_add_u32 s60, s60, s61
  s_add_u32 s60, s60, 2
  s_lshl_b32 s60, s60, 10
  v_cvt_pk_bf16_f32 v192, v32, v33
  v_cvt_pk_bf16_f32 v193, v34, v35
  v_cvt_pk_bf16_f32 v194, v40, v41
  v_cvt_pk_bf16_f32 v195, v42, v43
  s_add_u32 s61, s60, 0
  buffer_store_dwordx4 v[192:195], v242, s[20:23], s61 offen
  v_cvt_pk_bf16_f32 v196, v48, v49
  v_cvt_pk_bf16_f32 v197, v50, v51
  v_cvt_pk_bf16_f32 v198, v56, v57
  v_cvt_pk_bf16_f32 v199, v58, v59
  s_add_u32 s61, s60, 1024
  buffer_store_dwordx4 v[196:199], v242, s[20:23], s61 offen
  v_cvt_pk_bf16_f32 v200, v36, v37
  v_cvt_pk_bf16_f32 v201, v38, v39
  v_cvt_pk_bf16_f32 v202, v44, v45
  v_cvt_pk_bf16_f32 v203, v46, v47
  s_add_u32 s61, s60, 131072
  buffer_store_dwordx4 v[200:203], v242, s[20:23], s61 offen
  v_cvt_pk_bf16_f32 v204, v52, v53
  v_cvt_pk_bf16_f32 v205, v54, v55
  v_cvt_pk_bf16_f32 v206, v60, v61
  v_cvt_pk_bf16_f32 v207, v62, v63
  s_add_u32 s61, s60, 132096
  buffer_store_dwordx4 v[204:207], v242, s[20:23], s61 offen
L29:
  s_add_u32 s24, s24, 1
  s_cmp_lt_u32 s24, 2
  s_cbranch_scc1 UNIT_C
  s_waitcnt vmcnt(0)
  s_waitcnt vmcnt(0)
  s_endpgm
SLOW_C:
  v_xor_b32 v245, 16, v244
  v_lshlrev_b32 v245, 2, v245
  v_xor_b32 v246, 32, v244
  v_lshlrev_b32 v246, 2, v246
  v_max3_f32 v247, v156, v157, v158
  v_max3_f32 v247, v247, v159, v160
  v_max3_f32 v247, v247, v161, v162
  v_max_f32 v247, v247, v163
  ds_bpermute_b32 v252, v245, v247
  s_waitcnt lgkmcnt(0)
  v_max_f32 v247, v247, v252
  ds_bpermute_b32 v252, v246, v247
  s_waitcnt lgkmcnt(0)
  v_max_f32 v247, v247, v252
  v_max_f32 v247, 0, v247
  v_sub_f32 v156, v156, v247
  v_sub_f32 v157, v157, v247
  v_sub_f32 v158, v158, v247
  v_sub_f32 v159, v159, v247
  v_sub_f32 v160, v160, v247
  v_sub_f32 v161, v161, v247
  v_sub_f32 v162, v162, v247
  v_sub_f32 v163, v163, v247
  v_sub_f32 v180, v180, v247
  v_sub_f32 v181, v181, v247
  v_sub_f32 v182, v182, v247
  v_sub_f32 v183, v183, v247
  v_max3_f32 v248, v164, v165, v166
  v_max3_f32 v248, v248, v167, v168
  v_max3_f32 v248, v248, v169, v170
  v_max_f32 v248, v248, v171
  ds_bpermute_b32 v252, v245, v248
  s_waitcnt lgkmcnt(0)
  v_max_f32 v248, v248, v252
  ds_bpermute_b32 v252, v246, v248
  s_waitcnt lgkmcnt(0)
  v_max_f32 v248, v248, v252
  v_max_f32 v248, 0, v248
  v_sub_f32 v164, v164, v248
  v_sub_f32 v165, v165, v248
  v_sub_f32 v166, v166, v248
  v_sub_f32 v167, v167, v248
  v_sub_f32 v168, v168, v248
  v_sub_f32 v169, v169, v248
  v_sub_f32 v170, v170, v248
  v_sub_f32 v171, v171, v248
  v_sub_f32 v184, v184, v248
  v_sub_f32 v185, v185, v248
  v_sub_f32 v186, v186, v248
  v_sub_f32 v187, v187, v248
  v_sub_f32 v247, 0, v247
  v_exp_f32 v247, v247
  s_nop 0
  v_mul_f32 v0, v247, v0
  v_mul_f32 v1, v247, v1
  v_mul_f32 v2, v247, v2
  v_mul_f32 v3, v247, v3
  v_mul_f32 v8, v247, v8
  v_mul_f32 v9, v247, v9
  v_mul_f32 v10, v247, v10
  v_mul_f32 v11, v247, v11
  v_mul_f32 v16, v247, v16
  v_mul_f32 v17, v247, v17
  v_mul_f32 v18, v247, v18
  v_mul_f32 v19, v247, v19
  v_mul_f32 v24, v247, v24
  v_mul_f32 v25, v247, v25
  v_mul_f32 v26, v247, v26
  v_mul_f32 v27, v247, v27
  v_mul_f32 v32, v247, v32
  v_mul_f32 v33, v247, v33
  v_mul_f32 v34, v247, v34
  v_mul_f32 v35, v247, v35
  v_mul_f32 v40, v247, v40
  v_mul_f32 v41, v247, v41
  v_mul_f32 v42, v247, v42
  v_mul_f32 v43, v247, v43
  v_mul_f32 v48, v247, v48
  v_mul_f32 v49, v247, v49
  v_mul_f32 v50, v247, v50
  v_mul_f32 v51, v247, v51
  v_mul_f32 v56, v247, v56
  v_mul_f32 v57, v247, v57
  v_mul_f32 v58, v247, v58
  v_mul_f32 v59, v247, v59
  v_mul_f32 v96, v247, v96
  v_mul_f32 v97, v247, v97
  v_mul_f32 v98, v247, v98
  v_mul_f32 v99, v247, v99
  v_sub_f32 v248, 0, v248
  v_exp_f32 v248, v248
  s_nop 0
  v_mul_f32 v4, v248, v4
  v_mul_f32 v5, v248, v5
  v_mul_f32 v6, v248, v6
  v_mul_f32 v7, v248, v7
  v_mul_f32 v12, v248, v12
  v_mul_f32 v13, v248, v13
  v_mul_f32 v14, v248, v14
  v_mul_f32 v15, v248, v15
  v_mul_f32 v20, v248, v20
  v_mul_f32 v21, v248, v21
  v_mul_f32 v22, v248, v22
  v_mul_f32 v23, v248, v23
  v_mul_f32 v28, v248, v28
  v_mul_f32 v29, v248, v29
  v_mul_f32 v30, v248, v30
  v_mul_f32 v31, v248, v31
  v_mul_f32 v36, v248, v36
  v_mul_f32 v37, v248, v37
  v_mul_f32 v38, v248, v38
  v_mul_f32 v39, v248, v39
  v_mul_f32 v44, v248, v44
  v_mul_f32 v45, v248, v45
  v_mul_f32 v46, v248, v46
  v_mul_f32 v47, v248, v47
  v_mul_f32 v52, v248, v52
  v_mul_f32 v53, v248, v53
  v_mul_f32 v54, v248, v54
  v_mul_f32 v55, v248, v55
  v_mul_f32 v60, v248, v60
  v_mul_f32 v61, v248, v61
  v_mul_f32 v62, v248, v62
  v_mul_f32 v63, v248, v63
  v_mul_f32 v100, v248, v100
  v_mul_f32 v101, v248, v101
  v_mul_f32 v102, v248, v102
  v_mul_f32 v103, v248, v103
  s_nop 1
  s_branch BACK_C
K1_D:
  v_lshrrev_b32 v245, 4, v244
  v_and_b32 v246, 15, v244
  v_lshlrev_b32 v247, 1, v245
  v_xor_b32 v248, v246, v247
  v_lshlrev_b32 v248, 4, v248
  v_lshl_add_u32 v240, v245, 8, v248
  v_xor_b32 v241, 128, v240
UNIT_D:
  s_mul_i32 s60, s24, 9437184
  s_add_u32 s20, s56, s60
  s_addc_u32 s21, s57, 0
  s_mov_b32 s58, s24
  s_and_b32 s60, s26, s24
  s_cmp_lg_u32 s60, 0
  s_cbranch_scc1 INIT_D
QP_D:
  s_cmp_eq_u32 s58, 0
  s_cselect_b32 s12, s48, s50
  s_cselect_b32 s13, s49, s51
  s_cselect_b32 s16, s52, s54
  s_cselect_b32 s17, s53, s55
  v_mov_b32 v0, 0
  v_mov_b32 v1, 0
  v_mov_b32 v2, 0
  v_mov_b32 v3, 0
  v_mov_b32 v4, 0
  v_mov_b32 v5, 0
  v_mov_b32 v6, 0
  v_mov_b32 v7, 0
  v_mov_b32 v8, 0
  v_mov_b32 v9, 0
  v_mov_b32 v10, 0
  v_mov_b32 v11, 0
  v_mov_b32 v12, 0
  v_mov_b32 v13, 0
  v_mov_b32 v14, 0
  v_mov_b32 v15, 0
  v_mov_b32 v16, 0
  v_mov_b32 v17, 0
  v_mov_b32 v18, 0
  v_mov_b32 v19, 0
  v_mov_b32 v20, 0
  v_mov_b32 v21, 0
  v_mov_b32 v22, 0
  v_mov_b32 v23, 0
  v_mov_b32 v24, 0
  v_mov_b32 v25, 0
  v_mov_b32 v26, 0
  v_mov_b32 v27, 0
  v_mov_b32 v28, 0
  v_mov_b32 v29, 0
  v_mov_b32 v30, 0
  v_mov_b32 v31, 0
  v_mov_b32 v32, 0
  v_mov_b32 v33, 0
  v_mov_b32 v34, 0
  v_mov_b32 v35, 0
  v_mov_b32 v36, 0
  v_mov_b32 v37, 0
  v_mov_b32 v38, 0
  v_mov_b32 v39, 0
  v_and_b32 v245, 15, v244
  v_lshrrev_b32 v246, 2, v245
  v_sub_u32 v246, 0, v246
  v_lshrrev_b32 v247, 4, v244
  v_xor_b32 v246, v246, v247
  v_and_b32 v246, 3, v246
  v_lshlrev_b32 v246, 4, v246
  v_lshl_add_u32 v245, v245, 6, v246
  v_add_u32 v245, 98304, v245
  v_lshrrev_b32 v101, 4, v244
  v_and_b32 v102, 15, v244
  v_lshlrev_b32 v103, 2, v101
  v_xor_b32 v103, v102, v103
  v_lshlrev_b32 v103, 4, v103
  v_lshl_add_u32 v100, v101, 13, v103
  s_lshl_b32 s70, s39, 16
  s_lshl_b32 s71, s39, 11
  s_add_u32 s37, s73, 0
  s_and_b32 s37, s37, 15
  s_lshl_b32 s38, s37, 18
  s_lshl_b32 s37, s37, 6
  s_add_u32 m0, s71, 107520
  s_add_u32 s60, s70, s38
  buffer_load_dwordx4 v100, s[16:19], s60 offen lds
  s_add_u32 m0, s71, 108544
  s_add_u32 s60, s60, 32768
  buffer_load_dwordx4 v100, s[16:19], s60 offen lds
  s_add_u32 s37, s73, 1
  s_and_b32 s37, s37, 15
  s_lshl_b32 s38, s37, 18
  s_lshl_b32 s37, s37, 6
  s_add_u32 m0, s71, 124928
  s_add_u32 s60, s70, s38
  buffer_load_dwordx4 v100, s[16:19], s60 offen lds
  s_add_u32 m0, s71, 125952
  s_add_u32 s60, s60, 32768
  buffer_load_dwordx4 v100, s[16:19], s60 offen lds
  s_add_u32 s37, s73, 2
  s_and_b32 s37, s37, 15
  s_lshl_b32 s38, s37, 18
  s_lshl_b32 s37, s37, 6
  s_add_u32 m0, s71, 142336
  s_add_u32 s60, s70, s38
  buffer_load_dwordx4 v100, s[16:19], s60 offen lds
  s_add_u32 m0, s71, 143360
  s_add_u32 s60, s60, 32768
  buffer_load_dwordx4 v100, s[16:19], s60 offen lds
  s_waitcnt vmcnt(4)
  s_barrier
  ds_read_b64_tr_b16 v[40:41], v243 offset:9216
  ds_read_b64_tr_b16 v[42:43], v243 offset:10240
  ds_read_b64_tr_b16 v[44:45], v243 offset:9224
  ds_read_b64_tr_b16 v[46:47], v243 offset:10248
  ds_read_b128 v[56:59], v245 offset:5120
  ds_read_b128 v[60:63], v245 offset:6144
  ds_read_b128 v[64:67], v245 offset:7168
  ds_read_b128 v[68:71], v245 offset:8192
  s_waitcnt vmcnt(2)
  s_waitcnt lgkmcnt(0)
  s_barrier
  ds_read_b64_tr_b16 v[48:49], v243 offset:26624
  ds_read_b64_tr_b16 v[50:51], v243 offset:27648
  ds_read_b64_tr_b16 v[52:53], v243 offset:26632
  ds_read_b64_tr_b16 v[54:55], v243 offset:27656
  ds_read_b128 v[76:79], v245 offset:22528
  ds_read_b128 v[80:83], v245 offset:23552
  ds_read_b128 v[84:87], v245 offset:24576
  ds_read_b128 v[88:91], v245 offset:25600
  v_mfma_f32_16x16x32_bf16 v[0:3], v[40:43], v[56:59], v[0:3]
  v_mfma_f32_16x16x32_bf16 v[20:23], v[44:47], v[56:59], v[20:23]
  s_add_u32 s37, s73, 3
  s_and_b32 s37, s37, 15
  s_lshl_b32 s38, s37, 18
  s_lshl_b32 s37, s37, 6
  s_add_u32 m0, s71, 107520
  s_add_u32 s60, s70, s38
  buffer_load_dwordx4 v100, s[16:19], s60 offen lds
  v_mfma_f32_16x16x32_bf16 v[4:7], v[40:43], v[60:63], v[4:7]
  v_mfma_f32_16x16x32_bf16 v[24:27], v[44:47], v[60:63], v[24:27]
  s_add_u32 m0, s71, 108544
  s_add_u32 s60, s60, 32768
  buffer_load_dwordx4 v100, s[16:19], s60 offen lds
  v_mfma_f32_16x16x32_bf16 v[8:11], v[40:43], v[64:67], v[8:11]
  v_mfma_f32_16x16x32_bf16 v[28:31], v[44:47], v[64:67], v[28:31]
  v_mfma_f32_16x16x32_bf16 v[12:15], v[40:43], v[68:71], v[12:15]
  v_mfma_f32_16x16x32_bf16 v[32:35], v[44:47], v[68:71], v[32:35]
  s_waitcnt vmcnt(2)
  s_waitcnt lgkmcnt(0)
  s_barrier
  ds_read_b64_tr_b16 v[40:41], v243 offset:44032
  ds_read_b64_tr_b16 v[42:43], v243 offset:45056
  ds_read_b64_tr_b16 v[44:45], v243 offset:44040
  ds_read_b64_tr_b16 v[46:47], v243 offset:45064
  ds_read_b128 v[56:59], v245 offset:39936
  ds_read_b128 v[60:63], v245 offset:40960
  ds_read_b128 v[64:67], v245 offset:41984
  ds_read_b128 v[68:71], v245 offset:43008
  v_mfma_f32_16x16x32_bf16 v[0:3], v[48:51], v[76:79], v[0:3]
  v_mfma_f32_16x16x32_bf16 v[20:23], v[52:55], v[76:79], v[20:23]
  s_add_u32 s37, s73, 4
  s_and_b32 s37, s37, 15
  s_lshl_b32 s38, s37, 18
  s_lshl_b32 s37, s37, 6
  s_add_u32 m0, s71, 124928
  s_add_u32 s60, s70, s38
  buffer_load_dwordx4 v100, s[16:19], s60 offen lds
  v_mfma_f32_16x16x32_bf16 v[4:7], v[48:51], v[80:83], v[4:7]
  v_mfma_f32_16x16x32_bf16 v[24:27], v[52:55], v[80:83], v[24:27]
  s_add_u32 m0, s71, 125952
  s_add_u32 s60, s60, 32768
  buffer_load_dwordx4 v100, s[16:19], s60 offen lds
  v_mfma_f32_16x16x32_bf16 v[8:11], v[48:51], v[84:87], v[8:11]
  v_mfma_f32_16x16x32_bf16 v[28:31], v[52:55], v[84:87], v[28:31]
  v_mfma_f32_16x16x32_bf16 v[12:15], v[48:51], v[88:91], v[12:15]
  v_mfma_f32_16x16x32_bf16 v[32:35], v[52:55], v[88:91], v[32:35]
  s_waitcnt vmcnt(2)
  s_waitcnt lgkmcnt(0)
  s_barrier
  ds_read_b64_tr_b16 v[48:49], v243 offset:9216
  ds_read_b64_tr_b16 v[50:51], v243 offset:10240
  ds_read_b64_tr_b16 v[52:53], v243 offset:9224
  ds_read_b64_tr_b16 v[54:55], v243 offset:10248
  ds_read_b128 v[76:79], v245 offset:5120
  ds_read_b128 v[80:83], v245 offset:6144
  ds_read_b128 v[84:87], v245 offset:7168
  ds_read_b128 v[88:91], v245 offset:8192
  v_mfma_f32_16x16x32_bf16 v[0:3], v[40:43], v[56:59], v[0:3]
  v_mfma_f32_16x16x32_bf16 v[20:23], v[44:47], v[56:59], v[20:23]
  s_add_u32 s37, s73, 5
  s_and_b32 s37, s37, 15
  s_lshl_b32 s38, s37, 18
  s_lshl_b32 s37, s37, 6
  s_add_u32 m0, s71, 142336
  s_add_u32 s60, s70, s38
  buffer_load_dwordx4 v100, s[16:19], s60 offen lds
  v_mfma_f32_16x16x32_bf16 v[4:7], v[40:43], v[60:63], v[4:7]
  v_mfma_f32_16x16x32_bf16 v[24:27], v[44:47], v[60:63], v[24:27]
  s_add_u32 m0, s71, 143360
  s_add_u32 s60, s60, 32768
  buffer_load_dwordx4 v100, s[16:19], s60 offen lds
  v_mfma_f32_16x16x32_bf16 v[8:11], v[40:43], v[64:67], v[8:11]
  v_mfma_f32_16x16x32_bf16 v[28:31], v[44:47], v[64:67], v[28:31]
  v_mfma_f32_16x16x32_bf16 v[12:15], v[40:43], v[68:71], v[12:15]
  v_mfma_f32_16x16x32_bf16 v[32:35], v[44:47], v[68:71], v[32:35]
  s_waitcnt vmcnt(2)
  s_waitcnt lgkmcnt(0)
  s_barrier
  ds_read_b64_tr_b16 v[40:41], v243 offset:26624
  ds_read_b64_tr_b16 v[42:43], v243 offset:27648
  ds_read_b64_tr_b16 v[44:45], v243 offset:26632
  ds_read_b64_tr_b16 v[46:47], v243 offset:27656
  ds_read_b128 v[56:59], v245 offset:22528
  ds_read_b128 v[60:63], v245 offset:23552
  ds_read_b128 v[64:67], v245 offset:24576
  ds_read_b128 v[68:71], v245 offset:25600
  v_mfma_f32_16x16x32_bf16 v[0:3], v[48:51], v[76:79], v[0:3]
  v_mfma_f32_16x16x32_bf16 v[20:23], v[52:55], v[76:79], v[20:23]
  s_add_u32 s37, s73, 6
  s_and_b32 s37, s37, 15
  s_lshl_b32 s38, s37, 18
  s_lshl_b32 s37, s37, 6
  s_add_u32 m0, s71, 107520
  s_add_u32 s60, s70, s38
  buffer_load_dwordx4 v100, s[16:19], s60 offen lds
  v_mfma_f32_16x16x32_bf16 v[4:7], v[48:51], v[80:83], v[4:7]
  v_mfma_f32_16x16x32_bf16 v[24:27], v[52:55], v[80:83], v[24:27]
  s_add_u32 m0, s71, 108544
  s_add_u32 s60, s60, 32768
  buffer_load_dwordx4 v100, s[16:19], s60 offen lds
  v_mfma_f32_16x16x32_bf16 v[8:11], v[48:51], v[84:87], v[8:11]
  v_mfma_f32_16x16x32_bf16 v[28:31], v[52:55], v[84:87], v[28:31]
  v_mfma_f32_16x16x32_bf16 v[12:15], v[48:51], v[88:91], v[12:15]
  v_mfma_f32_16x16x32_bf16 v[32:35], v[52:55], v[88:91], v[32:35]
  s_waitcnt vmcnt(2)
  s_waitcnt lgkmcnt(0)
  s_barrier
  ds_read_b64_tr_b16 v[48:49], v243 offset:44032
  ds_read_b64_tr_b16 v[50:51], v243 offset:45056
  ds_read_b64_tr_b16 v[52:53], v243 offset:44040
  ds_read_b64_tr_b16 v[54:55], v243 offset:45064
  ds_read_b128 v[76:79], v245 offset:39936
  ds_read_b128 v[80:83], v245 offset:40960
  ds_read_b128 v[84:87], v245 offset:41984
  ds_read_b128 v[88:91], v245 offset:43008
  v_mfma_f32_16x16x32_bf16 v[0:3], v[40:43], v[56:59], v[0:3]
  v_mfma_f32_16x16x32_bf16 v[20:23], v[44:47], v[56:59], v[20:23]
  s_add_u32 s37, s73, 7
  s_and_b32 s37, s37, 15
  s_lshl_b32 s38, s37, 18
  s_lshl_b32 s37, s37, 6
  s_add_u32 m0, s71, 124928
  s_add_u32 s60, s70, s38
  buffer_load_dwordx4 v100, s[16:19], s60 offen lds
  v_mfma_f32_16x16x32_bf16 v[4:7], v[40:43], v[60:63], v[4:7]
  v_mfma_f32_16x16x32_bf16 v[24:27], v[44:47], v[60:63], v[24:27]
  s_add_u32 m0, s71, 125952
  s_add_u32 s60, s60, 32768
  buffer_load_dwordx4 v100, s[16:19], s60 offen lds
  v_mfma_f32_16x16x32_bf16 v[8:11], v[40:43], v[64:67], v[8:11]
  v_mfma_f32_16x16x32_bf16 v[28:31], v[44:47], v[64:67], v[28:31]
  v_mfma_f32_16x16x32_bf16 v[12:15], v[40:43], v[68:71], v[12:15]
  v_mfma_f32_16x16x32_bf16 v[32:35], v[44:47], v[68:71], v[32:35]
  s_waitcnt vmcnt(2)
  s_waitcnt lgkmcnt(0)
  s_barrier
  ds_read_b64_tr_b16 v[40:41], v243 offset:9216
  ds_read_b64_tr_b16 v[42:43], v243 offset:10240
  ds_read_b64_tr_b16 v[44:45], v243 offset:9224
  ds_read_b64_tr_b16 v[46:47], v243 offset:10248
  ds_read_b128 v[56:59], v245 offset:5120
  ds_read_b128 v[60:63], v245 offset:6144
  ds_read_b128 v[64:67], v245 offset:7168
  ds_read_b128 v[68:71], v245 offset:8192
  v_mfma_f32_16x16x32_bf16 v[0:3], v[48:51], v[76:79], v[0:3]
  v_mfma_f32_16x16x32_bf16 v[20:23], v[52:55], v[76:79], v[20:23]
  s_add_u32 s37, s73, 8
  s_and_b32 s37, s37, 15
  s_lshl_b32 s38, s37, 18
  s_lshl_b32 s37, s37, 6
  s_add_u32 m0, s71, 142336
  s_add_u32 s60, s70, s38
  buffer_load_dwordx4 v100, s[16:19], s60 offen lds
  v_mfma_f32_16x16x32_bf16 v[4:7], v[48:51], v[80:83], v[4:7]
  v_mfma_f32_16x16x32_bf16 v[24:27], v[52:55], v[80:83], v[24:27]
  s_add_u32 m0, s71, 143360
  s_add_u32 s60, s60, 32768
  buffer_load_dwordx4 v100, s[16:19], s60 offen lds
  v_mfma_f32_16x16x32_bf16 v[8:11], v[48:51], v[84:87], v[8:11]
  v_mfma_f32_16x16x32_bf16 v[28:31], v[52:55], v[84:87], v[28:31]
  v_mfma_f32_16x16x32_bf16 v[12:15], v[48:51], v[88:91], v[12:15]
  v_mfma_f32_16x16x32_bf16 v[32:35], v[52:55], v[88:91], v[32:35]
  s_waitcnt vmcnt(2)
  s_waitcnt lgkmcnt(0)
  s_barrier
  ds_read_b64_tr_b16 v[48:49], v243 offset:26624
  ds_read_b64_tr_b16 v[50:51], v243 offset:27648
  ds_read_b64_tr_b16 v[52:53], v243 offset:26632
  ds_read_b64_tr_b16 v[54:55], v243 offset:27656
  ds_read_b128 v[76:79], v245 offset:22528
  ds_read_b128 v[80:83], v245 offset:23552
  ds_read_b128 v[84:87], v245 offset:24576
  ds_read_b128 v[88:91], v245 offset:25600
  v_mfma_f32_16x16x32_bf16 v[0:3], v[40:43], v[56:59], v[0:3]
  v_mfma_f32_16x16x32_bf16 v[20:23], v[44:47], v[56:59], v[20:23]
  s_add_u32 s37, s73, 9
  s_and_b32 s37, s37, 15
  s_lshl_b32 s38, s37, 18
  s_lshl_b32 s37, s37, 6
  s_add_u32 m0, s71, 107520
  s_add_u32 s60, s70, s38
  buffer_load_dwordx4 v100, s[16:19], s60 offen lds
  v_mfma_f32_16x16x32_bf16 v[4:7], v[40:43], v[60:63], v[4:7]
  v_mfma_f32_16x16x32_bf16 v[24:27], v[44:47], v[60:63], v[24:27]
  s_add_u32 m0, s71, 108544
  s_add_u32 s60, s60, 32768
  buffer_load_dwordx4 v100, s[16:19], s60 offen lds
  v_mfma_f32_16x16x32_bf16 v[8:11], v[40:43], v[64:67], v[8:11]
  v_mfma_f32_16x16x32_bf16 v[28:31], v[44:47], v[64:67], v[28:31]
  v_mfma_f32_16x16x32_bf16 v[12:15], v[40:43], v[68:71], v[12:15]
  v_mfma_f32_16x16x32_bf16 v[32:35], v[44:47], v[68:71], v[32:35]
  s_waitcnt vmcnt(2)
  s_waitcnt lgkmcnt(0)
  s_barrier
  ds_read_b64_tr_b16 v[40:41], v243 offset:44032
  ds_read_b64_tr_b16 v[42:43], v243 offset:45056
  ds_read_b64_tr_b16 v[44:45], v243 offset:44040
  ds_read_b64_tr_b16 v[46:47], v243 offset:45064
  ds_read_b128 v[56:59], v245 offset:39936
  ds_read_b128 v[60:63], v245 offset:40960
  ds_read_b128 v[64:67], v245 offset:41984
  ds_read_b128 v[68:71], v245 offset:43008
  v_mfma_f32_16x16x32_bf16 v[0:3], v[48:51], v[76:79], v[0:3]
  v_mfma_f32_16x16x32_bf16 v[20:23], v[52:55], v[76:79], v[20:23]
  s_add_u32 s37, s73, 10
  s_and_b32 s37, s37, 15
  s_lshl_b32 s38, s37, 18
  s_lshl_b32 s37, s37, 6
  s_add_u32 m0, s71, 124928
  s_add_u32 s60, s70, s38
  buffer_load_dwordx4 v100, s[16:19], s60 offen lds
  v_mfma_f32_16x16x32_bf16 v[4:7], v[48:51], v[80:83], v[4:7]
  v_mfma_f32_16x16x32_bf16 v[24:27], v[52:55], v[80:83], v[24:27]
  s_add_u32 m0, s71, 125952
  s_add_u32 s60, s60, 32768
  buffer_load_dwordx4 v100, s[16:19], s60 offen lds
  v_mfma_f32_16x16x32_bf16 v[8:11], v[48:51], v[84:87], v[8:11]
  v_mfma_f32_16x16x32_bf16 v[28:31], v[52:55], v[84:87], v[28:31]
  v_mfma_f32_16x16x32_bf16 v[12:15], v[48:51], v[88:91], v[12:15]
  v_mfma_f32_16x16x32_bf16 v[32:35], v[52:55], v[88:91], v[32:35]
  s_waitcnt vmcnt(2)
  s_waitcnt lgkmcnt(0)
  s_barrier
  ds_read_b64_tr_b16 v[48:49], v243 offset:9216
  ds_read_b64_tr_b16 v[50:51], v243 offset:10240
  ds_read_b64_tr_b16 v[52:53], v243 offset:9224
  ds_read_b64_tr_b16 v[54:55], v243 offset:10248
  ds_read_b128 v[76:79], v245 offset:5120
  ds_read_b128 v[80:83], v245 offset:6144
  ds_read_b128 v[84:87], v245 offset:7168
  ds_read_b128 v[88:91], v245 offset:8192
  v_mfma_f32_16x16x32_bf16 v[0:3], v[40:43], v[56:59], v[0:3]
  v_mfma_f32_16x16x32_bf16 v[20:23], v[44:47], v[56:59], v[20:23]
  s_add_u32 s37, s73, 11
  s_and_b32 s37, s37, 15
  s_lshl_b32 s38, s37, 18
  s_lshl_b32 s37, s37, 6
  s_add_u32 m0, s71, 142336
  s_add_u32 s60, s70, s38
  buffer_load_dwordx4 v100, s[16:19], s60 offen lds
  v_mfma_f32_16x16x32_bf16 v[4:7], v[40:43], v[60:63], v[4:7]
  v_mfma_f32_16x16x32_bf16 v[24:27], v[44:47], v[60:63], v[24:27]
  s_add_u32 m0, s71, 143360
  s_add_u32 s60, s60, 32768
  buffer_load_dwordx4 v100, s[16:19], s60 offen lds
  v_mfma_f32_16x16x32_bf16 v[8:11], v[40:43], v[64:67], v[8:11]
  v_mfma_f32_16x16x32_bf16 v[28:31], v[44:47], v[64:67], v[28:31]
  v_mfma_f32_16x16x32_bf16 v[12:15], v[40:43], v[68:71], v[12:15]
  v_mfma_f32_16x16x32_bf16 v[32:35], v[44:47], v[68:71], v[32:35]
  s_waitcnt vmcnt(2)
  s_waitcnt lgkmcnt(0)
  s_barrier
  ds_read_b64_tr_b16 v[40:41], v243 offset:26624
  ds_read_b64_tr_b16 v[42:43], v243 offset:27648
  ds_read_b64_tr_b16 v[44:45], v243 offset:26632
  ds_read_b64_tr_b16 v[46:47], v243 offset:27656
  ds_read_b128 v[56:59], v245 offset:22528
  ds_read_b128 v[60:63], v245 offset:23552
  ds_read_b128 v[64:67], v245 offset:24576
  ds_read_b128 v[68:71], v245 offset:25600
  v_mfma_f32_16x16x32_bf16 v[0:3], v[48:51], v[76:79], v[0:3]
  v_mfma_f32_16x16x32_bf16 v[20:23], v[52:55], v[76:79], v[20:23]
  s_add_u32 s37, s73, 12
  s_and_b32 s37, s37, 15
  s_lshl_b32 s38, s37, 18
  s_lshl_b32 s37, s37, 6
  s_add_u32 m0, s71, 107520
  s_add_u32 s60, s70, s38
  buffer_load_dwordx4 v100, s[16:19], s60 offen lds
  v_mfma_f32_16x16x32_bf16 v[4:7], v[48:51], v[80:83], v[4:7]
  v_mfma_f32_16x16x32_bf16 v[24:27], v[52:55], v[80:83], v[24:27]
  s_add_u32 m0, s71, 108544
  s_add_u32 s60, s60, 32768
  buffer_load_dwordx4 v100, s[16:19], s60 offen lds
  v_mfma_f32_16x16x32_bf16 v[8:11], v[48:51], v[84:87], v[8:11]
  v_mfma_f32_16x16x32_bf16 v[28:31], v[52:55], v[84:87], v[28:31]
  v_mfma_f32_16x16x32_bf16 v[12:15], v[48:51], v[88:91], v[12:15]
  v_mfma_f32_16x16x32_bf16 v[32:35], v[52:55], v[88:91], v[32:35]
  s_waitcnt vmcnt(2)
  s_waitcnt lgkmcnt(0)
  s_barrier
  ds_read_b64_tr_b16 v[48:49], v243 offset:44032
  ds_read_b64_tr_b16 v[50:51], v243 offset:45056
  ds_read_b64_tr_b16 v[52:53], v243 offset:44040
  ds_read_b64_tr_b16 v[54:55], v243 offset:45064
  ds_read_b128 v[76:79], v245 offset:39936
  ds_read_b128 v[80:83], v245 offset:40960
  ds_read_b128 v[84:87], v245 offset:41984
  ds_read_b128 v[88:91], v245 offset:43008
  v_mfma_f32_16x16x32_bf16 v[0:3], v[40:43], v[56:59], v[0:3]
  v_mfma_f32_16x16x32_bf16 v[20:23], v[44:47], v[56:59], v[20:23]
  s_add_u32 s37, s73, 13
  s_and_b32 s37, s37, 15
  s_lshl_b32 s38, s37, 18
  s_lshl_b32 s37, s37, 6
  s_add_u32 m0, s71, 124928
  s_add_u32 s60, s70, s38
  buffer_load_dwordx4 v100, s[16:19], s60 offen lds
  v_mfma_f32_16x16x32_bf16 v[4:7], v[40:43], v[60:63], v[4:7]
  v_mfma_f32_16x16x32_bf16 v[24:27], v[44:47], v[60:63], v[24:27]
  s_add_u32 m0, s71, 125952
  s_add_u32 s60, s60, 32768
  buffer_load_dwordx4 v100, s[16:19], s60 offen lds
  v_mfma_f32_16x16x32_bf16 v[8:11], v[40:43], v[64:67], v[8:11]
  v_mfma_f32_16x16x32_bf16 v[28:31], v[44:47], v[64:67], v[28:31]
  v_mfma_f32_16x16x32_bf16 v[12:15], v[40:43], v[68:71], v[12:15]
  v_mfma_f32_16x16x32_bf16 v[32:35], v[44:47], v[68:71], v[32:35]
  s_waitcnt vmcnt(2)
  s_waitcnt lgkmcnt(0)
  s_barrier
  ds_read_b64_tr_b16 v[40:41], v243 offset:9216
  ds_read_b64_tr_b16 v[42:43], v243 offset:10240
  ds_read_b64_tr_b16 v[44:45], v243 offset:9224
  ds_read_b64_tr_b16 v[46:47], v243 offset:10248
  ds_read_b128 v[56:59], v245 offset:5120
  ds_read_b128 v[60:63], v245 offset:6144
  ds_read_b128 v[64:67], v245 offset:7168
  ds_read_b128 v[68:71], v245 offset:8192
  v_mfma_f32_16x16x32_bf16 v[0:3], v[48:51], v[76:79], v[0:3]
  v_mfma_f32_16x16x32_bf16 v[20:23], v[52:55], v[76:79], v[20:23]
  s_add_u32 s37, s73, 14
  s_and_b32 s37, s37, 15
  s_lshl_b32 s38, s37, 18
  s_lshl_b32 s37, s37, 6
  s_add_u32 m0, s71, 142336
  s_add_u32 s60, s70, s38
  buffer_load_dwordx4 v100, s[16:19], s60 offen lds
  v_mfma_f32_16x16x32_bf16 v[4:7], v[48:51], v[80:83], v[4:7]
  v_mfma_f32_16x16x32_bf16 v[24:27], v[52:55], v[80:83], v[24:27]
  s_add_u32 m0, s71, 143360
  s_add_u32 s60, s60, 32768
  buffer_load_dwordx4 v100, s[16:19], s60 offen lds
  v_mfma_f32_16x16x32_bf16 v[8:11], v[48:51], v[84:87], v[8:11]
  v_mfma_f32_16x16x32_bf16 v[28:31], v[52:55], v[84:87], v[28:31]
  v_mfma_f32_16x16x32_bf16 v[12:15], v[48:51], v[88:91], v[12:15]
  v_mfma_f32_16x16x32_bf16 v[32:35], v[52:55], v[88:91], v[32:35]
  s_waitcnt vmcnt(2)
  s_waitcnt lgkmcnt(0)
  s_barrier
  ds_read_b64_tr_b16 v[48:49], v243 offset:26624
  ds_read_b64_tr_b16 v[50:51], v243 offset:27648
  ds_read_b64_tr_b16 v[52:53], v243 offset:26632
  ds_read_b64_tr_b16 v[54:55], v243 offset:27656
  ds_read_b128 v[76:79], v245 offset:22528
  ds_read_b128 v[80:83], v245 offset:23552
  ds_read_b128 v[84:87], v245 offset:24576
  ds_read_b128 v[88:91], v245 offset:25600
  v_mfma_f32_16x16x32_bf16 v[0:3], v[40:43], v[56:59], v[0:3]
  v_mfma_f32_16x16x32_bf16 v[20:23], v[44:47], v[56:59], v[20:23]
  s_add_u32 s37, s73, 15
  s_and_b32 s37, s37, 15
  s_lshl_b32 s38, s37, 18
  s_lshl_b32 s37, s37, 6
  s_add_u32 m0, s71, 107520
  s_add_u32 s60, s70, s38
  buffer_load_dwordx4 v100, s[16:19], s60 offen lds
  v_mfma_f32_16x16x32_bf16 v[4:7], v[40:43], v[60:63], v[4:7]
  v_mfma_f32_16x16x32_bf16 v[24:27], v[44:47], v[60:63], v[24:27]
  s_add_u32 m0, s71, 108544
  s_add_u32 s60, s60, 32768
  buffer_load_dwordx4 v100, s[16:19], s60 offen lds
  v_mfma_f32_16x16x32_bf16 v[8:11], v[40:43], v[64:67], v[8:11]
  v_mfma_f32_16x16x32_bf16 v[28:31], v[44:47], v[64:67], v[28:31]
  v_mfma_f32_16x16x32_bf16 v[12:15], v[40:43], v[68:71], v[12:15]
  v_mfma_f32_16x16x32_bf16 v[32:35], v[44:47], v[68:71], v[32:35]
  s_waitcnt vmcnt(2)
  s_waitcnt lgkmcnt(0)
  s_barrier
  ds_read_b64_tr_b16 v[40:41], v243 offset:44032
  ds_read_b64_tr_b16 v[42:43], v243 offset:45056
  ds_read_b64_tr_b16 v[44:45], v243 offset:44040
  ds_read_b64_tr_b16 v[46:47], v243 offset:45064
  ds_read_b128 v[56:59], v245 offset:39936
  ds_read_b128 v[60:63], v245 offset:40960
  ds_read_b128 v[64:67], v245 offset:41984
  ds_read_b128 v[68:71], v245 offset:43008
  v_mfma_f32_16x16x32_bf16 v[0:3], v[48:51], v[76:79], v[0:3]
  v_mfma_f32_16x16x32_bf16 v[20:23], v[52:55], v[76:79], v[20:23]
  v_mfma_f32_16x16x32_bf16 v[4:7], v[48:51], v[80:83], v[4:7]
  v_mfma_f32_16x16x32_bf16 v[24:27], v[52:55], v[80:83], v[24:27]
  v_mfma_f32_16x16x32_bf16 v[8:11], v[48:51], v[84:87], v[8:11]
  v_mfma_f32_16x16x32_bf16 v[28:31], v[52:55], v[84:87], v[28:31]
  v_mfma_f32_16x16x32_bf16 v[12:15], v[48:51], v[88:91], v[12:15]
  v_mfma_f32_16x16x32_bf16 v[32:35], v[52:55], v[88:91], v[32:35]
  s_waitcnt vmcnt(0)
  s_waitcnt lgkmcnt(0)
  s_barrier
  ds_read_b64_tr_b16 v[48:49], v243 offset:9216
  ds_read_b64_tr_b16 v[50:51], v243 offset:10240
  ds_read_b64_tr_b16 v[52:53], v243 offset:9224
  ds_read_b64_tr_b16 v[54:55], v243 offset:10248
  ds_read_b128 v[76:79], v245 offset:5120
  ds_read_b128 v[80:83], v245 offset:6144
  ds_read_b128 v[84:87], v245 offset:7168
  ds_read_b128 v[88:91], v245 offset:8192
  s_cmp_eq_u32 s24, 0
  s_cbranch_scc0 L30
  s_lshl_b32 s60, s39, 12
  s_add_u32 s61, s28, s60
  s_add_u32 s62, s27, s60
  s_mov_b32 m0, s61
  s_nop 0
  buffer_load_dwordx4 v240, s[4:7], s62 offen offset:0 nt lds
  buffer_load_dwordx4 v241, s[4:7], s62 offen offset:1024 nt lds
  buffer_load_dwordx4 v240, s[4:7], s62 offen offset:2048 nt lds
  buffer_load_dwordx4 v241, s[4:7], s62 offen offset:3072 nt lds
  s_add_u32 m0, s61, 16384
  s_nop 0
  buffer_load_dwordx4 v240, s[8:11], s62 offen offset:0 nt lds
  buffer_load_dwordx4 v241, s[8:11], s62 offen offset:1024 nt lds
  buffer_load_dwordx4 v240, s[8:11], s62 offen offset:2048 nt lds
  buffer_load_dwordx4 v241, s[8:11], s62 offen offset:3072 nt lds
  s_add_u32 s28, s28, 32768
  s_cmp_eq_u32 s28, 131072
  s_cselect_b32 s28, 0, s28
  s_add_u32 s27, s27, 16384
  s_cmp_lg_u32 s27, 262144
  s_cbranch_scc1 L31
  s_mov_b32 s27, 0
  s_mov_b32 s4, s42
  s_mov_b32 s5, s43
  s_mov_b32 s8, s46
  s_mov_b32 s9, s47
  s_add_u32 s29, s29, 1
  s_cmp_eq_u32 s29, 1
  s_cselect_b32 s6, 262144, 0
  s_cselect_b32 s10, 262144, 0
L31:
  s_lshl_b32 s60, s39, 12
  s_add_u32 s61, s28, s60
  s_add_u32 s62, s27, s60
  s_mov_b32 m0, s61
  s_nop 0
  buffer_load_dwordx4 v240, s[4:7], s62 offen offset:0 nt lds
  buffer_load_dwordx4 v241, s[4:7], s62 offen offset:1024 nt lds
  buffer_load_dwordx4 v240, s[4:7], s62 offen offset:2048 nt lds
  buffer_load_dwordx4 v241, s[4:7], s62 offen offset:3072 nt lds
  s_add_u32 m0, s61, 16384
  s_nop 0
  buffer_load_dwordx4 v240, s[8:11], s62 offen offset:0 nt lds
  buffer_load_dwordx4 v241, s[8:11], s62 offen offset:1024 nt lds
  buffer_load_dwordx4 v240, s[8:11], s62 offen offset:2048 nt lds
  buffer_load_dwordx4 v241, s[8:11], s62 offen offset:3072 nt lds
  s_add_u32 s28, s28, 32768
  s_cmp_eq_u32 s28, 131072
  s_cselect_b32 s28, 0, s28
  s_add_u32 s27, s27, 16384
  s_cmp_lg_u32 s27, 262144
  s_cbranch_scc1 L32
  s_mov_b32 s27, 0
  s_mov_b32 s4, s42
  s_mov_b32 s5, s43
  s_mov_b32 s8, s46
  s_mov_b32 s9, s47
  s_add_u32 s29, s29, 1
  s_cmp_eq_u32 s29, 1
  s_cselect_b32 s6, 262144, 0
  s_cselect_b32 s10, 262144, 0
L32:
  s_lshl_b32 s60, s39, 12
  s_add_u32 s61, s28, s60
  s_add_u32 s62, s27, s60
  s_mov_b32 m0, s61
  s_nop 0
  buffer_load_dwordx4 v240, s[4:7], s62 offen offset:0 nt lds
  buffer_load_dwordx4 v241, s[4:7], s62 offen offset:1024 nt lds
  buffer_load_dwordx4 v240, s[4:7], s62 offen offset:2048 nt lds
  buffer_load_dwordx4 v241, s[4:7], s62 offen offset:3072 nt lds
  s_add_u32 m0, s61, 16384
  s_nop 0
  buffer_load_dwordx4 v240, s[8:11], s62 offen offset:0 nt lds
  buffer_load_dwordx4 v241, s[8:11], s62 offen offset:1024 nt lds
  buffer_load_dwordx4 v240, s[8:11], s62 offen offset:2048 nt lds
  buffer_load_dwordx4 v241, s[8:11], s62 offen offset:3072 nt lds
  s_add_u32 s28, s28, 32768
  s_cmp_eq_u32 s28, 131072
  s_cselect_b32 s28, 0, s28
  s_add_u32 s27, s27, 16384
  s_cmp_lg_u32 s27, 262144
  s_cbranch_scc1 L33
  s_mov_b32 s27, 0
  s_mov_b32 s4, s42
  s_mov_b32 s5, s43
  s_mov_b32 s8, s46
  s_mov_b32 s9, s47
  s_add_u32 s29, s29, 1
  s_cmp_eq_u32 s29, 1
  s_cselect_b32 s6, 262144, 0
  s_cselect_b32 s10, 262144, 0
L33:
L30:
  v_mfma_f32_16x16x32_bf16 v[0:3], v[40:43], v[56:59], v[0:3]
  v_mfma_f32_16x16x32_bf16 v[20:23], v[44:47], v[56:59], v[20:23]
  v_mfma_f32_16x16x32_bf16 v[4:7], v[40:43], v[60:63], v[4:7]
  v_mfma_f32_16x16x32_bf16 v[24:27], v[44:47], v[60:63], v[24:27]
  v_mfma_f32_16x16x32_bf16 v[8:11], v[40:43], v[64:67], v[8:11]
  v_mfma_f32_16x16x32_bf16 v[28:31], v[44:47], v[64:67], v[28:31]
  v_mfma_f32_16x16x32_bf16 v[12:15], v[40:43], v[68:71], v[12:15]
  v_mfma_f32_16x16x32_bf16 v[32:35], v[44:47], v[68:71], v[32:35]
  s_waitcnt lgkmcnt(0)
  v_mfma_f32_16x16x32_bf16 v[0:3], v[48:51], v[76:79], v[0:3]
  v_mfma_f32_16x16x32_bf16 v[20:23], v[52:55], v[76:79], v[20:23]
  v_mfma_f32_16x16x32_bf16 v[4:7], v[48:51], v[80:83], v[4:7]
  v_mfma_f32_16x16x32_bf16 v[24:27], v[52:55], v[80:83], v[24:27]
  v_mfma_f32_16x16x32_bf16 v[8:11], v[48:51], v[84:87], v[8:11]
  v_mfma_f32_16x16x32_bf16 v[28:31], v[52:55], v[84:87], v[28:31]
  v_mfma_f32_16x16x32_bf16 v[12:15], v[48:51], v[88:91], v[12:15]
  v_mfma_f32_16x16x32_bf16 v[32:35], v[52:55], v[88:91], v[32:35]
  s_barrier
  s_and_b32 s60, s3, 3
  s_lshl_b32 s60, s60, 10
  s_add_u32 s60, s60, 98304
  v_add_u32 v245, s60, v242
  v_mul_f32 v0, s65, v0
  v_mul_f32 v1, s65, v1
  v_mul_f32 v2, s65, v2
  v_mul_f32 v3, s65, v3
  v_mul_f32 v20, s65, v20
  v_mul_f32 v21, s65, v21
  v_mul_f32 v22, s65, v22
  v_mul_f32 v23, s65, v23
  v_cvt_pk_bf16_f32 v40, v0, v1
  v_cvt_pk_bf16_f32 v41, v2, v3
  v_cvt_pk_bf16_f32 v42, v20, v21
  v_cvt_pk_bf16_f32 v43, v22, v23
  ds_write_b128 v245, v[40:43] offset:20480
  v_mul_f32 v4, s65, v4
  v_mul_f32 v5, s65, v5
  v_mul_f32 v6, s65, v6
  v_mul_f32 v7, s65, v7
  v_mul_f32 v24, s65, v24
  v_mul_f32 v25, s65, v25
  v_mul_f32 v26, s65, v26
  v_mul_f32 v27, s65, v27
  v_cvt_pk_bf16_f32 v44, v4, v5
  v_cvt_pk_bf16_f32 v45, v6, v7
  v_cvt_pk_bf16_f32 v46, v24, v25
  v_cvt_pk_bf16_f32 v47, v26, v27
  ds_write_b128 v245, v[44:47] offset:24576
  v_mul_f32 v8, s65, v8
  v_mul_f32 v9, s65, v9
  v_mul_f32 v10, s65, v10
  v_mul_f32 v11, s65, v11
  v_mul_f32 v28, s65, v28
  v_mul_f32 v29, s65, v29
  v_mul_f32 v30, s65, v30
  v_mul_f32 v31, s65, v31
  v_cvt_pk_bf16_f32 v48, v8, v9
  v_cvt_pk_bf16_f32 v49, v10, v11
  v_cvt_pk_bf16_f32 v50, v28, v29
  v_cvt_pk_bf16_f32 v51, v30, v31
  ds_write_b128 v245, v[48:51] offset:28672
  v_mul_f32 v12, s65, v12
  v_mul_f32 v13, s65, v13
  v_mul_f32 v14, s65, v14
  v_mul_f32 v15, s65, v15
  v_mul_f32 v32, s65, v32
  v_mul_f32 v33, s65, v33
  v_mul_f32 v34, s65, v34
  v_mul_f32 v35, s65, v35
  v_cvt_pk_bf16_f32 v52, v12, v13
  v_cvt_pk_bf16_f32 v53, v14, v15
  v_cvt_pk_bf16_f32 v54, v32, v33
  v_cvt_pk_bf16_f32 v55, v34, v35
  ds_write_b128 v245, v[52:55] offset:32768
  s_waitcnt lgkmcnt(0)
  s_barrier
  s_cmp_lg_u32 s58, s24
  s_cbranch_scc1 INIT_D
  s_lshl_b32 s60, s35, 12
  s_add_u32 s60, s60, 98304
  v_add_u32 v245, s60, v242
  ds_read_b128 v[108:111], v245 offset:0
  ds_read_b128 v[112:115], v245 offset:1024
  ds_read_b128 v[116:119], v245 offset:2048
  ds_read_b128 v[120:123], v245 offset:3072
  ds_read_b128 v[124:127], v245 offset:4096
  ds_read_b128 v[128:131], v245 offset:5120
  ds_read_b128 v[132:135], v245 offset:6144
  ds_read_b128 v[136:139], v245 offset:7168
  s_cmp_eq_u32 s26, 0
  s_cbranch_scc1 INIT_D
  s_waitcnt lgkmcnt(0)
  s_barrier
  s_mov_b32 s58, 1
  s_branch QP_D
INIT_D:
  v_mov_b32 v0, 0
  v_mov_b32 v1, 0
  v_mov_b32 v2, 0
  v_mov_b32 v3, 0
  v_mov_b32 v4, 0
  v_mov_b32 v5, 0
  v_mov_b32 v6, 0
  v_mov_b32 v7, 0
  v_mov_b32 v8, 0
  v_mov_b32 v9, 0
  v_mov_b32 v10, 0
  v_mov_b32 v11, 0
  v_mov_b32 v12, 0
  v_mov_b32 v13, 0
  v_mov_b32 v14, 0
  v_mov_b32 v15, 0
  v_mov_b32 v16, 0
  v_mov_b32 v17, 0
  v_mov_b32 v18, 0
  v_mov_b32 v19, 0
  v_mov_b32 v20, 0
  v_mov_b32 v21, 0
  v_mov_b32 v22, 0
  v_mov_b32 v23, 0
  v_mov_b32 v24, 0
  v_mov_b32 v25, 0
  v_mov_b32 v26, 0
  v_mov_b32 v27, 0
  v_mov_b32 v28, 0
  v_mov_b32 v29, 0
  v_mov_b32 v30, 0
  v_mov_b32 v31, 0
  v_mov_b32 v32, 0
  v_mov_b32 v33, 0
  v_mov_b32 v34, 0
  v_mov_b32 v35, 0
  v_mov_b32 v36, 0
  v_mov_b32 v37, 0
  v_mov_b32 v38, 0
  v_mov_b32 v39, 0
  v_mov_b32 v40, 0
  v_mov_b32 v41, 0
  v_mov_b32 v42, 0
  v_mov_b32 v43, 0
  v_mov_b32 v44, 0
  v_mov_b32 v45, 0
  v_mov_b32 v46, 0
  v_mov_b32 v47, 0
  v_mov_b32 v48, 0
  v_mov_b32 v49, 0
  v_mov_b32 v50, 0
  v_mov_b32 v51, 0
  v_mov_b32 v52, 0
  v_mov_b32 v53, 0
  v_mov_b32 v54, 0
  v_mov_b32 v55, 0
  v_mov_b32 v56, 0
  v_mov_b32 v57, 0
  v_mov_b32 v58, 0
  v_mov_b32 v59, 0
  v_mov_b32 v60, 0
  v_mov_b32 v61, 0
  v_mov_b32 v62, 0
  v_mov_b32 v63, 0
  v_mov_b32 v96, 0
  v_mov_b32 v180, 0
  v_mov_b32 v97, 0
  v_mov_b32 v181, 0
  v_mov_b32 v98, 0
  v_mov_b32 v182, 0
  v_mov_b32 v99, 0
  v_mov_b32 v183, 0
  v_mov_b32 v100, 0
  v_mov_b32 v184, 0
  v_mov_b32 v101, 0
  v_mov_b32 v185, 0
  v_mov_b32 v102, 0
  v_mov_b32 v186, 0
  v_mov_b32 v103, 0
  v_mov_b32 v187, 0
  s_waitcnt vmcnt(16)
  s_waitcnt lgkmcnt(0)
  s_barrier
  ds_read_b128 v[192:195], v224 offset:0
  ds_read_b128 v[196:199], v225 offset:0
  ds_read_b128 v[200:203], v226 offset:0
  ds_read_b128 v[204:207], v227 offset:0
  ds_read_b128 v[208:211], v224 offset:4096
  ds_read_b128 v[212:215], v225 offset:4096
  ds_read_b128 v[216:219], v226 offset:4096
  ds_read_b128 v[220:223], v227 offset:4096
  s_waitcnt lgkmcnt(7)
  v_mfma_f32_16x16x32_bf16 v[156:159], v[192:195], v[108:111], v[180:183]
  v_mfma_f32_16x16x32_bf16 v[164:167], v[192:195], v[124:127], v[184:187]
  s_lshl_b32 s60, s39, 12
  s_add_u32 s61, s28, s60
  s_add_u32 s62, s27, s60
  s_mov_b32 m0, s61
  s_nop 0
  buffer_load_dwordx4 v240, s[4:7], s62 offen offset:0 nt lds
  s_waitcnt lgkmcnt(6)
  v_mfma_f32_16x16x32_bf16 v[156:159], v[196:199], v[112:115], v[156:159]
  v_mfma_f32_16x16x32_bf16 v[164:167], v[196:199], v[128:131], v[164:167]
  ds_read_b64_tr_b16 v[192:193], v228 offset:0
  ds_read_b64_tr_b16 v[194:195], v228 offset:4096
  buffer_load_dwordx4 v241, s[4:7], s62 offen offset:1024 nt lds
  s_waitcnt lgkmcnt(7)
  v_mfma_f32_16x16x32_bf16 v[156:159], v[200:203], v[116:119], v[156:159]
  v_mfma_f32_16x16x32_bf16 v[164:167], v[200:203], v[132:135], v[164:167]
  ds_read_b64_tr_b16 v[196:197], v229 offset:0
  ds_read_b64_tr_b16 v[198:199], v229 offset:4096
  buffer_load_dwordx4 v240, s[4:7], s62 offen offset:2048 nt lds
  s_waitcnt lgkmcnt(8)
  v_mfma_f32_16x16x32_bf16 v[156:159], v[204:207], v[120:123], v[156:159]
  v_mfma_f32_16x16x32_bf16 v[164:167], v[204:207], v[136:139], v[164:167]
  ds_read_b64_tr_b16 v[200:201], v230 offset:0
  ds_read_b64_tr_b16 v[202:203], v230 offset:4096
  buffer_load_dwordx4 v241, s[4:7], s62 offen offset:3072 nt lds
  s_waitcnt lgkmcnt(9)
  v_mfma_f32_16x16x32_bf16 v[160:163], v[208:211], v[108:111], v[180:183]
  v_mfma_f32_16x16x32_bf16 v[168:171], v[208:211], v[124:127], v[184:187]
  ds_read_b64_tr_b16 v[204:205], v231 offset:0
  ds_read_b64_tr_b16 v[206:207], v231 offset:4096
  s_add_u32 m0, s61, 16384
  s_nop 0
  buffer_load_dwordx4 v240, s[8:11], s62 offen offset:0 nt lds
  s_waitcnt lgkmcnt(10)
  v_mfma_f32_16x16x32_bf16 v[160:163], v[212:215], v[112:115], v[160:163]
  v_mfma_f32_16x16x32_bf16 v[168:171], v[212:215], v[128:131], v[168:171]
  ds_read_b64_tr_b16 v[208:209], v232 offset:0
  ds_read_b64_tr_b16 v[210:211], v232 offset:4096
  buffer_load_dwordx4 v241, s[8:11], s62 offen offset:1024 nt lds
  s_waitcnt lgkmcnt(11)
  v_mfma_f32_16x16x32_bf16 v[160:163], v[216:219], v[116:119], v[160:163]
  v_mfma_f32_16x16x32_bf16 v[168:171], v[216:219], v[132:135], v[168:171]
  ds_read_b64_tr_b16 v[212:213], v233 offset:0
  ds_read_b64_tr_b16 v[214:215], v233 offset:4096
  buffer_load_dwordx4 v240, s[8:11], s62 offen offset:2048 nt lds
  s_waitcnt lgkmcnt(12)
  v_mfma_f32_16x16x32_bf16 v[160:163], v[220:223], v[120:123], v[160:163]
  v_mfma_f32_16x16x32_bf16 v[168:171], v[220:223], v[136:139], v[168:171]
  ds_read_b64_tr_b16 v[216:217], v234 offset:0
  ds_read_b64_tr_b16 v[218:219], v234 offset:4096
  buffer_load_dwordx4 v241, s[8:11], s62 offen offset:3072 nt lds
  s_add_u32 s28, s28, 32768
  s_cmp_eq_u32 s28, 131072
  s_cselect_b32 s28, 0, s28
  s_add_u32 s27, s27, 16384
  s_cmp_lg_u32 s27, 262144
  s_cbranch_scc1 L34
  s_mov_b32 s27, 0
  s_mov_b32 s4, s42
  s_mov_b32 s5, s43
  s_mov_b32 s8, s46
  s_mov_b32 s9, s47
  s_add_u32 s29, s29, 1
  s_cmp_eq_u32 s29, 1
  s_cselect_b32 s6, 262144, 0
  s_cselect_b32 s10, 262144, 0
L34:
  s_add_u32 s31, s31, 1
  s_cmp_eq_u32 s31, 4
  s_cselect_b32 s31, 0, s31
  s_mov_b32 s30, 32768
  s_cselect_b32 s30, 0xfffe8000, s30
  v_add_u32 v224, s30, v224
  v_add_u32 v225, s30, v225
  v_add_u32 v226, s30, v226
  v_add_u32 v227, s30, v227
  ds_read_b64_tr_b16 v[220:221], v235 offset:0
  ds_read_b64_tr_b16 v[222:223], v235 offset:4096
  v_xor_b32 v245, 16, v244
  v_lshlrev_b32 v245, 2, v245
  v_xor_b32 v246, 32, v244
  v_lshlrev_b32 v246, 2, v246
  v_max3_f32 v247, v156, v157, v158
  v_max3_f32 v247, v247, v159, v160
  v_max3_f32 v247, v247, v161, v162
  v_max_f32 v247, v247, v163
  ds_bpermute_b32 v252, v245, v247
  s_waitcnt lgkmcnt(0)
  v_max_f32 v247, v247, v252
  ds_bpermute_b32 v252, v246, v247
  s_waitcnt lgkmcnt(0)
  v_max_f32 v247, v247, v252
  v_sub_f32 v156, v156, v247
  v_sub_f32 v157, v157, v247
  v_sub_f32 v158, v158, v247
  v_sub_f32 v159, v159, v247
  v_sub_f32 v160, v160, v247
  v_sub_f32 v161, v161, v247
  v_sub_f32 v162, v162, v247
  v_sub_f32 v163, v163, v247
  v_sub_f32 v180, v180, v247
  v_sub_f32 v181, v181, v247
  v_sub_f32 v182, v182, v247
  v_sub_f32 v183, v183, v247
  v_max3_f32 v248, v164, v165, v166
  v_max3_f32 v248, v248, v167, v168
  v_max3_f32 v248, v248, v169, v170
  v_max_f32 v248, v248, v171
  ds_bpermute_b32 v252, v245, v248
  s_waitcnt lgkmcnt(0)
  v_max_f32 v248, v248, v252
  ds_bpermute_b32 v252, v246, v248
  s_waitcnt lgkmcnt(0)
  v_max_f32 v248, v248, v252
  v_sub_f32 v164, v164, v248
  v_sub_f32 v165, v165, v248
  v_sub_f32 v166, v166, v248
  v_sub_f32 v167, v167, v248
  v_sub_f32 v168, v168, v248
  v_sub_f32 v169, v169, v248
  v_sub_f32 v170, v170, v248
  v_sub_f32 v171, v171, v248
  v_sub_f32 v184, v184, v248
  v_sub_f32 v185, v185, v248
  v_sub_f32 v186, v186, v248
  v_sub_f32 v187, v187, v248
  v_exp_f32 v156, v156
  v_exp_f32 v157, v157
  v_exp_f32 v158, v158
  v_exp_f32 v159, v159
  v_exp_f32 v160, v160
  v_exp_f32 v161, v161
  v_exp_f32 v162, v162
  v_exp_f32 v163, v163
  v_cvt_pk_bf16_f32 v156, v156, v157
  v_cvt_pk_bf16_f32 v157, v158, v159
  v_cvt_pk_bf16_f32 v158, v160, v161
  v_cvt_pk_bf16_f32 v159, v162, v163
  v_exp_f32 v164, v164
  v_exp_f32 v165, v165
  v_exp_f32 v166, v166
  v_exp_f32 v167, v167
  v_exp_f32 v168, v168
  v_exp_f32 v169, v169
  v_exp_f32 v170, v170
  v_exp_f32 v171, v171
  v_cvt_pk_bf16_f32 v164, v164, v165
  v_cvt_pk_bf16_f32 v165, v166, v167
  v_cvt_pk_bf16_f32 v166, v168, v169
  v_cvt_pk_bf16_f32 v167, v170, v171
  v_add_u32 v228, s30, v228
  v_add_u32 v229, s30, v229
  v_add_u32 v230, s30, v230
  v_add_u32 v231, s30, v231
  v_add_u32 v232, s30, v232
  v_add_u32 v233, s30, v233
  v_add_u32 v234, s30, v234
  v_add_u32 v235, s30, v235
  s_mov_b32 s25, 1
LOOP_D:
  s_waitcnt vmcnt(16)
  s_waitcnt lgkmcnt(0)
  s_barrier
  v_mfma_f32_16x16x32_bf16 v[0:3], v[192:195], v[156:159], v[0:3]
  v_mfma_f32_16x16x32_bf16 v[4:7], v[192:195], v[164:167], v[4:7]
  v_mfma_f32_16x16x32_bf16 v[96:99], v[236:239], v[156:159], v[96:99]
  v_mfma_f32_16x16x32_bf16 v[100:103], v[236:239], v[164:167], v[100:103]
  ds_read_b128 v[192:195], v224 offset:0
  s_lshl_b32 s60, s39, 12
  s_add_u32 s61, s28, s60
  s_add_u32 s62, s27, s60
  s_mov_b32 m0, s61
  s_nop 0
  buffer_load_dwordx4 v240, s[4:7], s62 offen offset:0 nt lds
  v_mfma_f32_16x16x32_bf16 v[8:11], v[196:199], v[156:159], v[8:11]
  v_mfma_f32_16x16x32_bf16 v[12:15], v[196:199], v[164:167], v[12:15]
  ds_read_b128 v[196:199], v225 offset:0
  buffer_load_dwordx4 v241, s[4:7], s62 offen offset:1024 nt lds
  v_mfma_f32_16x16x32_bf16 v[16:19], v[200:203], v[156:159], v[16:19]
  v_mfma_f32_16x16x32_bf16 v[20:23], v[200:203], v[164:167], v[20:23]
  ds_read_b128 v[200:203], v226 offset:0
  buffer_load_dwordx4 v240, s[4:7], s62 offen offset:2048 nt lds
  v_mfma_f32_16x16x32_bf16 v[24:27], v[204:207], v[156:159], v[24:27]
  v_mfma_f32_16x16x32_bf16 v[28:31], v[204:207], v[164:167], v[28:31]
  ds_read_b128 v[204:207], v227 offset:0
  buffer_load_dwordx4 v241, s[4:7], s62 offen offset:3072 nt lds
  v_mfma_f32_16x16x32_bf16 v[32:35], v[208:211], v[156:159], v[32:35]
  v_mfma_f32_16x16x32_bf16 v[36:39], v[208:211], v[164:167], v[36:39]
  ds_read_b128 v[208:211], v224 offset:4096
  s_add_u32 m0, s61, 16384
  s_nop 0
  buffer_load_dwordx4 v240, s[8:11], s62 offen offset:0 nt lds
  v_mfma_f32_16x16x32_bf16 v[40:43], v[212:215], v[156:159], v[40:43]
  v_mfma_f32_16x16x32_bf16 v[44:47], v[212:215], v[164:167], v[44:47]
  ds_read_b128 v[212:215], v225 offset:4096
  buffer_load_dwordx4 v241, s[8:11], s62 offen offset:1024 nt lds
  v_mfma_f32_16x16x32_bf16 v[48:51], v[216:219], v[156:159], v[48:51]
  v_mfma_f32_16x16x32_bf16 v[52:55], v[216:219], v[164:167], v[52:55]
  ds_read_b128 v[216:219], v226 offset:4096
  buffer_load_dwordx4 v240, s[8:11], s62 offen offset:2048 nt lds
  v_mfma_f32_16x16x32_bf16 v[56:59], v[220:223], v[156:159], v[56:59]
  v_mfma_f32_16x16x32_bf16 v[60:63], v[220:223], v[164:167], v[60:63]
  ds_read_b128 v[220:223], v227 offset:4096
  buffer_load_dwordx4 v241, s[8:11], s62 offen offset:3072 nt lds
  s_waitcnt lgkmcnt(7)
  v_mfma_f32_16x16x32_bf16 v[156:159], v[192:195], v[108:111], v[180:183]
  v_mfma_f32_16x16x32_bf16 v[164:167], v[192:195], v[124:127], v[184:187]
  s_waitcnt lgkmcnt(6)
  v_mfma_f32_16x16x32_bf16 v[156:159], v[196:199], v[112:115], v[156:159]
  v_mfma_f32_16x16x32_bf16 v[164:167], v[196:199], v[128:131], v[164:167]
  ds_read_b64_tr_b16 v[192:193], v228 offset:0
  ds_read_b64_tr_b16 v[194:195], v228 offset:4096
  s_waitcnt lgkmcnt(7)
  v_mfma_f32_16x16x32_bf16 v[156:159], v[200:203], v[116:119], v[156:159]
  v_mfma_f32_16x16x32_bf16 v[164:167], v[200:203], v[132:135], v[164:167]
  ds_read_b64_tr_b16 v[196:197], v229 offset:0
  ds_read_b64_tr_b16 v[198:199], v229 offset:4096
  s_waitcnt lgkmcnt(8)
  v_mfma_f32_16x16x32_bf16 v[156:159], v[204:207], v[120:123], v[156:159]
  v_mfma_f32_16x16x32_bf16 v[164:167], v[204:207], v[136:139], v[164:167]
  ds_read_b64_tr_b16 v[200:201], v230 offset:0
  ds_read_b64_tr_b16 v[202:203], v230 offset:4096
  s_waitcnt lgkmcnt(9)
  v_mfma_f32_16x16x32_bf16 v[160:163], v[208:211], v[108:111], v[180:183]
  v_mfma_f32_16x16x32_bf16 v[168:171], v[208:211], v[124:127], v[184:187]
  ds_read_b64_tr_b16 v[204:205], v231 offset:0
  ds_read_b64_tr_b16 v[206:207], v231 offset:4096
  s_waitcnt lgkmcnt(10)
  v_mfma_f32_16x16x32_bf16 v[160:163], v[212:215], v[112:115], v[160:163]
  v_mfma_f32_16x16x32_bf16 v[168:171], v[212:215], v[128:131], v[168:171]
  ds_read_b64_tr_b16 v[208:209], v232 offset:0
  ds_read_b64_tr_b16 v[210:211], v232 offset:4096
  s_waitcnt lgkmcnt(11)
  v_mfma_f32_16x16x32_bf16 v[160:163], v[216:219], v[116:119], v[160:163]
  v_mfma_f32_16x16x32_bf16 v[168:171], v[216:219], v[132:135], v[168:171]
  ds_read_b64_tr_b16 v[212:213], v233 offset:0
  ds_read_b64_tr_b16 v[214:215], v233 offset:4096
  s_waitcnt lgkmcnt(12)
  v_mfma_f32_16x16x32_bf16 v[160:163], v[220:223], v[120:123], v[160:163]
  v_mfma_f32_16x16x32_bf16 v[168:171], v[220:223], v[136:139], v[168:171]
  ds_read_b64_tr_b16 v[216:217], v234 offset:0
  ds_read_b64_tr_b16 v[218:219], v234 offset:4096
  s_add_u32 s28, s28, 32768
  s_cmp_eq_u32 s28, 131072
  s_cselect_b32 s28, 0, s28
  s_add_u32 s27, s27, 16384
  s_cmp_lg_u32 s27, 262144
  s_cbranch_scc1 L35
  s_mov_b32 s27, 0
  s_mov_b32 s4, s42
  s_mov_b32 s5, s43
  s_mov_b32 s8, s46
  s_mov_b32 s9, s47
  s_add_u32 s29, s29, 1
  s_cmp_eq_u32 s29, 1
  s_cselect_b32 s6, 262144, 0
  s_cselect_b32 s10, 262144, 0
L35:
  s_add_u32 s31, s31, 1
  s_cmp_eq_u32 s31, 4
  s_cselect_b32 s31, 0, s31
  s_mov_b32 s30, 32768
  s_cselect_b32 s30, 0xfffe8000, s30
  v_add_u32 v224, s30, v224
  v_add_u32 v225, s30, v225
  v_add_u32 v226, s30, v226
  v_add_u32 v227, s30, v227
  v_max3_f32 v252, v156, v157, v158
  v_max3_f32 v252, v252, v159, v164
  v_max3_f32 v252, v252, v165, v166
  v_max3_f32 v252, v252, v167, v160
  v_max3_f32 v252, v252, v161, v162
  v_max3_f32 v252, v252, v163, v168
  v_max3_f32 v252, v252, v169, v170
  v_max_f32 v252, v252, v171
  v_cmp_lt_f32 vcc, s64, v252
  ds_read_b64_tr_b16 v[220:221], v235 offset:0
  ds_read_b64_tr_b16 v[222:223], v235 offset:4096
  s_nop 2
  s_cbranch_vccnz SLOW_D
BACK_D:
  v_exp_f32 v156, v156
  v_exp_f32 v157, v157
  v_exp_f32 v158, v158
  v_exp_f32 v159, v159
  v_exp_f32 v160, v160
  v_exp_f32 v161, v161
  v_exp_f32 v162, v162
  v_exp_f32 v163, v163
  v_cvt_pk_bf16_f32 v156, v156, v157
  v_cvt_pk_bf16_f32 v157, v158, v159
  v_cvt_pk_bf16_f32 v158, v160, v161
  v_cvt_pk_bf16_f32 v159, v162, v163
  v_exp_f32 v164, v164
  v_exp_f32 v165, v165
  v_exp_f32 v166, v166
  v_exp_f32 v167, v167
  v_exp_f32 v168, v168
  v_exp_f32 v169, v169
  v_exp_f32 v170, v170
  v_exp_f32 v171, v171
  v_cvt_pk_bf16_f32 v164, v164, v165
  v_cvt_pk_bf16_f32 v165, v166, v167
  v_cvt_pk_bf16_f32 v166, v168, v169
  v_cvt_pk_bf16_f32 v167, v170, v171
  v_add_u32 v228, s30, v228
  v_add_u32 v229, s30, v229
  v_add_u32 v230, s30, v230
  v_add_u32 v231, s30, v231
  v_add_u32 v232, s30, v232
  v_add_u32 v233, s30, v233
  v_add_u32 v234, s30, v234
  v_add_u32 v235, s30, v235
  s_add_u32 s25, s25, 1
  s_cmp_lt_u32 s25, 16
  s_cbranch_scc1 LOOP_D
  s_waitcnt lgkmcnt(0)
  v_mfma_f32_16x16x32_bf16 v[0:3], v[192:195], v[156:159], v[0:3]
  v_mfma_f32_16x16x32_bf16 v[4:7], v[192:195], v[164:167], v[4:7]
  v_mfma_f32_16x16x32_bf16 v[96:99], v[236:239], v[156:159], v[96:99]
  v_mfma_f32_16x16x32_bf16 v[100:103], v[236:239], v[164:167], v[100:103]
  v_mfma_f32_16x16x32_bf16 v[8:11], v[196:199], v[156:159], v[8:11]
  v_mfma_f32_16x16x32_bf16 v[12:15], v[196:199], v[164:167], v[12:15]
  v_mfma_f32_16x16x32_bf16 v[16:19], v[200:203], v[156:159], v[16:19]
  v_mfma_f32_16x16x32_bf16 v[20:23], v[200:203], v[164:167], v[20:23]
  v_mfma_f32_16x16x32_bf16 v[24:27], v[204:207], v[156:159], v[24:27]
  v_mfma_f32_16x16x32_bf16 v[28:31], v[204:207], v[164:167], v[28:31]
  v_mfma_f32_16x16x32_bf16 v[32:35], v[208:211], v[156:159], v[32:35]
  v_mfma_f32_16x16x32_bf16 v[36:39], v[208:211], v[164:167], v[36:39]
  v_mfma_f32_16x16x32_bf16 v[40:43], v[212:215], v[156:159], v[40:43]
  v_mfma_f32_16x16x32_bf16 v[44:47], v[212:215], v[164:167], v[44:47]
  v_mfma_f32_16x16x32_bf16 v[48:51], v[216:219], v[156:159], v[48:51]
  v_mfma_f32_16x16x32_bf16 v[52:55], v[216:219], v[164:167], v[52:55]
  v_mfma_f32_16x16x32_bf16 v[56:59], v[220:223], v[156:159], v[56:59]
  v_mfma_f32_16x16x32_bf16 v[60:63], v[220:223], v[164:167], v[60:63]
  s_cmp_gt_u32 s26, s24
  s_cbranch_scc0 L36
  s_lshl_b32 s60, s35, 12
  s_add_u32 s60, s60, 98304
  v_add_u32 v245, s60, v242
  ds_read_b128 v[108:111], v245 offset:0
  ds_read_b128 v[112:115], v245 offset:1024
  ds_read_b128 v[116:119], v245 offset:2048
  ds_read_b128 v[120:123], v245 offset:3072
  ds_read_b128 v[124:127], v245 offset:4096
  ds_read_b128 v[128:131], v245 offset:5120
  ds_read_b128 v[132:135], v245 offset:6144
  ds_read_b128 v[136:139], v245 offset:7168
  s_waitcnt lgkmcnt(0)
L36:
  s_barrier
  s_cmp_lg_u32 s24, 0
  s_cbranch_scc1 L37
  s_lshr_b32 s60, s2, 3
  s_lshl_b32 s60, s60, 3
  s_add_u32 s60, s60, s3
  s_cmp_lt_u32 s60, 64
  s_cbranch_scc0 L38
  s_mov_b32 s12, s90
  s_mov_b32 s13, s91
  s_mov_b32 s14, 4194304
  s_lshl_b32 s60, s60, 16
  s_and_b32 s61, s2, 7
  s_lshl_b32 s61, s61, 10
  s_add_u32 s60, s60, s61
  v_lshrrev_b32 v253, 3, v244
  v_and_b32 v254, 7, v244
  v_lshlrev_b32 v254, 7, v254
  v_lshl_add_u32 v253, v253, 13, v254
  buffer_load_dword v255, v253, s[12:15], s60 offen
  s_branch L39
L38:
  s_mov_b32 s12, s84
  s_mov_b32 s13, s85
  s_mov_b32 s14, 1179648
  s_sub_u32 s60, s60, 64
  s_lshl_b32 s60, s60, 13
  v_lshlrev_b32 v253, 7, v244
  buffer_load_dword v255, v253, s[12:15], s60 offen
L39:
  s_mov_b32 s14, 147456
L37:
  s_cmp_eq_u32 s24, 0
  s_cbranch_scc1 L40
  s_and_b32 s60, s2, 1
  s_mul_i32 s60, s60, 40
  s_add_u32 s62, s0, s60
  s_addc_u32 s63, s1, 0
  s_load_dwordx2 s[12:13], s[62:63], 32
  s_lshr_b32 s60, s2, 3
  s_lshl_b32 s60, s60, 3
  s_add_u32 s60, s60, s3
  s_lshl_b32 s60, s60, 14
  s_bfe_u32 s61, s2, 0x10001
  s_lshl_b32 s61, s61, 9
  s_add_u32 s60, s60, s61
  v_lshrrev_b32 v253, 2, v244
  v_and_b32 v254, 3, v244
  v_lshlrev_b32 v254, 7, v254
  v_lshl_add_u32 v253, v253, 10, v254
  s_mov_b32 s14, 4194304
  s_waitcnt lgkmcnt(0)
  buffer_load_dword v255, v253, s[12:15], s60 offen
L40:
  v_and_b32 v247, 15, v244
  v_lshlrev_b32 v247, 2, v247
  s_mul_i32 s60, s3, 384
  s_add_u32 s60, s60, 147456
  v_add_u32 v245, s60, v247
  s_mul_i32 s60, s36, 384
  s_add_u32 s60, s60, 147456
  v_add_u32 v246, s60, v247
  s_nop 7
  ds_write_b32 v245, v180 offset:0
  ds_write_b32 v245, v96 offset:64
  ds_write_b32 v245, v184 offset:128
  ds_write_b32 v245, v100 offset:192
  s_waitcnt lgkmcnt(0)
  s_barrier
  ds_read_b32 v156, v246 offset:0
  ds_read_b32 v157, v246 offset:64
  ds_read_b32 v164, v246 offset:128
  ds_read_b32 v165, v246 offset:192
  s_waitcnt lgkmcnt(0)
  v_min_f32 v158, v156, v180
  v_sub_f32 v159, v158, v180
  v_sub_f32 v160, v158, v156
  v_exp_f32 v159, v159
  v_exp_f32 v160, v160
  v_mul_f32 v161, v159, v96
  v_fma_f32 v161, v160, v157, v161
  v_rcp_f32 v161, v161
  s_nop 0
  v_mul_f32 v162, v159, v161
  v_mul_f32 v0, v162, v0
  v_mul_f32 v1, v162, v1
  v_mul_f32 v2, v162, v2
  v_mul_f32 v3, v162, v3
  v_mul_f32 v8, v162, v8
  v_mul_f32 v9, v162, v9
  v_mul_f32 v10, v162, v10
  v_mul_f32 v11, v162, v11
  v_mul_f32 v16, v162, v16
  v_mul_f32 v17, v162, v17
  v_mul_f32 v18, v162, v18
  v_mul_f32 v19, v162, v19
  v_mul_f32 v24, v162, v24
  v_mul_f32 v25, v162, v25
  v_mul_f32 v26, v162, v26
  v_mul_f32 v27, v162, v27
  v_mul_f32 v32, v162, v32
  v_mul_f32 v33, v162, v33
  v_mul_f32 v34, v162, v34
  v_mul_f32 v35, v162, v35
  v_mul_f32 v40, v162, v40
  v_mul_f32 v41, v162, v41
  v_mul_f32 v42, v162, v42
  v_mul_f32 v43, v162, v43
  v_mul_f32 v48, v162, v48
  v_mul_f32 v49, v162, v49
  v_mul_f32 v50, v162, v50
  v_mul_f32 v51, v162, v51
  v_mul_f32 v56, v162, v56
  v_mul_f32 v57, v162, v57
  v_mul_f32 v58, v162, v58
  v_mul_f32 v59, v162, v59
  v_min_f32 v166, v164, v184
  v_sub_f32 v167, v166, v184
  v_sub_f32 v168, v166, v164
  v_exp_f32 v167, v167
  v_exp_f32 v168, v168
  v_mul_f32 v169, v167, v100
  v_fma_f32 v169, v168, v165, v169
  v_rcp_f32 v169, v169
  s_nop 0
  v_mul_f32 v170, v167, v169
  v_mul_f32 v4, v170, v4
  v_mul_f32 v5, v170, v5
  v_mul_f32 v6, v170, v6
  v_mul_f32 v7, v170, v7
  v_mul_f32 v12, v170, v12
  v_mul_f32 v13, v170, v13
  v_mul_f32 v14, v170, v14
  v_mul_f32 v15, v170, v15
  v_mul_f32 v20, v170, v20
  v_mul_f32 v21, v170, v21
  v_mul_f32 v22, v170, v22
  v_mul_f32 v23, v170, v23
  v_mul_f32 v28, v170, v28
  v_mul_f32 v29, v170, v29
  v_mul_f32 v30, v170, v30
  v_mul_f32 v31, v170, v31
  v_mul_f32 v36, v170, v36
  v_mul_f32 v37, v170, v37
  v_mul_f32 v38, v170, v38
  v_mul_f32 v39, v170, v39
  v_mul_f32 v44, v170, v44
  v_mul_f32 v45, v170, v45
  v_mul_f32 v46, v170, v46
  v_mul_f32 v47, v170, v47
  v_mul_f32 v52, v170, v52
  v_mul_f32 v53, v170, v53
  v_mul_f32 v54, v170, v54
  v_mul_f32 v55, v170, v55
  v_mul_f32 v60, v170, v60
  v_mul_f32 v61, v170, v61
  v_mul_f32 v62, v170, v62
  v_mul_f32 v63, v170, v63
  s_mul_i32 s60, s3, 6144
  s_add_u32 s60, s60, 98304
  v_add_u32 v245, s60, v242
  s_mul_i32 s60, s36, 6144
  s_add_u32 s60, s60, 98304
  v_add_u32 v246, s60, v242
  s_cmp_lg_u32 s34, 0
  s_cbranch_scc1 L41
  ds_write_b128 v245, v[32:35] offset:0
  ds_write_b128 v245, v[40:43] offset:1024
  ds_write_b128 v245, v[36:39] offset:2048
  ds_write_b128 v245, v[44:47] offset:3072
  s_waitcnt lgkmcnt(0)
  s_barrier
  ds_read_b128 v[192:195], v246 offset:0
  ds_read_b128 v[196:199], v246 offset:1024
  ds_read_b128 v[200:203], v246 offset:2048
  ds_read_b128 v[204:207], v246 offset:3072
  s_waitcnt lgkmcnt(0)
  s_barrier
  v_add_f32 v0, v0, v192
  v_add_f32 v1, v1, v193
  v_add_f32 v2, v2, v194
  v_add_f32 v3, v3, v195
  v_add_f32 v8, v8, v196
  v_add_f32 v9, v9, v197
  v_add_f32 v10, v10, v198
  v_add_f32 v11, v11, v199
  v_add_f32 v4, v4, v200
  v_add_f32 v5, v5, v201
  v_add_f32 v6, v6, v202
  v_add_f32 v7, v7, v203
  v_add_f32 v12, v12, v204
  v_add_f32 v13, v13, v205
  v_add_f32 v14, v14, v206
  v_add_f32 v15, v15, v207
  ds_write_b128 v245, v[48:51] offset:0
  ds_write_b128 v245, v[56:59] offset:1024
  ds_write_b128 v245, v[52:55] offset:2048
  ds_write_b128 v245, v[60:63] offset:3072
  s_waitcnt lgkmcnt(0)
  s_barrier
  ds_read_b128 v[192:195], v246 offset:0
  ds_read_b128 v[196:199], v246 offset:1024
  ds_read_b128 v[200:203], v246 offset:2048
  ds_read_b128 v[204:207], v246 offset:3072
  s_waitcnt lgkmcnt(0)
  s_barrier
  v_add_f32 v16, v16, v192
  v_add_f32 v17, v17, v193
  v_add_f32 v18, v18, v194
  v_add_f32 v19, v19, v195
  v_add_f32 v24, v24, v196
  v_add_f32 v25, v25, v197
  v_add_f32 v26, v26, v198
  v_add_f32 v27, v27, v199
  v_add_f32 v20, v20, v200
  v_add_f32 v21, v21, v201
  v_add_f32 v22, v22, v202
  v_add_f32 v23, v23, v203
  v_add_f32 v28, v28, v204
  v_add_f32 v29, v29, v205
  v_add_f32 v30, v30, v206
  v_add_f32 v31, v31, v207
  s_mul_i32 s60, s32, 9
  s_add_u32 s60, s60, s35
  s_lshl_b32 s60, s60, 7
  s_lshl_b32 s61, s33, 2
  s_add_u32 s60, s60, s61
  s_add_u32 s60, s60, 0
  s_lshl_b32 s60, s60, 10
  v_cvt_pk_bf16_f32 v192, v0, v1
  v_cvt_pk_bf16_f32 v193, v2, v3
  v_cvt_pk_bf16_f32 v194, v8, v9
  v_cvt_pk_bf16_f32 v195, v10, v11
  s_add_u32 s61, s60, 0
  buffer_store_dwordx4 v[192:195], v242, s[20:23], s61 offen
  v_cvt_pk_bf16_f32 v196, v16, v17
  v_cvt_pk_bf16_f32 v197, v18, v19
  v_cvt_pk_bf16_f32 v198, v24, v25
  v_cvt_pk_bf16_f32 v199, v26, v27
  s_add_u32 s61, s60, 1024
  buffer_store_dwordx4 v[196:199], v242, s[20:23], s61 offen
  v_cvt_pk_bf16_f32 v200, v4, v5
  v_cvt_pk_bf16_f32 v201, v6, v7
  v_cvt_pk_bf16_f32 v202, v12, v13
  v_cvt_pk_bf16_f32 v203, v14, v15
  s_add_u32 s61, s60, 131072
  buffer_store_dwordx4 v[200:203], v242, s[20:23], s61 offen
  v_cvt_pk_bf16_f32 v204, v20, v21
  v_cvt_pk_bf16_f32 v205, v22, v23
  v_cvt_pk_bf16_f32 v206, v28, v29
  v_cvt_pk_bf16_f32 v207, v30, v31
  s_add_u32 s61, s60, 132096
  buffer_store_dwordx4 v[204:207], v242, s[20:23], s61 offen
  s_branch L42
L41:
  ds_write_b128 v245, v[0:3] offset:0
  ds_write_b128 v245, v[8:11] offset:1024
  ds_write_b128 v245, v[4:7] offset:2048
  ds_write_b128 v245, v[12:15] offset:3072
  s_waitcnt lgkmcnt(0)
  s_barrier
  ds_read_b128 v[192:195], v246 offset:0
  ds_read_b128 v[196:199], v246 offset:1024
  ds_read_b128 v[200:203], v246 offset:2048
  ds_read_b128 v[204:207], v246 offset:3072
  s_waitcnt lgkmcnt(0)
  s_barrier
  v_add_f32 v32, v32, v192
  v_add_f32 v33, v33, v193
  v_add_f32 v34, v34, v194
  v_add_f32 v35, v35, v195
  v_add_f32 v40, v40, v196
  v_add_f32 v41, v41, v197
  v_add_f32 v42, v42, v198
  v_add_f32 v43, v43, v199
  v_add_f32 v36, v36, v200
  v_add_f32 v37, v37, v201
  v_add_f32 v38, v38, v202
  v_add_f32 v39, v39, v203
  v_add_f32 v44, v44, v204
  v_add_f32 v45, v45, v205
  v_add_f32 v46, v46, v206
  v_add_f32 v47, v47, v207
  ds_write_b128 v245, v[16:19] offset:0
  ds_write_b128 v245, v[24:27] offset:1024
  ds_write_b128 v245, v[20:23] offset:2048
  ds_write_b128 v245, v[28:31] offset:3072
  s_waitcnt lgkmcnt(0)
  s_barrier
  ds_read_b128 v[192:195], v246 offset:0
  ds_read_b128 v[196:199], v246 offset:1024
  ds_read_b128 v[200:203], v246 offset:2048
  ds_read_b128 v[204:207], v246 offset:3072
  s_waitcnt lgkmcnt(0)
  s_barrier
  v_add_f32 v48, v48, v192
  v_add_f32 v49, v49, v193
  v_add_f32 v50, v50, v194
  v_add_f32 v51, v51, v195
  v_add_f32 v56, v56, v196
  v_add_f32 v57, v57, v197
  v_add_f32 v58, v58, v198
  v_add_f32 v59, v59, v199
  v_add_f32 v52, v52, v200
  v_add_f32 v53, v53, v201
  v_add_f32 v54, v54, v202
  v_add_f32 v55, v55, v203
  v_add_f32 v60, v60, v204
  v_add_f32 v61, v61, v205
  v_add_f32 v62, v62, v206
  v_add_f32 v63, v63, v207
  s_mul_i32 s60, s32, 9
  s_add_u32 s60, s60, s35
  s_lshl_b32 s60, s60, 7
  s_lshl_b32 s61, s33, 2
  s_add_u32 s60, s60, s61
  s_add_u32 s60, s60, 2
  s_lshl_b32 s60, s60, 10
  v_cvt_pk_bf16_f32 v192, v32, v33
  v_cvt_pk_bf16_f32 v193, v34, v35
  v_cvt_pk_bf16_f32 v194, v40, v41
  v_cvt_pk_bf16_f32 v195, v42, v43
  s_add_u32 s61, s60, 0
  buffer_store_dwordx4 v[192:195], v242, s[20:23], s61 offen
  v_cvt_pk_bf16_f32 v196, v48, v49
  v_cvt_pk_bf16_f32 v197, v50, v51
  v_cvt_pk_bf16_f32 v198, v56, v57
  v_cvt_pk_bf16_f32 v199, v58, v59
  s_add_u32 s61, s60, 1024
  buffer_store_dwordx4 v[196:199], v242, s[20:23], s61 offen
  v_cvt_pk_bf16_f32 v200, v36, v37
  v_cvt_pk_bf16_f32 v201, v38, v39
  v_cvt_pk_bf16_f32 v202, v44, v45
  v_cvt_pk_bf16_f32 v203, v46, v47
  s_add_u32 s61, s60, 131072
  buffer_store_dwordx4 v[200:203], v242, s[20:23], s61 offen
  v_cvt_pk_bf16_f32 v204, v52, v53
  v_cvt_pk_bf16_f32 v205, v54, v55
  v_cvt_pk_bf16_f32 v206, v60, v61
  v_cvt_pk_bf16_f32 v207, v62, v63
  s_add_u32 s61, s60, 132096
  buffer_store_dwordx4 v[204:207], v242, s[20:23], s61 offen
L42:
  s_add_u32 s24, s24, 1
  s_cmp_lt_u32 s24, 2
  s_cbranch_scc1 UNIT_D
  s_waitcnt vmcnt(0)
  s_waitcnt vmcnt(0)
  s_endpgm
SLOW_D:
  v_xor_b32 v245, 16, v244
  v_lshlrev_b32 v245, 2, v245
  v_xor_b32 v246, 32, v244
  v_lshlrev_b32 v246, 2, v246
  v_max3_f32 v247, v156, v157, v158
  v_max3_f32 v247, v247, v159, v160
  v_max3_f32 v247, v247, v161, v162
  v_max_f32 v247, v247, v163
  ds_bpermute_b32 v252, v245, v247
  s_waitcnt lgkmcnt(0)
  v_max_f32 v247, v247, v252
  ds_bpermute_b32 v252, v246, v247
  s_waitcnt lgkmcnt(0)
  v_max_f32 v247, v247, v252
  v_max_f32 v247, 0, v247
  v_sub_f32 v156, v156, v247
  v_sub_f32 v157, v157, v247
  v_sub_f32 v158, v158, v247
  v_sub_f32 v159, v159, v247
  v_sub_f32 v160, v160, v247
  v_sub_f32 v161, v161, v247
  v_sub_f32 v162, v162, v247
  v_sub_f32 v163, v163, v247
  v_sub_f32 v180, v180, v247
  v_sub_f32 v181, v181, v247
  v_sub_f32 v182, v182, v247
  v_sub_f32 v183, v183, v247
  v_max3_f32 v248, v164, v165, v166
  v_max3_f32 v248, v248, v167, v168
  v_max3_f32 v248, v248, v169, v170
  v_max_f32 v248, v248, v171
  ds_bpermute_b32 v252, v245, v248
  s_waitcnt lgkmcnt(0)
  v_max_f32 v248, v248, v252
  ds_bpermute_b32 v252, v246, v248
  s_waitcnt lgkmcnt(0)
  v_max_f32 v248, v248, v252
  v_max_f32 v248, 0, v248
  v_sub_f32 v164, v164, v248
  v_sub_f32 v165, v165, v248
  v_sub_f32 v166, v166, v248
  v_sub_f32 v167, v167, v248
  v_sub_f32 v168, v168, v248
  v_sub_f32 v169, v169, v248
  v_sub_f32 v170, v170, v248
  v_sub_f32 v171, v171, v248
  v_sub_f32 v184, v184, v248
  v_sub_f32 v185, v185, v248
  v_sub_f32 v186, v186, v248
  v_sub_f32 v187, v187, v248
  v_sub_f32 v247, 0, v247
  v_exp_f32 v247, v247
  s_nop 0
  v_mul_f32 v0, v247, v0
  v_mul_f32 v1, v247, v1
  v_mul_f32 v2, v247, v2
  v_mul_f32 v3, v247, v3
  v_mul_f32 v8, v247, v8
  v_mul_f32 v9, v247, v9
  v_mul_f32 v10, v247, v10
  v_mul_f32 v11, v247, v11
  v_mul_f32 v16, v247, v16
  v_mul_f32 v17, v247, v17
  v_mul_f32 v18, v247, v18
  v_mul_f32 v19, v247, v19
  v_mul_f32 v24, v247, v24
  v_mul_f32 v25, v247, v25
  v_mul_f32 v26, v247, v26
  v_mul_f32 v27, v247, v27
  v_mul_f32 v32, v247, v32
  v_mul_f32 v33, v247, v33
  v_mul_f32 v34, v247, v34
  v_mul_f32 v35, v247, v35
  v_mul_f32 v40, v247, v40
  v_mul_f32 v41, v247, v41
  v_mul_f32 v42, v247, v42
  v_mul_f32 v43, v247, v43
  v_mul_f32 v48, v247, v48
  v_mul_f32 v49, v247, v49
  v_mul_f32 v50, v247, v50
  v_mul_f32 v51, v247, v51
  v_mul_f32 v56, v247, v56
  v_mul_f32 v57, v247, v57
  v_mul_f32 v58, v247, v58
  v_mul_f32 v59, v247, v59
  v_mul_f32 v96, v247, v96
  v_mul_f32 v97, v247, v97
  v_mul_f32 v98, v247, v98
  v_mul_f32 v99, v247, v99
  v_sub_f32 v248, 0, v248
  v_exp_f32 v248, v248
  s_nop 0
  v_mul_f32 v4, v248, v4
  v_mul_f32 v5, v248, v5
  v_mul_f32 v6, v248, v6
  v_mul_f32 v7, v248, v7
  v_mul_f32 v12, v248, v12
  v_mul_f32 v13, v248, v13
  v_mul_f32 v14, v248, v14
  v_mul_f32 v15, v248, v15
  v_mul_f32 v20, v248, v20
  v_mul_f32 v21, v248, v21
  v_mul_f32 v22, v248, v22
  v_mul_f32 v23, v248, v23
  v_mul_f32 v28, v248, v28
  v_mul_f32 v29, v248, v29
  v_mul_f32 v30, v248, v30
  v_mul_f32 v31, v248, v31
  v_mul_f32 v36, v248, v36
  v_mul_f32 v37, v248, v37
  v_mul_f32 v38, v248, v38
  v_mul_f32 v39, v248, v39
  v_mul_f32 v44, v248, v44
  v_mul_f32 v45, v248, v45
  v_mul_f32 v46, v248, v46
  v_mul_f32 v47, v248, v47
  v_mul_f32 v52, v248, v52
  v_mul_f32 v53, v248, v53
  v_mul_f32 v54, v248, v54
  v_mul_f32 v55, v248, v55
  v_mul_f32 v60, v248, v60
  v_mul_f32 v61, v248, v61
  v_mul_f32 v62, v248, v62
  v_mul_f32 v63, v248, v63
  v_mul_f32 v100, v248, v100
  v_mul_f32 v101, v248, v101
  v_mul_f32 v102, v248, v102
  v_mul_f32 v103, v248, v103
  s_nop 1
  s_branch BACK_D
K1_EXIT:
  s_endpgm

.globl mha_oproj_kernel
.p2align 8
.type mha_oproj_kernel,@function
mha_oproj_kernel:
  s_cmp_ge_u32 s2, 256
  s_cbranch_scc1 K2_EXIT
  s_and_b32 s4, s2, 7
  s_lshr_b32 s5, s2, 3
  s_and_b32 s6, s4, 1
  s_lshr_b32 s7, s4, 2
  s_lshl_b32 s7, s7, 3
  s_lshr_b32 s8, s5, 2
  s_add_u32 s7, s7, s8
  s_cmp_ge_u32 s7, 15
  s_cbranch_scc1 K2_EXIT
  s_bfe_u32 s8, s4, 0x10001
  s_lshl_b32 s8, s8, 2
  s_and_b32 s9, s5, 3
  s_add_u32 s8, s8, s9
  s_mul_i32 s9, s6, 40
  s_add_u32 s10, s0, s9
  s_addc_u32 s11, s1, 0
  s_load_dwordx2 s[12:13], s[10:11], 32
  s_load_dwordx2 s[14:15], s[0:1], 80
  s_load_dwordx2 s[16:17], s[0:1], 96
  v_and_b32 v178, 63, v0
  v_lshrrev_b32 v1, 6, v0
  v_lshlrev_b32 v172, 4, v178
  v_readfirstlane_b32 s3, v1
  v_lshrrev_b32 v1, 3, v178
  v_and_b32 v2, 7, v178
  v_lshrrev_b32 v3, 4, v178
  v_lshlrev_b32 v4, 1, v3
  v_xor_b32 v2, v2, v4
  v_lshlrev_b32 v2, 4, v2
  v_lshl_add_u32 v173, v1, 10, v2
  v_bfe_u32 v1, v178, 2, 2
  v_lshl_add_u32 v2, v3, 2, v1
  v_lshrrev_b32 v4, 1, v2
  v_and_b32 v4, 3, v4
  v_lshlrev_b32 v4, 1, v4
  v_bfe_u32 v5, v178, 1, 1
  v_xor_b32 v4, v4, v5
  v_lshlrev_b32 v4, 4, v4
  v_and_b32 v5, 1, v178
  v_lshl_add_u32 v4, v5, 3, v4
  v_lshl_add_u32 v4, v2, 7, v4
  s_mul_i32 s18, s3, 12288
  v_add_u32 v4, s18, v4
  v_xor_b32 v174, 0, v4
  v_xor_b32 v175, 32, v4
  v_xor_b32 v176, 64, v4
  v_xor_b32 v177, 96, v4
  v_mov_b32 v0, 0
  v_mov_b32 v1, 0
  v_mov_b32 v2, 0
  v_mov_b32 v3, 0
  v_mov_b32 v4, 0
  v_mov_b32 v5, 0
  v_mov_b32 v6, 0
  v_mov_b32 v7, 0
  v_mov_b32 v8, 0
  v_mov_b32 v9, 0
  v_mov_b32 v10, 0
  v_mov_b32 v11, 0
  v_mov_b32 v12, 0
  v_mov_b32 v13, 0
  v_mov_b32 v14, 0
  v_mov_b32 v15, 0
  v_mov_b32 v16, 0
  v_mov_b32 v17, 0
  v_mov_b32 v18, 0
  v_mov_b32 v19, 0
  v_mov_b32 v20, 0
  v_mov_b32 v21, 0
  v_mov_b32 v22, 0
  v_mov_b32 v23, 0
  v_mov_b32 v24, 0
  v_mov_b32 v25, 0
  v_mov_b32 v26, 0
  v_mov_b32 v27, 0
  v_mov_b32 v28, 0
  v_mov_b32 v29, 0
  v_mov_b32 v30, 0
  v_mov_b32 v31, 0
  v_mov_b32 v32, 0
  v_mov_b32 v33, 0
  v_mov_b32 v34, 0
  v_mov_b32 v35, 0
  v_mov_b32 v36, 0
  v_mov_b32 v37, 0
  v_mov_b32 v38, 0
  v_mov_b32 v39, 0
  v_mov_b32 v40, 0
  v_mov_b32 v41, 0
  v_mov_b32 v42, 0
  v_mov_b32 v43, 0
  v_mov_b32 v44, 0
  v_mov_b32 v45, 0
  v_mov_b32 v46, 0
  v_mov_b32 v47, 0
  v_mov_b32 v48, 0
  v_mov_b32 v49, 0
  v_mov_b32 v50, 0
  v_mov_b32 v51, 0
  v_mov_b32 v52, 0
  v_mov_b32 v53, 0
  v_mov_b32 v54, 0
  v_mov_b32 v55, 0
  v_mov_b32 v56, 0
  v_mov_b32 v57, 0
  v_mov_b32 v58, 0
  v_mov_b32 v59, 0
  v_mov_b32 v60, 0
  v_mov_b32 v61, 0
  v_mov_b32 v62, 0
  v_mov_b32 v63, 0
  v_mov_b32 v64, 0
  v_mov_b32 v65, 0
  v_mov_b32 v66, 0
  v_mov_b32 v67, 0
  v_mov_b32 v68, 0
  v_mov_b32 v69, 0
  v_mov_b32 v70, 0
  v_mov_b32 v71, 0
  v_mov_b32 v72, 0
  v_mov_b32 v73, 0
  v_mov_b32 v74, 0
  v_mov_b32 v75, 0
  v_mov_b32 v76, 0
  v_mov_b32 v77, 0
  v_mov_b32 v78, 0
  v_mov_b32 v79, 0
  s_waitcnt lgkmcnt(0)
  s_mul_i32 s9, s6, 9437184
  s_add_u32 s20, s16, s9
  s_addc_u32 s21, s17, 0
  s_mov_b32 s22, 9437184
  s_mov_b32 s23, 0x20000
  s_lshl_b32 s9, s8, 7
  s_add_u32 s24, s12, s9
  s_addc_u32 s25, s13, 0
  s_mov_b32 s26, 4194304
  s_mov_b32 s27, 0x20000
  s_lshl_b32 s19, s6, 10
  s_add_u32 s9, s9, s19
  s_add_u32 s28, s14, s9
  s_addc_u32 s29, s15, 0
  s_sub_u32 s30, 2359296, s9
  s_mov_b32 s31, 0x20000
  s_mul_i32 s32, s7, 655360
  s_lshl_b32 s9, s3, 14
  s_add_u32 s32, s32, s9
  s_lshl_b32 s33, s3, 19
  s_add_u32 m0, s18, 0
  s_add_u32 s34, s33, 0
  buffer_load_dwordx4 v173, s[24:27], s34 offen lds
  s_add_u32 m0, s18, 1024
  s_add_u32 s34, s33, 8192
  buffer_load_dwordx4 v173, s[24:27], s34 offen lds
  s_add_u32 m0, s18, 2048
  s_add_u32 s34, s33, 16384
  buffer_load_dwordx4 v173, s[24:27], s34 offen lds
  s_add_u32 m0, s18, 3072
  s_add_u32 s34, s33, 24576
  buffer_load_dwordx4 v173, s[24:27], s34 offen lds
  s_add_u32 s34, s32, 0
  buffer_load_dwordx4 v[80:83], v172, s[20:23], s34 offen
  s_add_u32 s34, s32, 131072
  buffer_load_dwordx4 v[84:87], v172, s[20:23], s34 offen
  s_add_u32 s34, s32, 262144
  buffer_load_dwordx4 v[88:91], v172, s[20:23], s34 offen
  s_add_u32 s34, s32, 393216
  buffer_load_dwordx4 v[92:95], v172, s[20:23], s34 offen
  s_add_u32 s34, s32, 524288
  buffer_load_dwordx4 v[96:99], v172, s[20:23], s34 offen
  s_add_u32 m0, s18, 4096
  s_add_u32 s34, s33, 32768
  buffer_load_dwordx4 v173, s[24:27], s34 offen lds
  s_add_u32 m0, s18, 5120
  s_add_u32 s34, s33, 40960
  buffer_load_dwordx4 v173, s[24:27], s34 offen lds
  s_add_u32 m0, s18, 6144
  s_add_u32 s34, s33, 49152
  buffer_load_dwordx4 v173, s[24:27], s34 offen lds
  s_add_u32 m0, s18, 7168
  s_add_u32 s34, s33, 57344
  buffer_load_dwordx4 v173, s[24:27], s34 offen lds
  s_add_u32 s34, s32, 1024
  buffer_load_dwordx4 v[100:103], v172, s[20:23], s34 offen
  s_add_u32 s34, s32, 132096
  buffer_load_dwordx4 v[104:107], v172, s[20:23], s34 offen
  s_add_u32 s34, s32, 263168
  buffer_load_dwordx4 v[108:111], v172, s[20:23], s34 offen
  s_add_u32 s34, s32, 394240
  buffer_load_dwordx4 v[112:115], v172, s[20:23], s34 offen
  s_add_u32 s34, s32, 525312
  buffer_load_dwordx4 v[116:119], v172, s[20:23], s34 offen
  s_add_u32 m0, s18, 8192
  s_add_u32 s34, s33, 65536
  buffer_load_dwordx4 v173, s[24:27], s34 offen lds
  s_add_u32 m0, s18, 9216
  s_add_u32 s34, s33, 73728
  buffer_load_dwordx4 v173, s[24:27], s34 offen lds
  s_add_u32 m0, s18, 10240
  s_add_u32 s34, s33, 81920
  buffer_load_dwordx4 v173, s[24:27], s34 offen lds
  s_add_u32 m0, s18, 11264
  s_add_u32 s34, s33, 90112
  buffer_load_dwordx4 v173, s[24:27], s34 offen lds
  s_add_u32 s34, s32, 2048
  buffer_load_dwordx4 v[120:123], v172, s[20:23], s34 offen
  s_add_u32 s34, s32, 133120
  buffer_load_dwordx4 v[124:127], v172, s[20:23], s34 offen
  s_add_u32 s34, s32, 264192
  buffer_load_dwordx4 v[128:131], v172, s[20:23], s34 offen
  s_add_u32 s34, s32, 395264
  buffer_load_dwordx4 v[132:135], v172, s[20:23], s34 offen
  s_add_u32 s34, s32, 526336
  buffer_load_dwordx4 v[136:139], v172, s[20:23], s34 offen
  s_waitcnt vmcnt(18)
  ds_read_b64_tr_b16 v[140:141], v174 offset:0
  ds_read_b64_tr_b16 v[142:143], v174 offset:2048
  ds_read_b64_tr_b16 v[144:145], v175 offset:0
  ds_read_b64_tr_b16 v[146:147], v175 offset:2048
  ds_read_b64_tr_b16 v[148:149], v176 offset:0
  ds_read_b64_tr_b16 v[150:151], v176 offset:2048
  ds_read_b64_tr_b16 v[152:153], v177 offset:0
  ds_read_b64_tr_b16 v[154:155], v177 offset:2048
  s_waitcnt vmcnt(9)
  s_waitcnt lgkmcnt(0)
  ds_read_b64_tr_b16 v[156:157], v174 offset:4096
  ds_read_b64_tr_b16 v[158:159], v174 offset:6144
  ds_read_b64_tr_b16 v[160:161], v175 offset:4096
  ds_read_b64_tr_b16 v[162:163], v175 offset:6144
  ds_read_b64_tr_b16 v[164:165], v176 offset:4096
  ds_read_b64_tr_b16 v[166:167], v176 offset:6144
  ds_read_b64_tr_b16 v[168:169], v177 offset:4096
  ds_read_b64_tr_b16 v[170:171], v177 offset:6144
  v_mfma_f32_16x16x32_bf16 v[0:3], v[140:143], v[80:83], v[0:3]
  v_mfma_f32_16x16x32_bf16 v[4:7], v[144:147], v[80:83], v[4:7]
  v_mfma_f32_16x16x32_bf16 v[8:11], v[148:151], v[80:83], v[8:11]
  v_mfma_f32_16x16x32_bf16 v[12:15], v[152:155], v[80:83], v[12:15]
  v_mfma_f32_16x16x32_bf16 v[16:19], v[140:143], v[84:87], v[16:19]
  v_mfma_f32_16x16x32_bf16 v[20:23], v[144:147], v[84:87], v[20:23]
  v_mfma_f32_16x16x32_bf16 v[24:27], v[148:151], v[84:87], v[24:27]
  v_mfma_f32_16x16x32_bf16 v[28:31], v[152:155], v[84:87], v[28:31]
  v_mfma_f32_16x16x32_bf16 v[32:35], v[140:143], v[88:91], v[32:35]
  v_mfma_f32_16x16x32_bf16 v[36:39], v[144:147], v[88:91], v[36:39]
  v_mfma_f32_16x16x32_bf16 v[40:43], v[148:151], v[88:91], v[40:43]
  v_mfma_f32_16x16x32_bf16 v[44:47], v[152:155], v[88:91], v[44:47]
  v_mfma_f32_16x16x32_bf16 v[48:51], v[140:143], v[92:95], v[48:51]
  v_mfma_f32_16x16x32_bf16 v[52:55], v[144:147], v[92:95], v[52:55]
  v_mfma_f32_16x16x32_bf16 v[56:59], v[148:151], v[92:95], v[56:59]
  v_mfma_f32_16x16x32_bf16 v[60:63], v[152:155], v[92:95], v[60:63]
  v_mfma_f32_16x16x32_bf16 v[64:67], v[140:143], v[96:99], v[64:67]
  v_mfma_f32_16x16x32_bf16 v[68:71], v[144:147], v[96:99], v[68:71]
  v_mfma_f32_16x16x32_bf16 v[72:75], v[148:151], v[96:99], v[72:75]
  v_mfma_f32_16x16x32_bf16 v[76:79], v[152:155], v[96:99], v[76:79]
  s_add_u32 m0, s18, 0
  s_add_u32 s34, s33, 98304
  buffer_load_dwordx4 v173, s[24:27], s34 offen lds
  s_add_u32 m0, s18, 1024
  s_add_u32 s34, s33, 106496
  buffer_load_dwordx4 v173, s[24:27], s34 offen lds
  s_add_u32 m0, s18, 2048
  s_add_u32 s34, s33, 114688
  buffer_load_dwordx4 v173, s[24:27], s34 offen lds
  s_add_u32 m0, s18, 3072
  s_add_u32 s34, s33, 122880
  buffer_load_dwordx4 v173, s[24:27], s34 offen lds
  s_add_u32 s34, s32, 3072
  buffer_load_dwordx4 v[80:83], v172, s[20:23], s34 offen
  s_add_u32 s34, s32, 134144
  buffer_load_dwordx4 v[84:87], v172, s[20:23], s34 offen
  s_add_u32 s34, s32, 265216
  buffer_load_dwordx4 v[88:91], v172, s[20:23], s34 offen
  s_add_u32 s34, s32, 396288
  buffer_load_dwordx4 v[92:95], v172, s[20:23], s34 offen
  s_add_u32 s34, s32, 527360
  buffer_load_dwordx4 v[96:99], v172, s[20:23], s34 offen
  s_waitcnt vmcnt(9)
  s_waitcnt lgkmcnt(0)
  ds_read_b64_tr_b16 v[140:141], v174 offset:8192
  ds_read_b64_tr_b16 v[142:143], v174 offset:10240
  ds_read_b64_tr_b16 v[144:145], v175 offset:8192
  ds_read_b64_tr_b16 v[146:147], v175 offset:10240
  ds_read_b64_tr_b16 v[148:149], v176 offset:8192
  ds_read_b64_tr_b16 v[150:151], v176 offset:10240
  ds_read_b64_tr_b16 v[152:153], v177 offset:8192
  ds_read_b64_tr_b16 v[154:155], v177 offset:10240
  v_mfma_f32_16x16x32_bf16 v[0:3], v[156:159], v[100:103], v[0:3]
  v_mfma_f32_16x16x32_bf16 v[4:7], v[160:163], v[100:103], v[4:7]
  v_mfma_f32_16x16x32_bf16 v[8:11], v[164:167], v[100:103], v[8:11]
  v_mfma_f32_16x16x32_bf16 v[12:15], v[168:171], v[100:103], v[12:15]
  v_mfma_f32_16x16x32_bf16 v[16:19], v[156:159], v[104:107], v[16:19]
  v_mfma_f32_16x16x32_bf16 v[20:23], v[160:163], v[104:107], v[20:23]
  v_mfma_f32_16x16x32_bf16 v[24:27], v[164:167], v[104:107], v[24:27]
  v_mfma_f32_16x16x32_bf16 v[28:31], v[168:171], v[104:107], v[28:31]
  v_mfma_f32_16x16x32_bf16 v[32:35], v[156:159], v[108:111], v[32:35]
  v_mfma_f32_16x16x32_bf16 v[36:39], v[160:163], v[108:111], v[36:39]
  v_mfma_f32_16x16x32_bf16 v[40:43], v[164:167], v[108:111], v[40:43]
  v_mfma_f32_16x16x32_bf16 v[44:47], v[168:171], v[108:111], v[44:47]
  v_mfma_f32_16x16x32_bf16 v[48:51], v[156:159], v[112:115], v[48:51]
  v_mfma_f32_16x16x32_bf16 v[52:55], v[160:163], v[112:115], v[52:55]
  v_mfma_f32_16x16x32_bf16 v[56:59], v[164:167], v[112:115], v[56:59]
  v_mfma_f32_16x16x32_bf16 v[60:63], v[168:171], v[112:115], v[60:63]
  v_mfma_f32_16x16x32_bf16 v[64:67], v[156:159], v[116:119], v[64:67]
  v_mfma_f32_16x16x32_bf16 v[68:71], v[160:163], v[116:119], v[68:71]
  v_mfma_f32_16x16x32_bf16 v[72:75], v[164:167], v[116:119], v[72:75]
  v_mfma_f32_16x16x32_bf16 v[76:79], v[168:171], v[116:119], v[76:79]
  s_add_u32 m0, s18, 4096
  s_add_u32 s34, s33, 131072
  buffer_load_dwordx4 v173, s[24:27], s34 offen lds
  s_add_u32 m0, s18, 5120
  s_add_u32 s34, s33, 139264
  buffer_load_dwordx4 v173, s[24:27], s34 offen lds
  s_add_u32 m0, s18, 6144
  s_add_u32 s34, s33, 147456
  buffer_load_dwordx4 v173, s[24:27], s34 offen lds
  s_add_u32 m0, s18, 7168
  s_add_u32 s34, s33, 155648
  buffer_load_dwordx4 v173, s[24:27], s34 offen lds
  s_add_u32 s34, s32, 4096
  buffer_load_dwordx4 v[100:103], v172, s[20:23], s34 offen
  s_add_u32 s34, s32, 135168
  buffer_load_dwordx4 v[104:107], v172, s[20:23], s34 offen
  s_add_u32 s34, s32, 266240
  buffer_load_dwordx4 v[108:111], v172, s[20:23], s34 offen
  s_add_u32 s34, s32, 397312
  buffer_load_dwordx4 v[112:115], v172, s[20:23], s34 offen
  s_add_u32 s34, s32, 528384
  buffer_load_dwordx4 v[116:119], v172, s[20:23], s34 offen
  s_waitcnt vmcnt(9)
  s_waitcnt lgkmcnt(0)
  ds_read_b64_tr_b16 v[156:157], v174 offset:0
  ds_read_b64_tr_b16 v[158:159], v174 offset:2048
  ds_read_b64_tr_b16 v[160:161], v175 offset:0
  ds_read_b64_tr_b16 v[162:163], v175 offset:2048
  ds_read_b64_tr_b16 v[164:165], v176 offset:0
  ds_read_b64_tr_b16 v[166:167], v176 offset:2048
  ds_read_b64_tr_b16 v[168:169], v177 offset:0
  ds_read_b64_tr_b16 v[170:171], v177 offset:2048
  v_mfma_f32_16x16x32_bf16 v[0:3], v[140:143], v[120:123], v[0:3]
  v_mfma_f32_16x16x32_bf16 v[4:7], v[144:147], v[120:123], v[4:7]
  v_mfma_f32_16x16x32_bf16 v[8:11], v[148:151], v[120:123], v[8:11]
  v_mfma_f32_16x16x32_bf16 v[12:15], v[152:155], v[120:123], v[12:15]
  v_mfma_f32_16x16x32_bf16 v[16:19], v[140:143], v[124:127], v[16:19]
  v_mfma_f32_16x16x32_bf16 v[20:23], v[144:147], v[124:127], v[20:23]
  v_mfma_f32_16x16x32_bf16 v[24:27], v[148:151], v[124:127], v[24:27]
  v_mfma_f32_16x16x32_bf16 v[28:31], v[152:155], v[124:127], v[28:31]
  v_mfma_f32_16x16x32_bf16 v[32:35], v[140:143], v[128:131], v[32:35]
  v_mfma_f32_16x16x32_bf16 v[36:39], v[144:147], v[128:131], v[36:39]
  v_mfma_f32_16x16x32_bf16 v[40:43], v[148:151], v[128:131], v[40:43]
  v_mfma_f32_16x16x32_bf16 v[44:47], v[152:155], v[128:131], v[44:47]
  v_mfma_f32_16x16x32_bf16 v[48:51], v[140:143], v[132:135], v[48:51]
  v_mfma_f32_16x16x32_bf16 v[52:55], v[144:147], v[132:135], v[52:55]
  v_mfma_f32_16x16x32_bf16 v[56:59], v[148:151], v[132:135], v[56:59]
  v_mfma_f32_16x16x32_bf16 v[60:63], v[152:155], v[132:135], v[60:63]
  v_mfma_f32_16x16x32_bf16 v[64:67], v[140:143], v[136:139], v[64:67]
  v_mfma_f32_16x16x32_bf16 v[68:71], v[144:147], v[136:139], v[68:71]
  v_mfma_f32_16x16x32_bf16 v[72:75], v[148:151], v[136:139], v[72:75]
  v_mfma_f32_16x16x32_bf16 v[76:79], v[152:155], v[136:139], v[76:79]
  s_add_u32 m0, s18, 8192
  s_add_u32 s34, s33, 163840
  buffer_load_dwordx4 v173, s[24:27], s34 offen lds
  s_add_u32 m0, s18, 9216
  s_add_u32 s34, s33, 172032
  buffer_load_dwordx4 v173, s[24:27], s34 offen lds
  s_add_u32 m0, s18, 10240
  s_add_u32 s34, s33, 180224
  buffer_load_dwordx4 v173, s[24:27], s34 offen lds
  s_add_u32 m0, s18, 11264
  s_add_u32 s34, s33, 188416
  buffer_load_dwordx4 v173, s[24:27], s34 offen lds
  s_add_u32 s34, s32, 5120
  buffer_load_dwordx4 v[120:123], v172, s[20:23], s34 offen
  s_add_u32 s34, s32, 136192
  buffer_load_dwordx4 v[124:127], v172, s[20:23], s34 offen
  s_add_u32 s34, s32, 267264
  buffer_load_dwordx4 v[128:131], v172, s[20:23], s34 offen
  s_add_u32 s34, s32, 398336
  buffer_load_dwordx4 v[132:135], v172, s[20:23], s34 offen
  s_add_u32 s34, s32, 529408
  buffer_load_dwordx4 v[136:139], v172, s[20:23], s34 offen
  s_waitcnt vmcnt(9)
  s_waitcnt lgkmcnt(0)
  ds_read_b64_tr_b16 v[140:141], v174 offset:4096
  ds_read_b64_tr_b16 v[142:143], v174 offset:6144
  ds_read_b64_tr_b16 v[144:145], v175 offset:4096
  ds_read_b64_tr_b16 v[146:147], v175 offset:6144
  ds_read_b64_tr_b16 v[148:149], v176 offset:4096
  ds_read_b64_tr_b16 v[150:151], v176 offset:6144
  ds_read_b64_tr_b16 v[152:153], v177 offset:4096
  ds_read_b64_tr_b16 v[154:155], v177 offset:6144
  v_mfma_f32_16x16x32_bf16 v[0:3], v[156:159], v[80:83], v[0:3]
  v_mfma_f32_16x16x32_bf16 v[4:7], v[160:163], v[80:83], v[4:7]
  v_mfma_f32_16x16x32_bf16 v[8:11], v[164:167], v[80:83], v[8:11]
  v_mfma_f32_16x16x32_bf16 v[12:15], v[168:171], v[80:83], v[12:15]
  v_mfma_f32_16x16x32_bf16 v[16:19], v[156:159], v[84:87], v[16:19]
  v_mfma_f32_16x16x32_bf16 v[20:23], v[160:163], v[84:87], v[20:23]
  v_mfma_f32_16x16x32_bf16 v[24:27], v[164:167], v[84:87], v[24:27]
  v_mfma_f32_16x16x32_bf16 v[28:31], v[168:171], v[84:87], v[28:31]
  v_mfma_f32_16x16x32_bf16 v[32:35], v[156:159], v[88:91], v[32:35]
  v_mfma_f32_16x16x32_bf16 v[36:39], v[160:163], v[88:91], v[36:39]
  v_mfma_f32_16x16x32_bf16 v[40:43], v[164:167], v[88:91], v[40:43]
  v_mfma_f32_16x16x32_bf16 v[44:47], v[168:171], v[88:91], v[44:47]
  v_mfma_f32_16x16x32_bf16 v[48:51], v[156:159], v[92:95], v[48:51]
  v_mfma_f32_16x16x32_bf16 v[52:55], v[160:163], v[92:95], v[52:55]
  v_mfma_f32_16x16x32_bf16 v[56:59], v[164:167], v[92:95], v[56:59]
  v_mfma_f32_16x16x32_bf16 v[60:63], v[168:171], v[92:95], v[60:63]
  v_mfma_f32_16x16x32_bf16 v[64:67], v[156:159], v[96:99], v[64:67]
  v_mfma_f32_16x16x32_bf16 v[68:71], v[160:163], v[96:99], v[68:71]
  v_mfma_f32_16x16x32_bf16 v[72:75], v[164:167], v[96:99], v[72:75]
  v_mfma_f32_16x16x32_bf16 v[76:79], v[168:171], v[96:99], v[76:79]
  s_add_u32 m0, s18, 0
  s_add_u32 s34, s33, 196608
  buffer_load_dwordx4 v173, s[24:27], s34 offen lds
  s_add_u32 m0, s18, 1024
  s_add_u32 s34, s33, 204800
  buffer_load_dwordx4 v173, s[24:27], s34 offen lds
  s_add_u32 m0, s18, 2048
  s_add_u32 s34, s33, 212992
  buffer_load_dwordx4 v173, s[24:27], s34 offen lds
  s_add_u32 m0, s18, 3072
  s_add_u32 s34, s33, 221184
  buffer_load_dwordx4 v173, s[24:27], s34 offen lds
  s_add_u32 s34, s32, 6144
  buffer_load_dwordx4 v[80:83], v172, s[20:23], s34 offen
  s_add_u32 s34, s32, 137216
  buffer_load_dwordx4 v[84:87], v172, s[20:23], s34 offen
  s_add_u32 s34, s32, 268288
  buffer_load_dwordx4 v[88:91], v172, s[20:23], s34 offen
  s_add_u32 s34, s32, 399360
  buffer_load_dwordx4 v[92:95], v172, s[20:23], s34 offen
  s_add_u32 s34, s32, 530432
  buffer_load_dwordx4 v[96:99], v172, s[20:23], s34 offen
  s_waitcnt vmcnt(9)
  s_waitcnt lgkmcnt(0)
  ds_read_b64_tr_b16 v[156:157], v174 offset:8192
  ds_read_b64_tr_b16 v[158:159], v174 offset:10240
  ds_read_b64_tr_b16 v[160:161], v175 offset:8192
  ds_read_b64_tr_b16 v[162:163], v175 offset:10240
  ds_read_b64_tr_b16 v[164:165], v176 offset:8192
  ds_read_b64_tr_b16 v[166:167], v176 offset:10240
  ds_read_b64_tr_b16 v[168:169], v177 offset:8192
  ds_read_b64_tr_b16 v[170:171], v177 offset:10240
  v_mfma_f32_16x16x32_bf16 v[0:3], v[140:143], v[100:103], v[0:3]
  v_mfma_f32_16x16x32_bf16 v[4:7], v[144:147], v[100:103], v[4:7]
  v_mfma_f32_16x16x32_bf16 v[8:11], v[148:151], v[100:103], v[8:11]
  v_mfma_f32_16x16x32_bf16 v[12:15], v[152:155], v[100:103], v[12:15]
  v_mfma_f32_16x16x32_bf16 v[16:19], v[140:143], v[104:107], v[16:19]
  v_mfma_f32_16x16x32_bf16 v[20:23], v[144:147], v[104:107], v[20:23]
  v_mfma_f32_16x16x32_bf16 v[24:27], v[148:151], v[104:107], v[24:27]
  v_mfma_f32_16x16x32_bf16 v[28:31], v[152:155], v[104:107], v[28:31]
  v_mfma_f32_16x16x32_bf16 v[32:35], v[140:143], v[108:111], v[32:35]
  v_mfma_f32_16x16x32_bf16 v[36:39], v[144:147], v[108:111], v[36:39]
  v_mfma_f32_16x16x32_bf16 v[40:43], v[148:151], v[108:111], v[40:43]
  v_mfma_f32_16x16x32_bf16 v[44:47], v[152:155], v[108:111], v[44:47]
  v_mfma_f32_16x16x32_bf16 v[48:51], v[140:143], v[112:115], v[48:51]
  v_mfma_f32_16x16x32_bf16 v[52:55], v[144:147], v[112:115], v[52:55]
  v_mfma_f32_16x16x32_bf16 v[56:59], v[148:151], v[112:115], v[56:59]
  v_mfma_f32_16x16x32_bf16 v[60:63], v[152:155], v[112:115], v[60:63]
  v_mfma_f32_16x16x32_bf16 v[64:67], v[140:143], v[116:119], v[64:67]
  v_mfma_f32_16x16x32_bf16 v[68:71], v[144:147], v[116:119], v[68:71]
  v_mfma_f32_16x16x32_bf16 v[72:75], v[148:151], v[116:119], v[72:75]
  v_mfma_f32_16x16x32_bf16 v[76:79], v[152:155], v[116:119], v[76:79]
  s_add_u32 m0, s18, 4096
  s_add_u32 s34, s33, 229376
  buffer_load_dwordx4 v173, s[24:27], s34 offen lds
  s_add_u32 m0, s18, 5120
  s_add_u32 s34, s33, 237568
  buffer_load_dwordx4 v173, s[24:27], s34 offen lds
  s_add_u32 m0, s18, 6144
  s_add_u32 s34, s33, 245760
  buffer_load_dwordx4 v173, s[24:27], s34 offen lds
  s_add_u32 m0, s18, 7168
  s_add_u32 s34, s33, 253952
  buffer_load_dwordx4 v173, s[24:27], s34 offen lds
  s_add_u32 s34, s32, 7168
  buffer_load_dwordx4 v[100:103], v172, s[20:23], s34 offen
  s_add_u32 s34, s32, 138240
  buffer_load_dwordx4 v[104:107], v172, s[20:23], s34 offen
  s_add_u32 s34, s32, 269312
  buffer_load_dwordx4 v[108:111], v172, s[20:23], s34 offen
  s_add_u32 s34, s32, 400384
  buffer_load_dwordx4 v[112:115], v172, s[20:23], s34 offen
  s_add_u32 s34, s32, 531456
  buffer_load_dwordx4 v[116:119], v172, s[20:23], s34 offen
  s_waitcnt vmcnt(9)
  s_waitcnt lgkmcnt(0)
  ds_read_b64_tr_b16 v[140:141], v174 offset:0
  ds_read_b64_tr_b16 v[142:143], v174 offset:2048
  ds_read_b64_tr_b16 v[144:145], v175 offset:0
  ds_read_b64_tr_b16 v[146:147], v175 offset:2048
  ds_read_b64_tr_b16 v[148:149], v176 offset:0
  ds_read_b64_tr_b16 v[150:151], v176 offset:2048
  ds_read_b64_tr_b16 v[152:153], v177 offset:0
  ds_read_b64_tr_b16 v[154:155], v177 offset:2048
  v_mfma_f32_16x16x32_bf16 v[0:3], v[156:159], v[120:123], v[0:3]
  v_mfma_f32_16x16x32_bf16 v[4:7], v[160:163], v[120:123], v[4:7]
  v_mfma_f32_16x16x32_bf16 v[8:11], v[164:167], v[120:123], v[8:11]
  v_mfma_f32_16x16x32_bf16 v[12:15], v[168:171], v[120:123], v[12:15]
  v_mfma_f32_16x16x32_bf16 v[16:19], v[156:159], v[124:127], v[16:19]
  v_mfma_f32_16x16x32_bf16 v[20:23], v[160:163], v[124:127], v[20:23]
  v_mfma_f32_16x16x32_bf16 v[24:27], v[164:167], v[124:127], v[24:27]
  v_mfma_f32_16x16x32_bf16 v[28:31], v[168:171], v[124:127], v[28:31]
  v_mfma_f32_16x16x32_bf16 v[32:35], v[156:159], v[128:131], v[32:35]
  v_mfma_f32_16x16x32_bf16 v[36:39], v[160:163], v[128:131], v[36:39]
  v_mfma_f32_16x16x32_bf16 v[40:43], v[164:167], v[128:131], v[40:43]
  v_mfma_f32_16x16x32_bf16 v[44:47], v[168:171], v[128:131], v[44:47]
  v_mfma_f32_16x16x32_bf16 v[48:51], v[156:159], v[132:135], v[48:51]
  v_mfma_f32_16x16x32_bf16 v[52:55], v[160:163], v[132:135], v[52:55]
  v_mfma_f32_16x16x32_bf16 v[56:59], v[164:167], v[132:135], v[56:59]
  v_mfma_f32_16x16x32_bf16 v[60:63], v[168:171], v[132:135], v[60:63]
  v_mfma_f32_16x16x32_bf16 v[64:67], v[156:159], v[136:139], v[64:67]
  v_mfma_f32_16x16x32_bf16 v[68:71], v[160:163], v[136:139], v[68:71]
  v_mfma_f32_16x16x32_bf16 v[72:75], v[164:167], v[136:139], v[72:75]
  v_mfma_f32_16x16x32_bf16 v[76:79], v[168:171], v[136:139], v[76:79]
  s_add_u32 m0, s18, 8192
  s_add_u32 s34, s33, 262144
  buffer_load_dwordx4 v173, s[24:27], s34 offen lds
  s_add_u32 m0, s18, 9216
  s_add_u32 s34, s33, 270336
  buffer_load_dwordx4 v173, s[24:27], s34 offen lds
  s_add_u32 m0, s18, 10240
  s_add_u32 s34, s33, 278528
  buffer_load_dwordx4 v173, s[24:27], s34 offen lds
  s_add_u32 m0, s18, 11264
  s_add_u32 s34, s33, 286720
  buffer_load_dwordx4 v173, s[24:27], s34 offen lds
  s_add_u32 s34, s32, 8192
  buffer_load_dwordx4 v[120:123], v172, s[20:23], s34 offen
  s_add_u32 s34, s32, 139264
  buffer_load_dwordx4 v[124:127], v172, s[20:23], s34 offen
  s_add_u32 s34, s32, 270336
  buffer_load_dwordx4 v[128:131], v172, s[20:23], s34 offen
  s_add_u32 s34, s32, 401408
  buffer_load_dwordx4 v[132:135], v172, s[20:23], s34 offen
  s_add_u32 s34, s32, 532480
  buffer_load_dwordx4 v[136:139], v172, s[20:23], s34 offen
  s_waitcnt vmcnt(9)
  s_waitcnt lgkmcnt(0)
  ds_read_b64_tr_b16 v[156:157], v174 offset:4096
  ds_read_b64_tr_b16 v[158:159], v174 offset:6144
  ds_read_b64_tr_b16 v[160:161], v175 offset:4096
  ds_read_b64_tr_b16 v[162:163], v175 offset:6144
  ds_read_b64_tr_b16 v[164:165], v176 offset:4096
  ds_read_b64_tr_b16 v[166:167], v176 offset:6144
  ds_read_b64_tr_b16 v[168:169], v177 offset:4096
  ds_read_b64_tr_b16 v[170:171], v177 offset:6144
  v_mfma_f32_16x16x32_bf16 v[0:3], v[140:143], v[80:83], v[0:3]
  v_mfma_f32_16x16x32_bf16 v[4:7], v[144:147], v[80:83], v[4:7]
  v_mfma_f32_16x16x32_bf16 v[8:11], v[148:151], v[80:83], v[8:11]
  v_mfma_f32_16x16x32_bf16 v[12:15], v[152:155], v[80:83], v[12:15]
  v_mfma_f32_16x16x32_bf16 v[16:19], v[140:143], v[84:87], v[16:19]
  v_mfma_f32_16x16x32_bf16 v[20:23], v[144:147], v[84:87], v[20:23]
  v_mfma_f32_16x16x32_bf16 v[24:27], v[148:151], v[84:87], v[24:27]
  v_mfma_f32_16x16x32_bf16 v[28:31], v[152:155], v[84:87], v[28:31]
  v_mfma_f32_16x16x32_bf16 v[32:35], v[140:143], v[88:91], v[32:35]
  v_mfma_f32_16x16x32_bf16 v[36:39], v[144:147], v[88:91], v[36:39]
  v_mfma_f32_16x16x32_bf16 v[40:43], v[148:151], v[88:91], v[40:43]
  v_mfma_f32_16x16x32_bf16 v[44:47], v[152:155], v[88:91], v[44:47]
  v_mfma_f32_16x16x32_bf16 v[48:51], v[140:143], v[92:95], v[48:51]
  v_mfma_f32_16x16x32_bf16 v[52:55], v[144:147], v[92:95], v[52:55]
  v_mfma_f32_16x16x32_bf16 v[56:59], v[148:151], v[92:95], v[56:59]
  v_mfma_f32_16x16x32_bf16 v[60:63], v[152:155], v[92:95], v[60:63]
  v_mfma_f32_16x16x32_bf16 v[64:67], v[140:143], v[96:99], v[64:67]
  v_mfma_f32_16x16x32_bf16 v[68:71], v[144:147], v[96:99], v[68:71]
  v_mfma_f32_16x16x32_bf16 v[72:75], v[148:151], v[96:99], v[72:75]
  v_mfma_f32_16x16x32_bf16 v[76:79], v[152:155], v[96:99], v[76:79]
  s_add_u32 m0, s18, 0
  s_add_u32 s34, s33, 294912
  buffer_load_dwordx4 v173, s[24:27], s34 offen lds
  s_add_u32 m0, s18, 1024
  s_add_u32 s34, s33, 303104
  buffer_load_dwordx4 v173, s[24:27], s34 offen lds
  s_add_u32 m0, s18, 2048
  s_add_u32 s34, s33, 311296
  buffer_load_dwordx4 v173, s[24:27], s34 offen lds
  s_add_u32 m0, s18, 3072
  s_add_u32 s34, s33, 319488
  buffer_load_dwordx4 v173, s[24:27], s34 offen lds
  s_add_u32 s34, s32, 9216
  buffer_load_dwordx4 v[80:83], v172, s[20:23], s34 offen
  s_add_u32 s34, s32, 140288
  buffer_load_dwordx4 v[84:87], v172, s[20:23], s34 offen
  s_add_u32 s34, s32, 271360
  buffer_load_dwordx4 v[88:91], v172, s[20:23], s34 offen
  s_add_u32 s34, s32, 402432
  buffer_load_dwordx4 v[92:95], v172, s[20:23], s34 offen
  s_add_u32 s34, s32, 533504
  buffer_load_dwordx4 v[96:99], v172, s[20:23], s34 offen
  s_waitcnt vmcnt(9)
  s_waitcnt lgkmcnt(0)
  ds_read_b64_tr_b16 v[140:141], v174 offset:8192
  ds_read_b64_tr_b16 v[142:143], v174 offset:10240
  ds_read_b64_tr_b16 v[144:145], v175 offset:8192
  ds_read_b64_tr_b16 v[146:147], v175 offset:10240
  ds_read_b64_tr_b16 v[148:149], v176 offset:8192
  ds_read_b64_tr_b16 v[150:151], v176 offset:10240
  ds_read_b64_tr_b16 v[152:153], v177 offset:8192
  ds_read_b64_tr_b16 v[154:155], v177 offset:10240
  v_mfma_f32_16x16x32_bf16 v[0:3], v[156:159], v[100:103], v[0:3]
  v_mfma_f32_16x16x32_bf16 v[4:7], v[160:163], v[100:103], v[4:7]
  v_mfma_f32_16x16x32_bf16 v[8:11], v[164:167], v[100:103], v[8:11]
  v_mfma_f32_16x16x32_bf16 v[12:15], v[168:171], v[100:103], v[12:15]
  v_mfma_f32_16x16x32_bf16 v[16:19], v[156:159], v[104:107], v[16:19]
  v_mfma_f32_16x16x32_bf16 v[20:23], v[160:163], v[104:107], v[20:23]
  v_mfma_f32_16x16x32_bf16 v[24:27], v[164:167], v[104:107], v[24:27]
  v_mfma_f32_16x16x32_bf16 v[28:31], v[168:171], v[104:107], v[28:31]
  v_mfma_f32_16x16x32_bf16 v[32:35], v[156:159], v[108:111], v[32:35]
  v_mfma_f32_16x16x32_bf16 v[36:39], v[160:163], v[108:111], v[36:39]
  v_mfma_f32_16x16x32_bf16 v[40:43], v[164:167], v[108:111], v[40:43]
  v_mfma_f32_16x16x32_bf16 v[44:47], v[168:171], v[108:111], v[44:47]
  v_mfma_f32_16x16x32_bf16 v[48:51], v[156:159], v[112:115], v[48:51]
  v_mfma_f32_16x16x32_bf16 v[52:55], v[160:163], v[112:115], v[52:55]
  v_mfma_f32_16x16x32_bf16 v[56:59], v[164:167], v[112:115], v[56:59]
  v_mfma_f32_16x16x32_bf16 v[60:63], v[168:171], v[112:115], v[60:63]
  v_mfma_f32_16x16x32_bf16 v[64:67], v[156:159], v[116:119], v[64:67]
  v_mfma_f32_16x16x32_bf16 v[68:71], v[160:163], v[116:119], v[68:71]
  v_mfma_f32_16x16x32_bf16 v[72:75], v[164:167], v[116:119], v[72:75]
  v_mfma_f32_16x16x32_bf16 v[76:79], v[168:171], v[116:119], v[76:79]
  s_add_u32 m0, s18, 4096
  s_add_u32 s34, s33, 327680
  buffer_load_dwordx4 v173, s[24:27], s34 offen lds
  s_add_u32 m0, s18, 5120
  s_add_u32 s34, s33, 335872
  buffer_load_dwordx4 v173, s[24:27], s34 offen lds
  s_add_u32 m0, s18, 6144
  s_add_u32 s34, s33, 344064
  buffer_load_dwordx4 v173, s[24:27], s34 offen lds
  s_add_u32 m0, s18, 7168
  s_add_u32 s34, s33, 352256
  buffer_load_dwordx4 v173, s[24:27], s34 offen lds
  s_add_u32 s34, s32, 10240
  buffer_load_dwordx4 v[100:103], v172, s[20:23], s34 offen
  s_add_u32 s34, s32, 141312
  buffer_load_dwordx4 v[104:107], v172, s[20:23], s34 offen
  s_add_u32 s34, s32, 272384
  buffer_load_dwordx4 v[108:111], v172, s[20:23], s34 offen
  s_add_u32 s34, s32, 403456
  buffer_load_dwordx4 v[112:115], v172, s[20:23], s34 offen
  s_add_u32 s34, s32, 534528
  buffer_load_dwordx4 v[116:119], v172, s[20:23], s34 offen
  s_waitcnt vmcnt(9)
  s_waitcnt lgkmcnt(0)
  ds_read_b64_tr_b16 v[156:157], v174 offset:0
  ds_read_b64_tr_b16 v[158:159], v174 offset:2048
  ds_read_b64_tr_b16 v[160:161], v175 offset:0
  ds_read_b64_tr_b16 v[162:163], v175 offset:2048
  ds_read_b64_tr_b16 v[164:165], v176 offset:0
  ds_read_b64_tr_b16 v[166:167], v176 offset:2048
  ds_read_b64_tr_b16 v[168:169], v177 offset:0
  ds_read_b64_tr_b16 v[170:171], v177 offset:2048
  v_mfma_f32_16x16x32_bf16 v[0:3], v[140:143], v[120:123], v[0:3]
  v_mfma_f32_16x16x32_bf16 v[4:7], v[144:147], v[120:123], v[4:7]
  v_mfma_f32_16x16x32_bf16 v[8:11], v[148:151], v[120:123], v[8:11]
  v_mfma_f32_16x16x32_bf16 v[12:15], v[152:155], v[120:123], v[12:15]
  v_mfma_f32_16x16x32_bf16 v[16:19], v[140:143], v[124:127], v[16:19]
  v_mfma_f32_16x16x32_bf16 v[20:23], v[144:147], v[124:127], v[20:23]
  v_mfma_f32_16x16x32_bf16 v[24:27], v[148:151], v[124:127], v[24:27]
  v_mfma_f32_16x16x32_bf16 v[28:31], v[152:155], v[124:127], v[28:31]
  v_mfma_f32_16x16x32_bf16 v[32:35], v[140:143], v[128:131], v[32:35]
  v_mfma_f32_16x16x32_bf16 v[36:39], v[144:147], v[128:131], v[36:39]
  v_mfma_f32_16x16x32_bf16 v[40:43], v[148:151], v[128:131], v[40:43]
  v_mfma_f32_16x16x32_bf16 v[44:47], v[152:155], v[128:131], v[44:47]
  v_mfma_f32_16x16x32_bf16 v[48:51], v[140:143], v[132:135], v[48:51]
  v_mfma_f32_16x16x32_bf16 v[52:55], v[144:147], v[132:135], v[52:55]
  v_mfma_f32_16x16x32_bf16 v[56:59], v[148:151], v[132:135], v[56:59]
  v_mfma_f32_16x16x32_bf16 v[60:63], v[152:155], v[132:135], v[60:63]
  v_mfma_f32_16x16x32_bf16 v[64:67], v[140:143], v[136:139], v[64:67]
  v_mfma_f32_16x16x32_bf16 v[68:71], v[144:147], v[136:139], v[68:71]
  v_mfma_f32_16x16x32_bf16 v[72:75], v[148:151], v[136:139], v[72:75]
  v_mfma_f32_16x16x32_bf16 v[76:79], v[152:155], v[136:139], v[76:79]
  s_add_u32 m0, s18, 8192
  s_add_u32 s34, s33, 360448
  buffer_load_dwordx4 v173, s[24:27], s34 offen lds
  s_add_u32 m0, s18, 9216
  s_add_u32 s34, s33, 368640
  buffer_load_dwordx4 v173, s[24:27], s34 offen lds
  s_add_u32 m0, s18, 10240
  s_add_u32 s34, s33, 376832
  buffer_load_dwordx4 v173, s[24:27], s34 offen lds
  s_add_u32 m0, s18, 11264
  s_add_u32 s34, s33, 385024
  buffer_load_dwordx4 v173, s[24:27], s34 offen lds
  s_add_u32 s34, s32, 11264
  buffer_load_dwordx4 v[120:123], v172, s[20:23], s34 offen
  s_add_u32 s34, s32, 142336
  buffer_load_dwordx4 v[124:127], v172, s[20:23], s34 offen
  s_add_u32 s34, s32, 273408
  buffer_load_dwordx4 v[128:131], v172, s[20:23], s34 offen
  s_add_u32 s34, s32, 404480
  buffer_load_dwordx4 v[132:135], v172, s[20:23], s34 offen
  s_add_u32 s34, s32, 535552
  buffer_load_dwordx4 v[136:139], v172, s[20:23], s34 offen
  s_waitcnt vmcnt(9)
  s_waitcnt lgkmcnt(0)
  ds_read_b64_tr_b16 v[140:141], v174 offset:4096
  ds_read_b64_tr_b16 v[142:143], v174 offset:6144
  ds_read_b64_tr_b16 v[144:145], v175 offset:4096
  ds_read_b64_tr_b16 v[146:147], v175 offset:6144
  ds_read_b64_tr_b16 v[148:149], v176 offset:4096
  ds_read_b64_tr_b16 v[150:151], v176 offset:6144
  ds_read_b64_tr_b16 v[152:153], v177 offset:4096
  ds_read_b64_tr_b16 v[154:155], v177 offset:6144
  v_mfma_f32_16x16x32_bf16 v[0:3], v[156:159], v[80:83], v[0:3]
  v_mfma_f32_16x16x32_bf16 v[4:7], v[160:163], v[80:83], v[4:7]
  v_mfma_f32_16x16x32_bf16 v[8:11], v[164:167], v[80:83], v[8:11]
  v_mfma_f32_16x16x32_bf16 v[12:15], v[168:171], v[80:83], v[12:15]
  v_mfma_f32_16x16x32_bf16 v[16:19], v[156:159], v[84:87], v[16:19]
  v_mfma_f32_16x16x32_bf16 v[20:23], v[160:163], v[84:87], v[20:23]
  v_mfma_f32_16x16x32_bf16 v[24:27], v[164:167], v[84:87], v[24:27]
  v_mfma_f32_16x16x32_bf16 v[28:31], v[168:171], v[84:87], v[28:31]
  v_mfma_f32_16x16x32_bf16 v[32:35], v[156:159], v[88:91], v[32:35]
  v_mfma_f32_16x16x32_bf16 v[36:39], v[160:163], v[88:91], v[36:39]
  v_mfma_f32_16x16x32_bf16 v[40:43], v[164:167], v[88:91], v[40:43]
  v_mfma_f32_16x16x32_bf16 v[44:47], v[168:171], v[88:91], v[44:47]
  v_mfma_f32_16x16x32_bf16 v[48:51], v[156:159], v[92:95], v[48:51]
  v_mfma_f32_16x16x32_bf16 v[52:55], v[160:163], v[92:95], v[52:55]
  v_mfma_f32_16x16x32_bf16 v[56:59], v[164:167], v[92:95], v[56:59]
  v_mfma_f32_16x16x32_bf16 v[60:63], v[168:171], v[92:95], v[60:63]
  v_mfma_f32_16x16x32_bf16 v[64:67], v[156:159], v[96:99], v[64:67]
  v_mfma_f32_16x16x32_bf16 v[68:71], v[160:163], v[96:99], v[68:71]
  v_mfma_f32_16x16x32_bf16 v[72:75], v[164:167], v[96:99], v[72:75]
  v_mfma_f32_16x16x32_bf16 v[76:79], v[168:171], v[96:99], v[76:79]
  s_add_u32 m0, s18, 0
  s_add_u32 s34, s33, 393216
  buffer_load_dwordx4 v173, s[24:27], s34 offen lds
  s_add_u32 m0, s18, 1024
  s_add_u32 s34, s33, 401408
  buffer_load_dwordx4 v173, s[24:27], s34 offen lds
  s_add_u32 m0, s18, 2048
  s_add_u32 s34, s33, 409600
  buffer_load_dwordx4 v173, s[24:27], s34 offen lds
  s_add_u32 m0, s18, 3072
  s_add_u32 s34, s33, 417792
  buffer_load_dwordx4 v173, s[24:27], s34 offen lds
  s_add_u32 s34, s32, 12288
  buffer_load_dwordx4 v[80:83], v172, s[20:23], s34 offen
  s_add_u32 s34, s32, 143360
  buffer_load_dwordx4 v[84:87], v172, s[20:23], s34 offen
  s_add_u32 s34, s32, 274432
  buffer_load_dwordx4 v[88:91], v172, s[20:23], s34 offen
  s_add_u32 s34, s32, 405504
  buffer_load_dwordx4 v[92:95], v172, s[20:23], s34 offen
  s_add_u32 s34, s32, 536576
  buffer_load_dwordx4 v[96:99], v172, s[20:23], s34 offen
  s_waitcnt vmcnt(9)
  s_waitcnt lgkmcnt(0)
  ds_read_b64_tr_b16 v[156:157], v174 offset:8192
  ds_read_b64_tr_b16 v[158:159], v174 offset:10240
  ds_read_b64_tr_b16 v[160:161], v175 offset:8192
  ds_read_b64_tr_b16 v[162:163], v175 offset:10240
  ds_read_b64_tr_b16 v[164:165], v176 offset:8192
  ds_read_b64_tr_b16 v[166:167], v176 offset:10240
  ds_read_b64_tr_b16 v[168:169], v177 offset:8192
  ds_read_b64_tr_b16 v[170:171], v177 offset:10240
  v_mfma_f32_16x16x32_bf16 v[0:3], v[140:143], v[100:103], v[0:3]
  v_mfma_f32_16x16x32_bf16 v[4:7], v[144:147], v[100:103], v[4:7]
  v_mfma_f32_16x16x32_bf16 v[8:11], v[148:151], v[100:103], v[8:11]
  v_mfma_f32_16x16x32_bf16 v[12:15], v[152:155], v[100:103], v[12:15]
  v_mfma_f32_16x16x32_bf16 v[16:19], v[140:143], v[104:107], v[16:19]
  v_mfma_f32_16x16x32_bf16 v[20:23], v[144:147], v[104:107], v[20:23]
  v_mfma_f32_16x16x32_bf16 v[24:27], v[148:151], v[104:107], v[24:27]
  v_mfma_f32_16x16x32_bf16 v[28:31], v[152:155], v[104:107], v[28:31]
  v_mfma_f32_16x16x32_bf16 v[32:35], v[140:143], v[108:111], v[32:35]
  v_mfma_f32_16x16x32_bf16 v[36:39], v[144:147], v[108:111], v[36:39]
  v_mfma_f32_16x16x32_bf16 v[40:43], v[148:151], v[108:111], v[40:43]
  v_mfma_f32_16x16x32_bf16 v[44:47], v[152:155], v[108:111], v[44:47]
  v_mfma_f32_16x16x32_bf16 v[48:51], v[140:143], v[112:115], v[48:51]
  v_mfma_f32_16x16x32_bf16 v[52:55], v[144:147], v[112:115], v[52:55]
  v_mfma_f32_16x16x32_bf16 v[56:59], v[148:151], v[112:115], v[56:59]
  v_mfma_f32_16x16x32_bf16 v[60:63], v[152:155], v[112:115], v[60:63]
  v_mfma_f32_16x16x32_bf16 v[64:67], v[140:143], v[116:119], v[64:67]
  v_mfma_f32_16x16x32_bf16 v[68:71], v[144:147], v[116:119], v[68:71]
  v_mfma_f32_16x16x32_bf16 v[72:75], v[148:151], v[116:119], v[72:75]
  v_mfma_f32_16x16x32_bf16 v[76:79], v[152:155], v[116:119], v[76:79]
  s_add_u32 m0, s18, 4096
  s_add_u32 s34, s33, 425984
  buffer_load_dwordx4 v173, s[24:27], s34 offen lds
  s_add_u32 m0, s18, 5120
  s_add_u32 s34, s33, 434176
  buffer_load_dwordx4 v173, s[24:27], s34 offen lds
  s_add_u32 m0, s18, 6144
  s_add_u32 s34, s33, 442368
  buffer_load_dwordx4 v173, s[24:27], s34 offen lds
  s_add_u32 m0, s18, 7168
  s_add_u32 s34, s33, 450560
  buffer_load_dwordx4 v173, s[24:27], s34 offen lds
  s_add_u32 s34, s32, 13312
  buffer_load_dwordx4 v[100:103], v172, s[20:23], s34 offen
  s_add_u32 s34, s32, 144384
  buffer_load_dwordx4 v[104:107], v172, s[20:23], s34 offen
  s_add_u32 s34, s32, 275456
  buffer_load_dwordx4 v[108:111], v172, s[20:23], s34 offen
  s_add_u32 s34, s32, 406528
  buffer_load_dwordx4 v[112:115], v172, s[20:23], s34 offen
  s_add_u32 s34, s32, 537600
  buffer_load_dwordx4 v[116:119], v172, s[20:23], s34 offen
  s_waitcnt vmcnt(9)
  s_waitcnt lgkmcnt(0)
  ds_read_b64_tr_b16 v[140:141], v174 offset:0
  ds_read_b64_tr_b16 v[142:143], v174 offset:2048
  ds_read_b64_tr_b16 v[144:145], v175 offset:0
  ds_read_b64_tr_b16 v[146:147], v175 offset:2048
  ds_read_b64_tr_b16 v[148:149], v176 offset:0
  ds_read_b64_tr_b16 v[150:151], v176 offset:2048
  ds_read_b64_tr_b16 v[152:153], v177 offset:0
  ds_read_b64_tr_b16 v[154:155], v177 offset:2048
  v_mfma_f32_16x16x32_bf16 v[0:3], v[156:159], v[120:123], v[0:3]
  v_mfma_f32_16x16x32_bf16 v[4:7], v[160:163], v[120:123], v[4:7]
  v_mfma_f32_16x16x32_bf16 v[8:11], v[164:167], v[120:123], v[8:11]
  v_mfma_f32_16x16x32_bf16 v[12:15], v[168:171], v[120:123], v[12:15]
  v_mfma_f32_16x16x32_bf16 v[16:19], v[156:159], v[124:127], v[16:19]
  v_mfma_f32_16x16x32_bf16 v[20:23], v[160:163], v[124:127], v[20:23]
  v_mfma_f32_16x16x32_bf16 v[24:27], v[164:167], v[124:127], v[24:27]
  v_mfma_f32_16x16x32_bf16 v[28:31], v[168:171], v[124:127], v[28:31]
  v_mfma_f32_16x16x32_bf16 v[32:35], v[156:159], v[128:131], v[32:35]
  v_mfma_f32_16x16x32_bf16 v[36:39], v[160:163], v[128:131], v[36:39]
  v_mfma_f32_16x16x32_bf16 v[40:43], v[164:167], v[128:131], v[40:43]
  v_mfma_f32_16x16x32_bf16 v[44:47], v[168:171], v[128:131], v[44:47]
  v_mfma_f32_16x16x32_bf16 v[48:51], v[156:159], v[132:135], v[48:51]
  v_mfma_f32_16x16x32_bf16 v[52:55], v[160:163], v[132:135], v[52:55]
  v_mfma_f32_16x16x32_bf16 v[56:59], v[164:167], v[132:135], v[56:59]
  v_mfma_f32_16x16x32_bf16 v[60:63], v[168:171], v[132:135], v[60:63]
  v_mfma_f32_16x16x32_bf16 v[64:67], v[156:159], v[136:139], v[64:67]
  v_mfma_f32_16x16x32_bf16 v[68:71], v[160:163], v[136:139], v[68:71]
  v_mfma_f32_16x16x32_bf16 v[72:75], v[164:167], v[136:139], v[72:75]
  v_mfma_f32_16x16x32_bf16 v[76:79], v[168:171], v[136:139], v[76:79]
  s_add_u32 m0, s18, 8192
  s_add_u32 s34, s33, 458752
  buffer_load_dwordx4 v173, s[24:27], s34 offen lds
  s_add_u32 m0, s18, 9216
  s_add_u32 s34, s33, 466944
  buffer_load_dwordx4 v173, s[24:27], s34 offen lds
  s_add_u32 m0, s18, 10240
  s_add_u32 s34, s33, 475136
  buffer_load_dwordx4 v173, s[24:27], s34 offen lds
  s_add_u32 m0, s18, 11264
  s_add_u32 s34, s33, 483328
  buffer_load_dwordx4 v173, s[24:27], s34 offen lds
  s_add_u32 s34, s32, 14336
  buffer_load_dwordx4 v[120:123], v172, s[20:23], s34 offen
  s_add_u32 s34, s32, 145408
  buffer_load_dwordx4 v[124:127], v172, s[20:23], s34 offen
  s_add_u32 s34, s32, 276480
  buffer_load_dwordx4 v[128:131], v172, s[20:23], s34 offen
  s_add_u32 s34, s32, 407552
  buffer_load_dwordx4 v[132:135], v172, s[20:23], s34 offen
  s_add_u32 s34, s32, 538624
  buffer_load_dwordx4 v[136:139], v172, s[20:23], s34 offen
  s_waitcnt vmcnt(9)
  s_waitcnt lgkmcnt(0)
  ds_read_b64_tr_b16 v[156:157], v174 offset:4096
  ds_read_b64_tr_b16 v[158:159], v174 offset:6144
  ds_read_b64_tr_b16 v[160:161], v175 offset:4096
  ds_read_b64_tr_b16 v[162:163], v175 offset:6144
  ds_read_b64_tr_b16 v[164:165], v176 offset:4096
  ds_read_b64_tr_b16 v[166:167], v176 offset:6144
  ds_read_b64_tr_b16 v[168:169], v177 offset:4096
  ds_read_b64_tr_b16 v[170:171], v177 offset:6144
  v_mfma_f32_16x16x32_bf16 v[0:3], v[140:143], v[80:83], v[0:3]
  v_mfma_f32_16x16x32_bf16 v[4:7], v[144:147], v[80:83], v[4:7]
  v_mfma_f32_16x16x32_bf16 v[8:11], v[148:151], v[80:83], v[8:11]
  v_mfma_f32_16x16x32_bf16 v[12:15], v[152:155], v[80:83], v[12:15]
  v_mfma_f32_16x16x32_bf16 v[16:19], v[140:143], v[84:87], v[16:19]
  v_mfma_f32_16x16x32_bf16 v[20:23], v[144:147], v[84:87], v[20:23]
  v_mfma_f32_16x16x32_bf16 v[24:27], v[148:151], v[84:87], v[24:27]
  v_mfma_f32_16x16x32_bf16 v[28:31], v[152:155], v[84:87], v[28:31]
  v_mfma_f32_16x16x32_bf16 v[32:35], v[140:143], v[88:91], v[32:35]
  v_mfma_f32_16x16x32_bf16 v[36:39], v[144:147], v[88:91], v[36:39]
  v_mfma_f32_16x16x32_bf16 v[40:43], v[148:151], v[88:91], v[40:43]
  v_mfma_f32_16x16x32_bf16 v[44:47], v[152:155], v[88:91], v[44:47]
  v_mfma_f32_16x16x32_bf16 v[48:51], v[140:143], v[92:95], v[48:51]
  v_mfma_f32_16x16x32_bf16 v[52:55], v[144:147], v[92:95], v[52:55]
  v_mfma_f32_16x16x32_bf16 v[56:59], v[148:151], v[92:95], v[56:59]
  v_mfma_f32_16x16x32_bf16 v[60:63], v[152:155], v[92:95], v[60:63]
  v_mfma_f32_16x16x32_bf16 v[64:67], v[140:143], v[96:99], v[64:67]
  v_mfma_f32_16x16x32_bf16 v[68:71], v[144:147], v[96:99], v[68:71]
  v_mfma_f32_16x16x32_bf16 v[72:75], v[148:151], v[96:99], v[72:75]
  v_mfma_f32_16x16x32_bf16 v[76:79], v[152:155], v[96:99], v[76:79]
  s_add_u32 m0, s18, 0
  s_add_u32 s34, s33, 491520
  buffer_load_dwordx4 v173, s[24:27], s34 offen lds
  s_add_u32 m0, s18, 1024
  s_add_u32 s34, s33, 499712
  buffer_load_dwordx4 v173, s[24:27], s34 offen lds
  s_add_u32 m0, s18, 2048
  s_add_u32 s34, s33, 507904
  buffer_load_dwordx4 v173, s[24:27], s34 offen lds
  s_add_u32 m0, s18, 3072
  s_add_u32 s34, s33, 516096
  buffer_load_dwordx4 v173, s[24:27], s34 offen lds
  s_add_u32 s34, s32, 15360
  buffer_load_dwordx4 v[80:83], v172, s[20:23], s34 offen
  s_add_u32 s34, s32, 146432
  buffer_load_dwordx4 v[84:87], v172, s[20:23], s34 offen
  s_add_u32 s34, s32, 277504
  buffer_load_dwordx4 v[88:91], v172, s[20:23], s34 offen
  s_add_u32 s34, s32, 408576
  buffer_load_dwordx4 v[92:95], v172, s[20:23], s34 offen
  s_add_u32 s34, s32, 539648
  buffer_load_dwordx4 v[96:99], v172, s[20:23], s34 offen
  s_waitcnt vmcnt(9)
  s_waitcnt lgkmcnt(0)
  ds_read_b64_tr_b16 v[140:141], v174 offset:8192
  ds_read_b64_tr_b16 v[142:143], v174 offset:10240
  ds_read_b64_tr_b16 v[144:145], v175 offset:8192
  ds_read_b64_tr_b16 v[146:147], v175 offset:10240
  ds_read_b64_tr_b16 v[148:149], v176 offset:8192
  ds_read_b64_tr_b16 v[150:151], v176 offset:10240
  ds_read_b64_tr_b16 v[152:153], v177 offset:8192
  ds_read_b64_tr_b16 v[154:155], v177 offset:10240
  v_mfma_f32_16x16x32_bf16 v[0:3], v[156:159], v[100:103], v[0:3]
  v_mfma_f32_16x16x32_bf16 v[4:7], v[160:163], v[100:103], v[4:7]
  v_mfma_f32_16x16x32_bf16 v[8:11], v[164:167], v[100:103], v[8:11]
  v_mfma_f32_16x16x32_bf16 v[12:15], v[168:171], v[100:103], v[12:15]
  v_mfma_f32_16x16x32_bf16 v[16:19], v[156:159], v[104:107], v[16:19]
  v_mfma_f32_16x16x32_bf16 v[20:23], v[160:163], v[104:107], v[20:23]
  v_mfma_f32_16x16x32_bf16 v[24:27], v[164:167], v[104:107], v[24:27]
  v_mfma_f32_16x16x32_bf16 v[28:31], v[168:171], v[104:107], v[28:31]
  v_mfma_f32_16x16x32_bf16 v[32:35], v[156:159], v[108:111], v[32:35]
  v_mfma_f32_16x16x32_bf16 v[36:39], v[160:163], v[108:111], v[36:39]
  v_mfma_f32_16x16x32_bf16 v[40:43], v[164:167], v[108:111], v[40:43]
  v_mfma_f32_16x16x32_bf16 v[44:47], v[168:171], v[108:111], v[44:47]
  v_mfma_f32_16x16x32_bf16 v[48:51], v[156:159], v[112:115], v[48:51]
  v_mfma_f32_16x16x32_bf16 v[52:55], v[160:163], v[112:115], v[52:55]
  v_mfma_f32_16x16x32_bf16 v[56:59], v[164:167], v[112:115], v[56:59]
  v_mfma_f32_16x16x32_bf16 v[60:63], v[168:171], v[112:115], v[60:63]
  v_mfma_f32_16x16x32_bf16 v[64:67], v[156:159], v[116:119], v[64:67]
  v_mfma_f32_16x16x32_bf16 v[68:71], v[160:163], v[116:119], v[68:71]
  v_mfma_f32_16x16x32_bf16 v[72:75], v[164:167], v[116:119], v[72:75]
  v_mfma_f32_16x16x32_bf16 v[76:79], v[168:171], v[116:119], v[76:79]
  s_waitcnt vmcnt(0)
  s_waitcnt lgkmcnt(0)
  ds_read_b64_tr_b16 v[156:157], v174 offset:0
  ds_read_b64_tr_b16 v[158:159], v174 offset:2048
  ds_read_b64_tr_b16 v[160:161], v175 offset:0
  ds_read_b64_tr_b16 v[162:163], v175 offset:2048
  ds_read_b64_tr_b16 v[164:165], v176 offset:0
  ds_read_b64_tr_b16 v[166:167], v176 offset:2048
  ds_read_b64_tr_b16 v[168:169], v177 offset:0
  ds_read_b64_tr_b16 v[170:171], v177 offset:2048
  v_mfma_f32_16x16x32_bf16 v[0:3], v[140:143], v[120:123], v[0:3]
  v_mfma_f32_16x16x32_bf16 v[4:7], v[144:147], v[120:123], v[4:7]
  v_mfma_f32_16x16x32_bf16 v[8:11], v[148:151], v[120:123], v[8:11]
  v_mfma_f32_16x16x32_bf16 v[12:15], v[152:155], v[120:123], v[12:15]
  v_mfma_f32_16x16x32_bf16 v[16:19], v[140:143], v[124:127], v[16:19]
  v_mfma_f32_16x16x32_bf16 v[20:23], v[144:147], v[124:127], v[20:23]
  v_mfma_f32_16x16x32_bf16 v[24:27], v[148:151], v[124:127], v[24:27]
  v_mfma_f32_16x16x32_bf16 v[28:31], v[152:155], v[124:127], v[28:31]
  v_mfma_f32_16x16x32_bf16 v[32:35], v[140:143], v[128:131], v[32:35]
  v_mfma_f32_16x16x32_bf16 v[36:39], v[144:147], v[128:131], v[36:39]
  v_mfma_f32_16x16x32_bf16 v[40:43], v[148:151], v[128:131], v[40:43]
  v_mfma_f32_16x16x32_bf16 v[44:47], v[152:155], v[128:131], v[44:47]
  v_mfma_f32_16x16x32_bf16 v[48:51], v[140:143], v[132:135], v[48:51]
  v_mfma_f32_16x16x32_bf16 v[52:55], v[144:147], v[132:135], v[52:55]
  v_mfma_f32_16x16x32_bf16 v[56:59], v[148:151], v[132:135], v[56:59]
  v_mfma_f32_16x16x32_bf16 v[60:63], v[152:155], v[132:135], v[60:63]
  v_mfma_f32_16x16x32_bf16 v[64:67], v[140:143], v[136:139], v[64:67]
  v_mfma_f32_16x16x32_bf16 v[68:71], v[144:147], v[136:139], v[68:71]
  v_mfma_f32_16x16x32_bf16 v[72:75], v[148:151], v[136:139], v[72:75]
  v_mfma_f32_16x16x32_bf16 v[76:79], v[152:155], v[136:139], v[76:79]
  s_waitcnt lgkmcnt(0)
  v_mfma_f32_16x16x32_bf16 v[0:3], v[156:159], v[80:83], v[0:3]
  v_mfma_f32_16x16x32_bf16 v[4:7], v[160:163], v[80:83], v[4:7]
  v_mfma_f32_16x16x32_bf16 v[8:11], v[164:167], v[80:83], v[8:11]
  v_mfma_f32_16x16x32_bf16 v[12:15], v[168:171], v[80:83], v[12:15]
  v_mfma_f32_16x16x32_bf16 v[16:19], v[156:159], v[84:87], v[16:19]
  v_mfma_f32_16x16x32_bf16 v[20:23], v[160:163], v[84:87], v[20:23]
  v_mfma_f32_16x16x32_bf16 v[24:27], v[164:167], v[84:87], v[24:27]
  v_mfma_f32_16x16x32_bf16 v[28:31], v[168:171], v[84:87], v[28:31]
  v_mfma_f32_16x16x32_bf16 v[32:35], v[156:159], v[88:91], v[32:35]
  v_mfma_f32_16x16x32_bf16 v[36:39], v[160:163], v[88:91], v[36:39]
  v_mfma_f32_16x16x32_bf16 v[40:43], v[164:167], v[88:91], v[40:43]
  v_mfma_f32_16x16x32_bf16 v[44:47], v[168:171], v[88:91], v[44:47]
  v_mfma_f32_16x16x32_bf16 v[48:51], v[156:159], v[92:95], v[48:51]
  v_mfma_f32_16x16x32_bf16 v[52:55], v[160:163], v[92:95], v[52:55]
  v_mfma_f32_16x16x32_bf16 v[56:59], v[164:167], v[92:95], v[56:59]
  v_mfma_f32_16x16x32_bf16 v[60:63], v[168:171], v[92:95], v[60:63]
  v_mfma_f32_16x16x32_bf16 v[64:67], v[156:159], v[96:99], v[64:67]
  v_mfma_f32_16x16x32_bf16 v[68:71], v[160:163], v[96:99], v[68:71]
  v_mfma_f32_16x16x32_bf16 v[72:75], v[164:167], v[96:99], v[72:75]
  v_mfma_f32_16x16x32_bf16 v[76:79], v[168:171], v[96:99], v[76:79]
  s_barrier
  s_mul_i32 s9, s3, 20480
  v_add_u32 v179, s9, v172
  s_nop 7
  ds_write_b128 v179, v[0:3] offset:0
  ds_write_b128 v179, v[4:7] offset:1024
  ds_write_b128 v179, v[8:11] offset:2048
  ds_write_b128 v179, v[12:15] offset:3072
  ds_write_b128 v179, v[16:19] offset:4096
  ds_write_b128 v179, v[20:23] offset:5120
  ds_write_b128 v179, v[24:27] offset:6144
  ds_write_b128 v179, v[28:31] offset:7168
  ds_write_b128 v179, v[32:35] offset:8192
  ds_write_b128 v179, v[36:39] offset:9216
  ds_write_b128 v179, v[40:43] offset:10240
  ds_write_b128 v179, v[44:47] offset:11264
  ds_write_b128 v179, v[48:51] offset:12288
  ds_write_b128 v179, v[52:55] offset:13312
  ds_write_b128 v179, v[56:59] offset:14336
  ds_write_b128 v179, v[60:63] offset:15360
  ds_write_b128 v179, v[64:67] offset:16384
  ds_write_b128 v179, v[68:71] offset:17408
  ds_write_b128 v179, v[72:75] offset:18432
  ds_write_b128 v179, v[76:79] offset:19456
  s_waitcnt lgkmcnt(0)
  s_barrier
  v_and_b32 v1, 15, v178
  v_lshrrev_b32 v2, 4, v178
  v_lshrrev_b32 v3, 1, v2
  v_and_b32 v4, 1, v2
  v_lshlrev_b32 v5, 4, v1
  v_lshl_add_u32 v5, v4, 9, v5
  v_lshl_add_u32 v5, v3, 10, v5
  v_lshlrev_b32 v6, 11, v1
  v_lshl_add_u32 v6, v2, 4, v6
  s_mov_b32 s35, s3
K2_TASK:
  s_lshr_b32 s36, s35, 1
  s_and_b32 s37, s35, 1
  s_lshl_b32 s9, s36, 12
  s_lshl_b32 s19, s37, 11
  s_add_u32 s9, s9, s19
  v_add_u32 v7, s9, v5
  v_add_u32 v8, 0x10000, v7
  v_add_u32 v9, 0x20000, v7
  ds_read_b128 v[16:19], v7 offset:0
  ds_read_b128 v[20:23], v7 offset:256
  ds_read_b128 v[24:27], v7 offset:20480
  ds_read_b128 v[28:31], v7 offset:20736
  ds_read_b128 v[32:35], v7 offset:40960
  ds_read_b128 v[36:39], v7 offset:41216
  ds_read_b128 v[40:43], v7 offset:61440
  ds_read_b128 v[44:47], v7 offset:61696
  ds_read_b128 v[48:51], v8 offset:16384
  ds_read_b128 v[52:55], v8 offset:16640
  ds_read_b128 v[56:59], v8 offset:36864
  ds_read_b128 v[60:63], v8 offset:37120
  ds_read_b128 v[64:67], v8 offset:57344
  ds_read_b128 v[68:71], v8 offset:57600
  ds_read_b128 v[72:75], v9 offset:12288
  ds_read_b128 v[76:79], v9 offset:12544
  s_waitcnt lgkmcnt(0)
  v_add_f32 v16, v16, v24
  v_add_f32 v17, v17, v25
  v_add_f32 v18, v18, v26
  v_add_f32 v19, v19, v27
  v_add_f32 v20, v20, v28
  v_add_f32 v21, v21, v29
  v_add_f32 v22, v22, v30
  v_add_f32 v23, v23, v31
  v_add_f32 v16, v16, v32
  v_add_f32 v17, v17, v33
  v_add_f32 v18, v18, v34
  v_add_f32 v19, v19, v35
  v_add_f32 v20, v20, v36
  v_add_f32 v21, v21, v37
  v_add_f32 v22, v22, v38
  v_add_f32 v23, v23, v39
  v_add_f32 v16, v16, v40
  v_add_f32 v17, v17, v41
  v_add_f32 v18, v18, v42
  v_add_f32 v19, v19, v43
  v_add_f32 v20, v20, v44
  v_add_f32 v21, v21, v45
  v_add_f32 v22, v22, v46
  v_add_f32 v23, v23, v47
  v_add_f32 v16, v16, v48
  v_add_f32 v17, v17, v49
  v_add_f32 v18, v18, v50
  v_add_f32 v19, v19, v51
  v_add_f32 v20, v20, v52
  v_add_f32 v21, v21, v53
  v_add_f32 v22, v22, v54
  v_add_f32 v23, v23, v55
  v_add_f32 v16, v16, v56
  v_add_f32 v17, v17, v57
  v_add_f32 v18, v18, v58
  v_add_f32 v19, v19, v59
  v_add_f32 v20, v20, v60
  v_add_f32 v21, v21, v61
  v_add_f32 v22, v22, v62
  v_add_f32 v23, v23, v63
  v_add_f32 v16, v16, v64
  v_add_f32 v17, v17, v65
  v_add_f32 v18, v18, v66
  v_add_f32 v19, v19, v67
  v_add_f32 v20, v20, v68
  v_add_f32 v21, v21, v69
  v_add_f32 v22, v22, v70
  v_add_f32 v23, v23, v71
  v_add_f32 v16, v16, v72
  v_add_f32 v17, v17, v73
  v_add_f32 v18, v18, v74
  v_add_f32 v19, v19, v75
  v_add_f32 v20, v20, v76
  v_add_f32 v21, v21, v77
  v_add_f32 v22, v22, v78
  v_add_f32 v23, v23, v79
  v_cvt_pk_bf16_f32 v12, v16, v17
  v_cvt_pk_bf16_f32 v13, v18, v19
  v_cvt_pk_bf16_f32 v14, v20, v21
  v_cvt_pk_bf16_f32 v15, v22, v23
  s_mul_i32 s9, s7, 5
  s_add_u32 s9, s9, s36
  s_lshl_b32 s9, s9, 15
  s_lshl_b32 s19, s37, 6
  s_add_u32 s9, s9, s19
  buffer_store_dwordx4 v[12:15], v6, s[28:31], s9 offen
  s_add_u32 s35, s35, 8
  s_cmp_lt_u32 s35, 10
  s_cbranch_scc1 K2_TASK
  s_waitcnt vmcnt(0)
K2_EXIT:
  s_endpgm

CODE_END:
.section .rodata,"a"
.p2align 6
.amdhsa_kernel mha_attn_kernel
  .amdhsa_next_free_vgpr 256
  .amdhsa_next_free_sgpr 102
  .amdhsa_accum_offset 256
  .amdhsa_group_segment_fixed_size 0
  .amdhsa_kernarg_size 104
  .amdhsa_user_sgpr_count 2
  .amdhsa_user_sgpr_kernarg_segment_ptr 1
  .amdhsa_system_sgpr_workgroup_id_x 1
.end_amdhsa_kernel

.p2align 6
.amdhsa_kernel mha_oproj_kernel
  .amdhsa_next_free_vgpr 184
  .amdhsa_next_free_sgpr 102
  .amdhsa_accum_offset 184
  .amdhsa_group_segment_fixed_size 0
  .amdhsa_kernarg_size 104
  .amdhsa_user_sgpr_count 2
  .amdhsa_user_sgpr_kernarg_segment_ptr 1
  .amdhsa_system_sgpr_workgroup_id_x 1
.end_amdhsa_kernel
```
